```python
import torch

def _softmax(x, axis=-1):
    return torch.softmax(x, dim=axis)
def _gelu(x):
    return torch.nn.functional.gelu(x, approximate="tanh")
def _silu(x):
    return torch.nn.functional.silu(x)
def _sigmoid(x):
    return torch.sigmoid(x)
def _layernorm(x, axis=-1, eps=1e-5):
    m = x.mean(dim=axis, keepdim=True)
    v = x.var(dim=axis, keepdim=True, unbiased=False)
    return (x - m) / torch.sqrt(v + eps)
def _scatter_add(tgt, idx, src, axis=0):
    return tgt.clone().index_add_(axis, idx, src)
def _segment_sum(src, seg, n):
    out = torch.zeros((n,) + src.shape[1:], dtype=src.dtype)
    return out.index_add_(0, seg, src)
def _pad(x, pw):
    flat = tuple(v for pair in reversed(pw) for v in pair)
    return torch.nn.functional.pad(x, flat)

kernel_name = 'interleave_layers__grouped_kv_mqa__ssm_conv_h3__prompt'

def setup_inputs():

    _w = (lambda a: (lambda t: t.to(torch.bfloat16) if t.is_floating_point() else t)(torch.as_tensor(a)))
    def _A_setup():
        B, S, D, H = 1, 2048, 576, 32
        Dh = D // H
        return {
            "x": _w((lambda *s: torch.randn(*s, dtype=torch.bfloat16) * 0.05)(B, S, D)),
            "wq": _w((lambda *s: torch.randn(*s, dtype=torch.bfloat16) * 0.05)(D, H * Dh)),
            "wk": _w((lambda *s: torch.randn(*s, dtype=torch.bfloat16) * 0.05)(D, Dh)),
            "wv": _w((lambda *s: torch.randn(*s, dtype=torch.bfloat16) * 0.05)(D, Dh)),
            "wo": _w((lambda *s: torch.randn(*s, dtype=torch.bfloat16) * 0.05)(H * Dh, D)),
        }
    _A_in = _A_setup()

    def _B_setup():
        B, S, D = 1, 2048, 576
        ks = 4
        return {
            "q": _w((lambda *s: torch.randn(*s, dtype=torch.bfloat16) * 0.05)(B, S, D)),
            "k": _w((lambda *s: torch.randn(*s, dtype=torch.bfloat16) * 0.4)(B, S, D)),
            "v": _w((lambda *s: torch.randn(*s, dtype=torch.bfloat16) * 0.4)(B, S, D)),
            "shift_k": _w((lambda *s: torch.randn(*s, dtype=torch.bfloat16) * 0.4)(D, ks) * 0.5),
            "ssm_k": _w((lambda *s: torch.randn(*s, dtype=torch.bfloat16) * 0.8)(D, S) * (1.0 / S ** 0.5)),
            "ssm_D": _w((lambda *s: torch.randn(*s, dtype=torch.bfloat16) * 0.4)(D)),
        }
    _B_in = _B_setup()

    return {
        "A_x": _A_in["x"],
        "A_wq": _A_in["wq"],
        "A_wk": _A_in["wk"],
        "A_wv": _A_in["wv"],
        "A_wo": _A_in["wo"],
        "B_q": _B_in["q"],
        "B_k": _B_in["k"],
        "B_v": _B_in["v"],
        "B_shift_k": _B_in["shift_k"],
        "B_ssm_k": _B_in["ssm_k"],
        "B_ssm_D": _B_in["ssm_D"],
    }

def reference(A_x, A_wq, A_wk, A_wv, A_wo, B_q, B_k, B_v, B_shift_k, B_ssm_k, B_ssm_D):
    def _A_ref(x, wq, wk, wv, wo):
        B, S, D = x.shape
        H = 32
        Dh = D // H
        q = (lambda x, *d: x.permute(*d))((x @ wq).reshape(B, S, H, Dh), 0, 2, 1, 3)
        k = x @ wk
        v = x @ wv
        scores = torch.einsum("bhqd,bkd->bhqk", q, k) * (Dh ** -0.5)
        p = _softmax(scores, axis=-1)
        o = torch.einsum("bhqk,bkd->bhqd", p, v)
        return (lambda x, *d: x.permute(*d))(o, 0, 2, 1, 3).reshape(B, S, H * Dh) @ wo

    def _B_ref(q, k, v, shift_k, ssm_k, ssm_D):
        B, S, D = q.shape
        ks = shift_k.shape[-1]
        k_pad = _pad(k, ((0, 0), (ks - 1, 0), (0, 0)))
        k_shift = torch.zeros_like(k)
        for t in range(ks):
            k_shift = k_shift + k_pad[:, t:t + S, :] * shift_k[:, ks - 1 - t][None, None, :]
        kv = k_shift * v
        L = 2 * S
        kv_pad = _pad(kv, ((0, 0), (0, S), (0, 0)))
        kf_pad = _pad(ssm_k, ((0, 0), (0, S)))
        kv_f = (lambda x, axes=(-2,-1): torch.fft.rfft2(x.float(), dim=axes))(kv_pad[:, None, :, :], axes=(1, 2))
        kf_f = (lambda x, axes=(-2,-1): torch.fft.rfft2(x.float(), dim=axes))(kf_pad[:, None, :], axes=(1, 2))
        kf_f = (lambda x, *d: x.permute(*d))(kf_f, 1, 2, 0)
        y_f = kv_f * kf_f[None, :, :, :]
        y = (lambda x, s, axes=(-2,-1): torch.fft.irfft2(x, s=s, dim=axes).to(torch.bfloat16))(y_f, (1, L), axes=(1, 2))[:, 0, :S, :]
        y = y + kv * ssm_D[None, None, :]
        return q * y

    x = A_x
    x = x + _A_ref(_layernorm(x, axis=-1), A_wq, A_wk, A_wv, A_wo)
    x = x + _B_ref(_layernorm(x, axis=-1), B_k, B_v, B_shift_k, B_ssm_k, B_ssm_D)
    x = x + _A_ref(_layernorm(x, axis=-1), A_wq, A_wk, A_wv, A_wo)
    x = x + _B_ref(_layernorm(x, axis=-1), B_k, B_v, B_shift_k, B_ssm_k, B_ssm_D)
    return x
```

```asm
; @launch grid=(256,1,1) block=(256,1,1) lds=151680
.amdgcn_target "amdgcn-amd-amdhsa--gfx950"
.text
.globl interleave_layers__grouped_kv_mqa__ssm_conv_h3__prompt_kernel
.p2align 8
.type interleave_layers__grouped_kv_mqa__ssm_conv_h3__prompt_kernel,@function
interleave_layers__grouped_kv_mqa__ssm_conv_h3__prompt_kernel:
    s_cmp_ge_u32 s2, 256
    s_cbranch_scc1 interleave_layers__grouped_kv_mqa__ssm_conv_h3__prompt_kernel_done
    s_load_dwordx2 s[8:9], s[0:1], 104
    s_load_dwordx16 s[48:63], s[0:1], 0
    s_load_dwordx8 s[64:71], s[0:1], 64
    v_and_b32 v1, 63, v0
    v_lshrrev_b32 v5, 6, v0
    v_and_b32 v2, 15, v0
    v_readfirstlane_b32 s4, v5
    v_bfe_u32 v3, v0, 4, 2
    v_lshlrev_b32 v4, 4, v1
    s_and_b32 s11, s2, 7
    s_lshr_b32 s10, s2, 3
    s_lshr_b32 s5, s10, 1
    s_lshl_b32 s3, s11, 4
    s_add_u32 s5, s5, s3
    s_and_b32 s6, s10, 1
    s_mul_i32 s7, s5, 18432
    v_mul_u32_u24 v38, 1152, v2
    s_mul_i32 s28, s4, 288
    v_lshl_add_u32 v38, v3, 3, v38
    v_add_u32 v38, s28, v38
    s_waitcnt lgkmcnt(0)
    v_mov_b32 v11, 0x27f0000
    global_load_dword v39, v11, s[8:9] sc1
    s_cmp_lt_u32 s4, 2
    s_cbranch_scc1 L_tc1
    s_cmp_eq_u32 s4, 2
    s_cselect_b32 s36, s50, s56
    s_cselect_b32 s37, s51, s57
    s_mov_b32 s24, s36
    s_and_b32 s25, s37, 0xffff
    s_mov_b32 s26, 0xa2000
    s_mov_b32 s27, 0x00020000
    s_mul_i32 s36, s2, 2688
    v_min_u32 v5, 20, v1
    v_lshlrev_b32 v5, 7, v5
    buffer_load_dword v12, v5, s[24:27], s36 offen
L_tc1:
    s_mov_b32 s12, s48
    s_and_b32 s13, s49, 0xffff
    s_mov_b32 s14, 0x240000
    s_mov_b32 s15, 0x00020000
    buffer_load_dwordx2 v[40:41], v38, s[12:15], s7 offen offset:0
    buffer_load_dwordx2 v[42:43], v38, s[12:15], s7 offen offset:32
    buffer_load_dwordx2 v[44:45], v38, s[12:15], s7 offen offset:64
    buffer_load_dwordx2 v[46:47], v38, s[12:15], s7 offen offset:96
    buffer_load_dwordx2 v[48:49], v38, s[12:15], s7 offen offset:128
    buffer_load_dwordx2 v[50:51], v38, s[12:15], s7 offen offset:160
    buffer_load_dwordx2 v[52:53], v38, s[12:15], s7 offen offset:192
    buffer_load_dwordx2 v[54:55], v38, s[12:15], s7 offen offset:224
    buffer_load_dwordx2 v[56:57], v38, s[12:15], s7 offen offset:256
    s_mov_b32 s20, s60
    s_and_b32 s21, s61, 0xffff
    s_mov_b32 s22, 0x240000
    s_mov_b32 s23, 0x00020000
    s_mov_b32 s24, s62
    s_and_b32 s25, s63, 0xffff
    s_mov_b32 s26, 0x240000
    s_mov_b32 s27, 0x00020000
    s_mov_b32 s36, 4608
    v_mov_b32 v218, 0
    v_and_b32 v5, 31, v1
    s_lshl_b32 s35, s4, 5
    v_add_u32 v5, s35, v5
    v_lshrrev_b32 v6, 5, v1
    s_mul_i32 s34, s6, 144
    v_add_u32 v5, s34, v5
    v_mul_u32_u24 v7, 9216, v6
    v_add_u32 v7, s7, v7
    v_lshl_add_u32 v7, v5, 2, v7
    v_subrev_u32 v8, 3456, v7
    v_cmp_gt_u32 vcc, 3456, v7
    v_mov_b32 v9, 0x40000000
    s_nop 0
    v_cndmask_b32 v8, v8, v9, vcc
    v_lshlrev_b32 v9, 4, v5
    buffer_load_dword v100, v8, s[20:23], 0 offen offset:0
    buffer_load_dword v101, v8, s[20:23], 0 offen offset:1152
    buffer_load_dword v102, v8, s[20:23], 0 offen offset:2304
    buffer_load_dword v103, v7, s[20:23], 0 offen offset:0
    buffer_load_dword v104, v7, s[20:23], 0 offen offset:1152
    buffer_load_dword v105, v7, s[20:23], 0 offen offset:2304
    buffer_load_dword v106, v7, s[20:23], 0 offen offset:3456
    buffer_load_dword v107, v7, s[20:23], s36 offen offset:0
    buffer_load_dword v108, v7, s[20:23], s36 offen offset:1152
    buffer_load_dword v109, v7, s[20:23], s36 offen offset:2304
    buffer_load_dword v110, v7, s[20:23], s36 offen offset:3456
    buffer_load_dword v111, v7, s[24:27], 0 offen offset:0
    buffer_load_dword v112, v7, s[24:27], 0 offen offset:1152
    buffer_load_dword v113, v7, s[24:27], 0 offen offset:2304
    buffer_load_dword v114, v7, s[24:27], 0 offen offset:3456
    buffer_load_dword v115, v7, s[24:27], s36 offen offset:0
    buffer_load_dword v116, v7, s[24:27], s36 offen offset:1152
    buffer_load_dword v117, v7, s[24:27], s36 offen offset:2304
    buffer_load_dword v118, v7, s[24:27], s36 offen offset:3456
    global_load_dwordx4 v[120:123], v9, s[64:65]
    v_lshlrev_b32 v58, 13, v5
    s_lshl_b32 s34, s5, 5
    s_add_u32 s34, s34, 0x2000000
    v_lshl_add_u32 v58, v6, 4, v58
    v_add_u32 v58, s34, v58
    s_cmp_lg_u32 s4, 3
    s_cbranch_scc1 L_ut_no2
    v_and_b32 v5, 15, v1
    v_add_u32 v5, 128, v5
    v_bfe_u32 v6, v1, 4, 1
    s_mul_i32 s34, s6, 144
    v_add_u32 v5, s34, v5
    v_mul_u32_u24 v7, 9216, v6
    v_add_u32 v7, s7, v7
    v_lshl_add_u32 v7, v5, 2, v7
    v_cmp_gt_u32 vcc, 32, v1
    v_mov_b32 v9, 0x40000000
    s_nop 0
    v_cndmask_b32 v7, v9, v7, vcc
    v_subrev_u32 v8, 3456, v7
    v_cmp_gt_u32 vcc, 3456, v7
    v_mov_b32 v9, 0x40000000
    s_nop 0
    v_cndmask_b32 v8, v8, v9, vcc
    v_lshlrev_b32 v9, 4, v5
    buffer_load_dword v124, v8, s[20:23], 0 offen offset:0
    buffer_load_dword v125, v8, s[20:23], 0 offen offset:1152
    buffer_load_dword v126, v8, s[20:23], 0 offen offset:2304
    buffer_load_dword v127, v7, s[20:23], 0 offen offset:0
    buffer_load_dword v128, v7, s[20:23], 0 offen offset:1152
    buffer_load_dword v129, v7, s[20:23], 0 offen offset:2304
    buffer_load_dword v130, v7, s[20:23], 0 offen offset:3456
    buffer_load_dword v131, v7, s[20:23], s36 offen offset:0
    buffer_load_dword v132, v7, s[20:23], s36 offen offset:1152
    buffer_load_dword v133, v7, s[20:23], s36 offen offset:2304
    buffer_load_dword v134, v7, s[20:23], s36 offen offset:3456
    buffer_load_dword v135, v7, s[24:27], 0 offen offset:0
    buffer_load_dword v136, v7, s[24:27], 0 offen offset:1152
    buffer_load_dword v137, v7, s[24:27], 0 offen offset:2304
    buffer_load_dword v138, v7, s[24:27], 0 offen offset:3456
    buffer_load_dword v139, v7, s[24:27], s36 offen offset:0
    buffer_load_dword v140, v7, s[24:27], s36 offen offset:1152
    buffer_load_dword v141, v7, s[24:27], s36 offen offset:2304
    buffer_load_dword v142, v7, s[24:27], s36 offen offset:3456
    global_load_dwordx4 v[144:147], v9, s[64:65]
    v_lshlrev_b32 v218, 13, v5
    s_lshl_b32 s34, s5, 5
    s_add_u32 s34, s34, 0x2000000
    v_lshl_add_u32 v218, v6, 4, v218
    v_add_u32 v218, s34, v218
L_ut_no2:
    s_cmp_eq_u32 s6, 0
    s_cselect_b32 s34, s52, s54
    s_cselect_b32 s35, s53, s55
    s_mov_b32 s16, s34
    s_and_b32 s17, s35, 0xffff
    s_mov_b32 s18, 0x5100
    s_mov_b32 s19, 0x00020000
    s_lshl_b32 s28, s4, 6
    s_add_u32 s28, s28, 0
    v_add_u32 v8, s28, v1
    v_mul_u32_u24 v9, 21846, v8
    v_lshrrev_b32 v9, 16, v9
    v_mul_u32_u24 v5, 3, v9
    v_sub_u32 v8, v8, v5
    v_mul_u32_u24 v5, 36, v9
    v_lshl_add_u32 v5, v8, 4, v5
    s_lshl_b32 s28, s4, 6
    s_add_u32 s28, s28, 1
    v_add_u32 v8, s28, v1
    v_mul_u32_u24 v9, 21846, v8
    v_lshrrev_b32 v9, 16, v9
    v_mul_u32_u24 v6, 3, v9
    v_sub_u32 v8, v8, v6
    v_mul_u32_u24 v6, 36, v9
    v_lshl_add_u32 v6, v8, 4, v6
    s_lshl_b32 s28, s4, 6
    s_add_u32 s28, s28, 2
    v_add_u32 v8, s28, v1
    v_mul_u32_u24 v9, 21846, v8
    v_lshrrev_b32 v9, 16, v9
    v_mul_u32_u24 v7, 3, v9
    v_sub_u32 v8, v8, v7
    v_mul_u32_u24 v7, 36, v9
    v_lshl_add_u32 v7, v8, 4, v7
    s_lshl_b32 s28, s4, 10
    s_add_u32 s28, s28, 123904
    s_add_u32 m0, s28, 0
    s_mov_b32 s29, 0
    buffer_load_dwordx4 v5, s[16:19], s29 offen lds
    s_add_u32 m0, s28, 4096
    s_mov_b32 s29, 3060
    buffer_load_dwordx4 v6, s[16:19], s29 offen lds
    s_add_u32 m0, s28, 8192
    s_mov_b32 s29, 6120
    buffer_load_dwordx4 v7, s[16:19], s29 offen lds
    s_add_u32 m0, s28, 12288
    s_mov_b32 s29, 9216
    buffer_load_dwordx4 v5, s[16:19], s29 offen lds
    s_add_u32 m0, s28, 16384
    s_mov_b32 s29, 12276
    buffer_load_dwordx4 v6, s[16:19], s29 offen lds
    s_add_u32 m0, s28, 20480
    s_mov_b32 s29, 15336
    buffer_load_dwordx4 v7, s[16:19], s29 offen lds
    s_cmp_eq_u32 s4, 3
    s_cbranch_scc1 L_wkdma_end48_0
    s_add_u32 m0, s28, 24576
    s_mov_b32 s29, 18432
    buffer_load_dwordx4 v5, s[16:19], s29 offen lds
L_wkdma_end48_0:
    v_lshlrev_b32 v35, 5, v2
    s_lshl_b32 s28, s4, 3
    v_add_u32 v34, s28, v35
    s_mul_i32 s28, s4, 4608
    s_add_u32 s28, s28, 1024
    s_and_b32 s29, s4, 1
    s_mul_i32 s29, s29, 504
    s_sub_u32 s30, s28, s29
    s_sub_u32 s28, s28, 504
    s_add_u32 s28, s28, s29
    v_add_u32 v36, s30, v4
    v_add_u32 v37, s28, v4
    v_mul_u32_u24 v38, 1152, v2
    s_mul_i32 s28, s4, 288
    v_lshl_add_u32 v38, v3, 3, v38
    v_add_u32 v38, s28, v38
    s_cmp_lt_u32 s10, 24
    s_cselect_b32 s81, 1, 0
    s_cbranch_scc0 interleave_layers__grouped_kv_mqa__ssm_conv_h3__prompt_kernel_r_rl
    s_mul_i32 s80, s11, 72
    s_mul_i32 s3, s10, 3
    s_add_u32 s80, s80, s3
    s_branch interleave_layers__grouped_kv_mqa__ssm_conv_h3__prompt_kernel_r_end
interleave_layers__grouped_kv_mqa__ssm_conv_h3__prompt_kernel_r_rl:
    s_sub_u32 s80, s10, 24
    s_lshl_b32 s80, s80, 3
    s_add_u32 s80, s80, s11
interleave_layers__grouped_kv_mqa__ssm_conv_h3__prompt_kernel_r_end:
    s_cmp_lt_u32 s4, 3
    s_cselect_b32 s87, s81, 0
    s_nop 0
    s_waitcnt vmcnt(6)
    v_lshlrev_b32 v186, 16, v120
    v_and_b32 v188, 0xffff0000, v120
    v_lshlrev_b32 v190, 16, v121
    v_and_b32 v192, 0xffff0000, v121
    v_lshlrev_b32 v187, 16, v122
    v_and_b32 v189, 0xffff0000, v122
    v_lshlrev_b32 v191, 16, v123
    v_and_b32 v193, 0xffff0000, v123
    v_lshlrev_b32 v148, 16, v100
    v_and_b32 v149, 0xffff0000, v100
    v_lshlrev_b32 v150, 16, v101
    v_and_b32 v151, 0xffff0000, v101
    v_lshlrev_b32 v152, 16, v102
    v_and_b32 v153, 0xffff0000, v102
    v_lshlrev_b32 v154, 16, v103
    v_and_b32 v155, 0xffff0000, v103
    v_lshlrev_b32 v156, 16, v104
    v_and_b32 v157, 0xffff0000, v104
    v_lshlrev_b32 v158, 16, v105
    v_and_b32 v159, 0xffff0000, v105
    v_lshlrev_b32 v160, 16, v106
    v_and_b32 v161, 0xffff0000, v106
    v_lshlrev_b32 v162, 16, v107
    v_and_b32 v163, 0xffff0000, v107
    v_lshlrev_b32 v164, 16, v108
    v_and_b32 v165, 0xffff0000, v108
    v_lshlrev_b32 v166, 16, v109
    v_and_b32 v167, 0xffff0000, v109
    v_lshlrev_b32 v168, 16, v110
    v_and_b32 v169, 0xffff0000, v110
    v_pk_mul_f32 v[194:195], v[192:193], v[148:149]
    v_pk_mul_f32 v[196:197], v[192:193], v[150:151]
    v_pk_mul_f32 v[198:199], v[192:193], v[152:153]
    v_pk_mul_f32 v[200:201], v[192:193], v[154:155]
    v_pk_mul_f32 v[202:203], v[192:193], v[156:157]
    v_pk_mul_f32 v[204:205], v[192:193], v[158:159]
    v_pk_mul_f32 v[206:207], v[192:193], v[160:161]
    v_pk_mul_f32 v[208:209], v[192:193], v[162:163]
    v_lshlrev_b32 v170, 16, v111
    v_and_b32 v171, 0xffff0000, v111
    v_lshlrev_b32 v172, 16, v112
    v_and_b32 v173, 0xffff0000, v112
    v_lshlrev_b32 v174, 16, v113
    v_and_b32 v175, 0xffff0000, v113
    v_lshlrev_b32 v176, 16, v114
    v_and_b32 v177, 0xffff0000, v114
    v_lshlrev_b32 v178, 16, v115
    v_and_b32 v179, 0xffff0000, v115
    v_lshlrev_b32 v180, 16, v116
    v_and_b32 v181, 0xffff0000, v116
    v_lshlrev_b32 v182, 16, v117
    v_and_b32 v183, 0xffff0000, v117
    v_lshlrev_b32 v184, 16, v118
    v_and_b32 v185, 0xffff0000, v118
    v_pk_fma_f32 v[194:195], v[190:191], v[150:151], v[194:195]
    v_pk_fma_f32 v[196:197], v[190:191], v[152:153], v[196:197]
    v_pk_fma_f32 v[198:199], v[190:191], v[154:155], v[198:199]
    v_pk_fma_f32 v[200:201], v[190:191], v[156:157], v[200:201]
    v_pk_fma_f32 v[202:203], v[190:191], v[158:159], v[202:203]
    v_pk_fma_f32 v[204:205], v[190:191], v[160:161], v[204:205]
    v_pk_fma_f32 v[206:207], v[190:191], v[162:163], v[206:207]
    v_pk_fma_f32 v[208:209], v[190:191], v[164:165], v[208:209]
    v_pk_fma_f32 v[194:195], v[188:189], v[152:153], v[194:195]
    v_pk_fma_f32 v[196:197], v[188:189], v[154:155], v[196:197]
    v_pk_fma_f32 v[198:199], v[188:189], v[156:157], v[198:199]
    v_pk_fma_f32 v[200:201], v[188:189], v[158:159], v[200:201]
    v_pk_fma_f32 v[202:203], v[188:189], v[160:161], v[202:203]
    v_pk_fma_f32 v[204:205], v[188:189], v[162:163], v[204:205]
    v_pk_fma_f32 v[206:207], v[188:189], v[164:165], v[206:207]
    v_pk_fma_f32 v[208:209], v[188:189], v[166:167], v[208:209]
    v_pk_fma_f32 v[194:195], v[186:187], v[154:155], v[194:195]
    v_pk_fma_f32 v[196:197], v[186:187], v[156:157], v[196:197]
    v_pk_fma_f32 v[198:199], v[186:187], v[158:159], v[198:199]
    v_pk_fma_f32 v[200:201], v[186:187], v[160:161], v[200:201]
    v_pk_fma_f32 v[202:203], v[186:187], v[162:163], v[202:203]
    v_pk_fma_f32 v[204:205], v[186:187], v[164:165], v[204:205]
    v_pk_fma_f32 v[206:207], v[186:187], v[166:167], v[206:207]
    v_pk_fma_f32 v[208:209], v[186:187], v[168:169], v[208:209]
    v_pk_mul_f32 v[194:195], v[194:195], v[170:171]
    v_pk_mul_f32 v[196:197], v[196:197], v[172:173]
    v_pk_mul_f32 v[198:199], v[198:199], v[174:175]
    v_pk_mul_f32 v[200:201], v[200:201], v[176:177]
    v_pk_mul_f32 v[202:203], v[202:203], v[178:179]
    v_pk_mul_f32 v[204:205], v[204:205], v[180:181]
    v_pk_mul_f32 v[206:207], v[206:207], v[182:183]
    v_pk_mul_f32 v[208:209], v[208:209], v[184:185]
    v_cvt_pk_bf16_f32 v210, v208, v206
    v_cvt_pk_bf16_f32 v211, v204, v202
    v_cvt_pk_bf16_f32 v212, v200, v198
    v_cvt_pk_bf16_f32 v213, v196, v194
    v_cvt_pk_bf16_f32 v214, v209, v207
    v_cvt_pk_bf16_f32 v215, v205, v203
    v_cvt_pk_bf16_f32 v216, v201, v199
    v_cvt_pk_bf16_f32 v217, v197, v195
    global_store_dwordx4 v58, v[210:213], s[8:9] sc1
    v_add_u32 v58, 4096, v58
    global_store_dwordx4 v58, v[214:217], s[8:9] sc1
    s_cmp_lg_u32 s4, 3
    s_cbranch_scc1 L_ut_no2b
    v_lshlrev_b32 v186, 16, v144
    v_and_b32 v188, 0xffff0000, v144
    v_lshlrev_b32 v190, 16, v145
    v_and_b32 v192, 0xffff0000, v145
    v_lshlrev_b32 v187, 16, v146
    v_and_b32 v189, 0xffff0000, v146
    v_lshlrev_b32 v191, 16, v147
    v_and_b32 v193, 0xffff0000, v147
    v_lshlrev_b32 v148, 16, v124
    v_and_b32 v149, 0xffff0000, v124
    v_lshlrev_b32 v150, 16, v125
    v_and_b32 v151, 0xffff0000, v125
    v_lshlrev_b32 v152, 16, v126
    v_and_b32 v153, 0xffff0000, v126
    v_lshlrev_b32 v154, 16, v127
    v_and_b32 v155, 0xffff0000, v127
    v_lshlrev_b32 v156, 16, v128
    v_and_b32 v157, 0xffff0000, v128
    v_lshlrev_b32 v158, 16, v129
    v_and_b32 v159, 0xffff0000, v129
    v_lshlrev_b32 v160, 16, v130
    v_and_b32 v161, 0xffff0000, v130
    v_lshlrev_b32 v162, 16, v131
    v_and_b32 v163, 0xffff0000, v131
    v_lshlrev_b32 v164, 16, v132
    v_and_b32 v165, 0xffff0000, v132
    v_lshlrev_b32 v166, 16, v133
    v_and_b32 v167, 0xffff0000, v133
    v_lshlrev_b32 v168, 16, v134
    v_and_b32 v169, 0xffff0000, v134
    v_pk_mul_f32 v[194:195], v[192:193], v[148:149]
    v_pk_mul_f32 v[196:197], v[192:193], v[150:151]
    v_pk_mul_f32 v[198:199], v[192:193], v[152:153]
    v_pk_mul_f32 v[200:201], v[192:193], v[154:155]
    v_pk_mul_f32 v[202:203], v[192:193], v[156:157]
    v_pk_mul_f32 v[204:205], v[192:193], v[158:159]
    v_pk_mul_f32 v[206:207], v[192:193], v[160:161]
    v_pk_mul_f32 v[208:209], v[192:193], v[162:163]
    v_lshlrev_b32 v170, 16, v135
    v_and_b32 v171, 0xffff0000, v135
    v_lshlrev_b32 v172, 16, v136
    v_and_b32 v173, 0xffff0000, v136
    v_lshlrev_b32 v174, 16, v137
    v_and_b32 v175, 0xffff0000, v137
    v_lshlrev_b32 v176, 16, v138
    v_and_b32 v177, 0xffff0000, v138
    v_lshlrev_b32 v178, 16, v139
    v_and_b32 v179, 0xffff0000, v139
    v_lshlrev_b32 v180, 16, v140
    v_and_b32 v181, 0xffff0000, v140
    v_lshlrev_b32 v182, 16, v141
    v_and_b32 v183, 0xffff0000, v141
    v_lshlrev_b32 v184, 16, v142
    v_and_b32 v185, 0xffff0000, v142
    v_pk_fma_f32 v[194:195], v[190:191], v[150:151], v[194:195]
    v_pk_fma_f32 v[196:197], v[190:191], v[152:153], v[196:197]
    v_pk_fma_f32 v[198:199], v[190:191], v[154:155], v[198:199]
    v_pk_fma_f32 v[200:201], v[190:191], v[156:157], v[200:201]
    v_pk_fma_f32 v[202:203], v[190:191], v[158:159], v[202:203]
    v_pk_fma_f32 v[204:205], v[190:191], v[160:161], v[204:205]
    v_pk_fma_f32 v[206:207], v[190:191], v[162:163], v[206:207]
    v_pk_fma_f32 v[208:209], v[190:191], v[164:165], v[208:209]
    v_pk_fma_f32 v[194:195], v[188:189], v[152:153], v[194:195]
    v_pk_fma_f32 v[196:197], v[188:189], v[154:155], v[196:197]
    v_pk_fma_f32 v[198:199], v[188:189], v[156:157], v[198:199]
    v_pk_fma_f32 v[200:201], v[188:189], v[158:159], v[200:201]
    v_pk_fma_f32 v[202:203], v[188:189], v[160:161], v[202:203]
    v_pk_fma_f32 v[204:205], v[188:189], v[162:163], v[204:205]
    v_pk_fma_f32 v[206:207], v[188:189], v[164:165], v[206:207]
    v_pk_fma_f32 v[208:209], v[188:189], v[166:167], v[208:209]
    v_pk_fma_f32 v[194:195], v[186:187], v[154:155], v[194:195]
    v_pk_fma_f32 v[196:197], v[186:187], v[156:157], v[196:197]
    v_pk_fma_f32 v[198:199], v[186:187], v[158:159], v[198:199]
    v_pk_fma_f32 v[200:201], v[186:187], v[160:161], v[200:201]
    v_pk_fma_f32 v[202:203], v[186:187], v[162:163], v[202:203]
    v_pk_fma_f32 v[204:205], v[186:187], v[164:165], v[204:205]
    v_pk_fma_f32 v[206:207], v[186:187], v[166:167], v[206:207]
    v_pk_fma_f32 v[208:209], v[186:187], v[168:169], v[208:209]
    v_pk_mul_f32 v[194:195], v[194:195], v[170:171]
    v_pk_mul_f32 v[196:197], v[196:197], v[172:173]
    v_pk_mul_f32 v[198:199], v[198:199], v[174:175]
    v_pk_mul_f32 v[200:201], v[200:201], v[176:177]
    v_pk_mul_f32 v[202:203], v[202:203], v[178:179]
    v_pk_mul_f32 v[204:205], v[204:205], v[180:181]
    v_pk_mul_f32 v[206:207], v[206:207], v[182:183]
    v_pk_mul_f32 v[208:209], v[208:209], v[184:185]
    v_cvt_pk_bf16_f32 v210, v208, v206
    v_cvt_pk_bf16_f32 v211, v204, v202
    v_cvt_pk_bf16_f32 v212, v200, v198
    v_cvt_pk_bf16_f32 v213, v196, v194
    v_cvt_pk_bf16_f32 v214, v209, v207
    v_cvt_pk_bf16_f32 v215, v205, v203
    v_cvt_pk_bf16_f32 v216, v201, v199
    v_cvt_pk_bf16_f32 v217, v197, v195
    s_mov_b64 exec, 0xffffffff
    global_store_dwordx4 v218, v[210:213], s[8:9] sc1
    v_add_u32 v218, 4096, v218
    global_store_dwordx4 v218, v[214:217], s[8:9] sc1
    s_mov_b64 exec, -1
L_ut_no2b:
    s_cmp_eq_u32 s81, 1
    s_cbranch_scc0 interleave_layers__grouped_kv_mqa__ssm_conv_h3__prompt_kernel_nofi
    s_mov_b32 s16, s66
    s_and_b32 s17, s67, 0xffff
    s_mov_b32 s18, 0x240000
    s_mov_b32 s19, 0x00020000
    s_lshl_b32 s38, s80, 1
    s_and_b32 s39, s38, 0xfffffffc
    s_add_u32 s36, s68, s39
    s_addc_u32 s37, s69, 0
    s_load_dwordx2 s[72:73], s[36:37], 0
    s_lshl_b32 s28, s4, 1
    s_lshl_b32 s29, s28, 2
    s_lshr_b32 s29, 0x6e9cb261, s29
    s_and_b32 s29, s29, 15
    s_mul_i32 s30, s28, 272
    s_add_u32 s29, s29, s30
    s_lshl_b32 s29, s29, 4
    s_add_u32 s29, s29, 19520
    s_lshl_b32 s30, s80, 12
    s_lshl_b32 s31, s28, 1
    s_add_u32 s30, s30, s31
    s_add_u32 m0, s29, 0
    s_nop 0
    buffer_load_dwordx4 v4, s[16:19], s30 offen offset:0 lds
    buffer_load_dwordx4 v4, s[16:19], s30 offen offset:1024 lds
    buffer_load_dwordx4 v4, s[16:19], s30 offen offset:2048 lds
    buffer_load_dwordx4 v4, s[16:19], s30 offen offset:3072 lds
    s_add_u32 m0, s29, 34816
    s_add_u32 s30, s30, 4096
    buffer_load_dwordx4 v4, s[16:19], s30 offen offset:0 lds
    buffer_load_dwordx4 v4, s[16:19], s30 offen offset:1024 lds
    buffer_load_dwordx4 v4, s[16:19], s30 offen offset:2048 lds
    buffer_load_dwordx4 v4, s[16:19], s30 offen offset:3072 lds
    s_add_u32 m0, s29, 69632
    s_add_u32 s30, s30, 4096
    buffer_load_dwordx4 v4, s[16:19], s30 offen offset:0 lds
    buffer_load_dwordx4 v4, s[16:19], s30 offen offset:1024 lds
    buffer_load_dwordx4 v4, s[16:19], s30 offen offset:2048 lds
    buffer_load_dwordx4 v4, s[16:19], s30 offen offset:3072 lds
    v_lshlrev_b32 v5, 4, v0
    s_lshl_b32 s30, s80, 12
    buffer_load_dwordx4 a[68:71], v5, s[16:19], s30 offen
    buffer_load_dwordx4 a[72:75], v5, s[16:19], s30 offen offset:16
    s_add_u32 s30, s30, 4096
    buffer_load_dwordx4 a[76:79], v5, s[16:19], s30 offen
    buffer_load_dwordx4 a[80:83], v5, s[16:19], s30 offen offset:16
    s_add_u32 s30, s30, 4096
    buffer_load_dwordx4 a[84:87], v5, s[16:19], s30 offen
    buffer_load_dwordx4 a[88:91], v5, s[16:19], s30 offen offset:16
    s_min_u32 s28, s4, 2
    s_add_u32 s28, s28, s80
    s_lshl_b32 s28, s28, 12
    v_mov_b32 v6, 0
    buffer_load_dwordx4 a[92:95], v6, s[16:19], s28 offen
    s_mov_b32 s74, 19
    s_branch interleave_layers__grouped_kv_mqa__ssm_conv_h3__prompt_kernel_issued
interleave_layers__grouped_kv_mqa__ssm_conv_h3__prompt_kernel_nofi:
    s_mov_b32 s96, 0
    s_cmp_ge_u32 s80, 54
    s_cbranch_scc1 interleave_layers__grouped_kv_mqa__ssm_conv_h3__prompt_kernel_rl_end
    s_cmp_ge_u32 s80, 36
    s_cbranch_scc1 interleave_layers__grouped_kv_mqa__ssm_conv_h3__prompt_kernel_rl_wo
    s_cmp_ge_u32 s80, 32
    s_cbranch_scc1 interleave_layers__grouped_kv_mqa__ssm_conv_h3__prompt_kernel_rl_ql
    s_lshr_b32 s28, s80, 4
    s_and_b32 s29, s80, 15
    s_lshl_b32 s30, s28, 4
    s_and_b32 s31, s29, 14
    s_add_u32 s30, s30, s31
    s_and_b32 s31, s29, 1
    s_lshl_b32 s31, s31, 2
    v_and_b32 v6, 1, v1
    v_add_u32 v6, s30, v6
    v_mul_u32_u24 v6, 18, v6
    v_bfe_u32 v7, v1, 1, 1
    v_lshl_add_u32 v6, v7, 3, v6
    v_add_u32 v6, s31, v6
    v_lshrrev_b32 v5, 2, v1
    v_mul_u32_u24 v5, 1152, v5
    v_lshl_add_u32 v5, v6, 1, v5
    s_mov_b32 s16, s50
    s_and_b32 s17, s51, 0xffff
    s_mov_b32 s18, 0xa2000
    s_mov_b32 s19, 0x00020000
    s_mul_i32 s32, s4, 165888
    s_mul_i32 s33, s4, 9216
    s_add_u32 s33, s33, 19456
    s_add_u32 m0, s33, 0
    s_nop 0
    buffer_load_dwordx4 v5, s[16:19], s32 offen lds
    s_add_u32 s32, s32, 18432
    s_add_u32 m0, s33, 1024
    s_nop 0
    buffer_load_dwordx4 v5, s[16:19], s32 offen lds
    s_add_u32 s32, s32, 18432
    s_add_u32 m0, s33, 2048
    s_nop 0
    buffer_load_dwordx4 v5, s[16:19], s32 offen lds
    s_add_u32 s32, s32, 18432
    s_add_u32 m0, s33, 3072
    s_nop 0
    buffer_load_dwordx4 v5, s[16:19], s32 offen lds
    s_add_u32 s32, s32, 18432
    s_add_u32 m0, s33, 4096
    s_nop 0
    buffer_load_dwordx4 v5, s[16:19], s32 offen lds
    s_add_u32 s32, s32, 18432
    s_add_u32 m0, s33, 5120
    s_nop 0
    buffer_load_dwordx4 v5, s[16:19], s32 offen lds
    s_add_u32 s32, s32, 18432
    s_add_u32 m0, s33, 6144
    s_nop 0
    buffer_load_dwordx4 v5, s[16:19], s32 offen lds
    s_add_u32 s32, s32, 18432
    s_add_u32 m0, s33, 7168
    s_nop 0
    buffer_load_dwordx4 v5, s[16:19], s32 offen lds
    s_add_u32 s32, s32, 18432
    s_add_u32 m0, s33, 8192
    s_nop 0
    buffer_load_dwordx4 v5, s[16:19], s32 offen lds
    s_add_u32 s32, s32, 18432
    s_mul_i32 s28, s28, 18
    s_add_u32 s28, s28, s29
    s_mov_b32 s97, 64
    s_branch interleave_layers__grouped_kv_mqa__ssm_conv_h3__prompt_kernel_rl_qc
interleave_layers__grouped_kv_mqa__ssm_conv_h3__prompt_kernel_rl_ql:
    s_sub_u32 s29, s80, 32
    s_lshr_b32 s28, s29, 1
    s_and_b32 s29, s29, 1
    s_lshl_b32 s30, s28, 4
    s_lshl_b32 s31, s29, 3
    s_add_u32 s30, s30, s31
    v_and_b32 v6, 1, v1
    v_bfe_u32 v7, v1, 1, 2
    v_lshl_add_u32 v6, v6, 2, v7
    v_add_u32 v6, s30, v6
    v_mul_u32_u24 v6, 36, v6
    v_add_u32 v6, 32, v6
    v_lshrrev_b32 v5, 3, v1
    v_mul_u32_u24 v5, 1152, v5
    v_add_u32 v5, v5, v6
    s_mov_b32 s16, s50
    s_and_b32 s17, s51, 0xffff
    s_mov_b32 s18, 0xa2000
    s_mov_b32 s19, 0x00020000
    s_mul_i32 s32, s4, 165888
    s_mul_i32 s33, s4, 4608
    s_add_u32 s33, s33, 19456
    s_add_u32 m0, s33, 0
    s_nop 0
    buffer_load_dword v5, s[16:19], s32 offen lds
    s_add_u32 s32, s32, 9216
    s_add_u32 m0, s33, 256
    s_nop 0
    buffer_load_dword v5, s[16:19], s32 offen lds
    s_add_u32 s32, s32, 9216
    s_add_u32 m0, s33, 512
    s_nop 0
    buffer_load_dword v5, s[16:19], s32 offen lds
    s_add_u32 s32, s32, 9216
    s_add_u32 m0, s33, 768
    s_nop 0
    buffer_load_dword v5, s[16:19], s32 offen lds
    s_add_u32 s32, s32, 9216
    s_add_u32 m0, s33, 1024
    s_nop 0
    buffer_load_dword v5, s[16:19], s32 offen lds
    s_add_u32 s32, s32, 9216
    s_add_u32 m0, s33, 1280
    s_nop 0
    buffer_load_dword v5, s[16:19], s32 offen lds
    s_add_u32 s32, s32, 9216
    s_add_u32 m0, s33, 1536
    s_nop 0
    buffer_load_dword v5, s[16:19], s32 offen lds
    s_add_u32 s32, s32, 9216
    s_add_u32 m0, s33, 1792
    s_nop 0
    buffer_load_dword v5, s[16:19], s32 offen lds
    s_add_u32 s32, s32, 9216
    s_add_u32 m0, s33, 2048
    s_nop 0
    buffer_load_dword v5, s[16:19], s32 offen lds
    s_add_u32 s32, s32, 9216
    s_add_u32 m0, s33, 2304
    s_nop 0
    buffer_load_dword v5, s[16:19], s32 offen lds
    s_add_u32 s32, s32, 9216
    s_add_u32 m0, s33, 2560
    s_nop 0
    buffer_load_dword v5, s[16:19], s32 offen lds
    s_add_u32 s32, s32, 9216
    s_add_u32 m0, s33, 2816
    s_nop 0
    buffer_load_dword v5, s[16:19], s32 offen lds
    s_add_u32 s32, s32, 9216
    s_add_u32 m0, s33, 3072
    s_nop 0
    buffer_load_dword v5, s[16:19], s32 offen lds
    s_add_u32 s32, s32, 9216
    s_add_u32 m0, s33, 3328
    s_nop 0
    buffer_load_dword v5, s[16:19], s32 offen lds
    s_add_u32 s32, s32, 9216
    s_add_u32 m0, s33, 3584
    s_nop 0
    buffer_load_dword v5, s[16:19], s32 offen lds
    s_add_u32 s32, s32, 9216
    s_add_u32 m0, s33, 3840
    s_nop 0
    buffer_load_dword v5, s[16:19], s32 offen lds
    s_add_u32 s32, s32, 9216
    s_add_u32 m0, s33, 4096
    s_nop 0
    buffer_load_dword v5, s[16:19], s32 offen lds
    s_add_u32 s32, s32, 9216
    s_add_u32 m0, s33, 4352
    s_nop 0
    buffer_load_dword v5, s[16:19], s32 offen lds
    s_add_u32 s32, s32, 9216
    s_mul_i32 s28, s28, 18
    s_add_u32 s28, s28, s29
    s_add_u32 s28, s28, 16
    s_mov_b32 s97, 32
interleave_layers__grouped_kv_mqa__ssm_conv_h3__prompt_kernel_rl_qc:
    s_mul_i32 s28, s28, 18432
    s_lshl_b32 s29, s4, 10
    s_add_u32 s28, s28, s29
    s_add_u32 s94, s28, 0x0
    s_mov_b32 s95, 4096
    s_cmp_lt_u32 s4, 2
    s_cselect_b32 s96, 5, 4
    s_lshl_b32 s29, s4, 5
    v_lshrrev_b32 v59, 2, v1
    v_add_u32 v59, s29, v59
    v_mul_lo_u32 v59, s97, v59
    s_lshr_b32 s30, s97, 2
    v_and_b32 v6, 3, v1
    v_mul_lo_u32 v6, s30, v6
    v_add_u32 v59, v59, v6
    v_add_u32 v59, 19456, v59
    s_lshl_b32 s98, s97, 7
    s_lshl_b32 s99, s97, 4
    s_branch interleave_layers__grouped_kv_mqa__ssm_conv_h3__prompt_kernel_rl_end
interleave_layers__grouped_kv_mqa__ssm_conv_h3__prompt_kernel_rl_wo:
    s_sub_u32 s33, s80, 36
    s_cmp_ge_u32 s33, 9
    s_cselect_b32 s28, 1, 0
    s_mul_i32 s29, s28, 9
    s_sub_u32 s29, s33, s29
    s_lshl_b32 s30, s28, 4
    s_cmp_eq_u32 s29, 8
    s_cselect_b32 s36, 1, 0
    s_lshl_b32 s31, s29, 1
    s_add_u32 s31, s31, s30
    s_mov_b32 s16, s56
    s_and_b32 s17, s57, 0xffff
    s_mov_b32 s18, 0xa2000
    s_mov_b32 s19, 0x00020000
    s_mul_i32 s32, s4, 288
    s_mul_i32 s37, s4, 9216
    s_add_u32 s37, s37, 19456
    v_lshrrev_b32 v6, 1, v3
    v_mul_u32_u24 v6, 18, v6
    v_and_b32 v7, 1, v3
    v_add_u32 v6, v6, v7
    s_cmp_eq_u32 s36, 1
    s_cselect_b64 vcc, -1, 0
    v_cndmask_b32 v6, v3, v6, vcc
    v_mul_u32_u24 v5, 1152, v6
    v_lshl_add_u32 v5, v2, 4, v5
    s_mul_i32 s38, s31, 18
    s_mul_i32 s39, s30, 18
    s_add_u32 s39, s39, 16
    s_add_u32 s28, s38, 0
    s_add_u32 s29, s39, 0
    s_cmp_eq_u32 s36, 1
    s_cselect_b32 s28, s29, s28
    s_mul_i32 s28, s28, 1152
    s_add_u32 s28, s28, s32
    s_add_u32 m0, s37, 0
    s_nop 0
    buffer_load_dwordx4 v5, s[16:19], s28 offen lds
    s_add_u32 s28, s38, 8
    s_add_u32 s29, s39, 36
    s_cmp_eq_u32 s36, 1
    s_cselect_b32 s28, s29, s28
    s_mul_i32 s28, s28, 1152
    s_add_u32 s28, s28, s32
    s_add_u32 m0, s37, 1024
    s_nop 0
    buffer_load_dwordx4 v5, s[16:19], s28 offen lds
    s_add_u32 s28, s38, 18
    s_add_u32 s29, s39, 72
    s_cmp_eq_u32 s36, 1
    s_cselect_b32 s28, s29, s28
    s_mul_i32 s28, s28, 1152
    s_add_u32 s28, s28, s32
    s_add_u32 m0, s37, 2048
    s_nop 0
    buffer_load_dwordx4 v5, s[16:19], s28 offen lds
    s_add_u32 s28, s38, 26
    s_add_u32 s29, s39, 108
    s_cmp_eq_u32 s36, 1
    s_cselect_b32 s28, s29, s28
    s_mul_i32 s28, s28, 1152
    s_add_u32 s28, s28, s32
    s_add_u32 m0, s37, 3072
    s_nop 0
    buffer_load_dwordx4 v5, s[16:19], s28 offen lds
    s_add_u32 s28, s38, 4
    s_add_u32 s29, s39, 144
    s_cmp_eq_u32 s36, 1
    s_cselect_b32 s28, s29, s28
    s_mul_i32 s28, s28, 1152
    s_add_u32 s28, s28, s32
    s_add_u32 m0, s37, 4096
    s_nop 0
    buffer_load_dwordx4 v5, s[16:19], s28 offen lds
    s_add_u32 s28, s38, 12
    s_add_u32 s29, s39, 180
    s_cmp_eq_u32 s36, 1
    s_cselect_b32 s28, s29, s28
    s_mul_i32 s28, s28, 1152
    s_add_u32 s28, s28, s32
    s_add_u32 m0, s37, 5120
    s_nop 0
    buffer_load_dwordx4 v5, s[16:19], s28 offen lds
    s_add_u32 s28, s38, 22
    s_add_u32 s29, s39, 216
    s_cmp_eq_u32 s36, 1
    s_cselect_b32 s28, s29, s28
    s_mul_i32 s28, s28, 1152
    s_add_u32 s28, s28, s32
    s_add_u32 m0, s37, 6144
    s_nop 0
    buffer_load_dwordx4 v5, s[16:19], s28 offen lds
    s_add_u32 s28, s38, 30
    s_add_u32 s29, s39, 252
    s_cmp_eq_u32 s36, 1
    s_cselect_b32 s28, s29, s28
    s_mul_i32 s28, s28, 1152
    s_add_u32 s28, s28, s32
    s_add_u32 m0, s37, 7168
    s_nop 0
    buffer_load_dwordx4 v5, s[16:19], s28 offen lds
    v_lshrrev_b32 v6, 1, v1
    v_lshrrev_b32 v7, 3, v6
    v_bfe_u32 v8, v6, 2, 1
    v_and_b32 v9, 3, v6
    v_and_b32 v10, 1, v7
    v_add_u32 v10, s31, v10
    v_mul_u32_u24 v10, 18, v10
    v_lshrrev_b32 v11, 1, v7
    v_lshl_add_u32 v10, v11, 2, v10
    v_lshl_add_u32 v10, v8, 3, v10
    v_add_u32 v10, v10, v9
    v_lshlrev_b32 v11, 2, v7
    v_add_u32 v11, s30, v11
    v_mul_u32_u24 v11, 18, v11
    v_mul_u32_u24 v8, 36, v8
    v_add3_u32 v11, v11, v8, 16
    v_lshrrev_b32 v8, 1, v9
    v_mul_u32_u24 v8, 18, v8
    v_and_b32 v9, 1, v9
    v_add3_u32 v11, v11, v8, v9
    s_cmp_eq_u32 s36, 1
    s_cselect_b64 vcc, -1, 0
    v_cndmask_b32 v10, v10, v11, vcc
    v_mul_u32_u24 v5, 1152, v10
    v_and_b32 v6, 1, v1
    v_lshl_add_u32 v5, v6, 4, v5
    v_add_u32 v5, 256, v5
    s_add_u32 m0, s37, 8192
    s_nop 0
    buffer_load_dwordx4 v5, s[16:19], s32 offen lds
    s_mul_i32 s28, s33, 36864
    s_mul_i32 s29, s4, 9216
    s_add_u32 s28, s28, s29
    s_add_u32 s94, s28, 0xa2000
    s_mov_b32 s95, 1024
    s_mov_b32 s96, 9
    s_mov_b32 s97, 0
    v_lshlrev_b32 v6, 3, v3
    v_bfe_u32 v7, v1, 2, 2
    v_add_u32 v6, v6, v7
    v_and_b32 v8, 3, v1
    v_lshlrev_b32 v59, 8, v6
    v_lshl_add_u32 v59, v8, 3, v59
    v_add_u32 v59, s37, v59
    v_lshlrev_b32 v13, 5, v6
    v_lshl_add_u32 v13, v8, 3, v13
    s_add_u32 s37, s37, 8192
    v_add_u32 v13, s37, v13
interleave_layers__grouped_kv_mqa__ssm_conv_h3__prompt_kernel_rl_end:
    s_mov_b32 s74, 9
    s_sub_u32 s3, s80, 32
    s_cmp_lt_u32 s3, 4
    s_cselect_b32 s74, 18, s74
    s_cmp_ge_u32 s80, 54
    s_cselect_b32 s74, 0, s74
interleave_layers__grouped_kv_mqa__ssm_conv_h3__prompt_kernel_issued:
    v_lshlrev_b32 v60, 16, v40
    v_and_b32 v61, 0xffff0000, v40
    v_lshlrev_b32 v62, 16, v41
    v_and_b32 v63, 0xffff0000, v41
    v_lshlrev_b32 v64, 16, v42
    v_and_b32 v65, 0xffff0000, v42
    v_lshlrev_b32 v66, 16, v43
    v_and_b32 v67, 0xffff0000, v43
    v_lshlrev_b32 v68, 16, v44
    v_and_b32 v69, 0xffff0000, v44
    v_lshlrev_b32 v70, 16, v45
    v_and_b32 v71, 0xffff0000, v45
    v_lshlrev_b32 v72, 16, v46
    v_and_b32 v73, 0xffff0000, v46
    v_lshlrev_b32 v74, 16, v47
    v_and_b32 v75, 0xffff0000, v47
    v_lshlrev_b32 v76, 16, v48
    v_and_b32 v77, 0xffff0000, v48
    v_lshlrev_b32 v78, 16, v49
    v_and_b32 v79, 0xffff0000, v49
    v_lshlrev_b32 v80, 16, v50
    v_and_b32 v81, 0xffff0000, v50
    v_lshlrev_b32 v82, 16, v51
    v_and_b32 v83, 0xffff0000, v51
    v_lshlrev_b32 v84, 16, v52
    v_and_b32 v85, 0xffff0000, v52
    v_lshlrev_b32 v86, 16, v53
    v_and_b32 v87, 0xffff0000, v53
    v_lshlrev_b32 v88, 16, v54
    v_and_b32 v89, 0xffff0000, v54
    v_lshlrev_b32 v90, 16, v55
    v_and_b32 v91, 0xffff0000, v55
    v_lshlrev_b32 v92, 16, v56
    v_and_b32 v93, 0xffff0000, v56
    v_lshlrev_b32 v94, 16, v57
    v_and_b32 v95, 0xffff0000, v57
    v_pk_add_f32 v[16:17], v[60:61], v[62:63]
    v_pk_mul_f32 v[18:19], v[60:61], v[60:61]
    v_pk_fma_f32 v[18:19], v[62:63], v[62:63], v[18:19]
    v_pk_add_f32 v[16:17], v[16:17], v[64:65]
    v_pk_fma_f32 v[18:19], v[64:65], v[64:65], v[18:19]
    v_pk_add_f32 v[16:17], v[16:17], v[66:67]
    v_pk_fma_f32 v[18:19], v[66:67], v[66:67], v[18:19]
    v_pk_add_f32 v[16:17], v[16:17], v[68:69]
    v_pk_fma_f32 v[18:19], v[68:69], v[68:69], v[18:19]
    v_pk_add_f32 v[16:17], v[16:17], v[70:71]
    v_pk_fma_f32 v[18:19], v[70:71], v[70:71], v[18:19]
    v_pk_add_f32 v[16:17], v[16:17], v[72:73]
    v_pk_fma_f32 v[18:19], v[72:73], v[72:73], v[18:19]
    v_pk_add_f32 v[16:17], v[16:17], v[74:75]
    v_pk_fma_f32 v[18:19], v[74:75], v[74:75], v[18:19]
    v_pk_add_f32 v[16:17], v[16:17], v[76:77]
    v_pk_fma_f32 v[18:19], v[76:77], v[76:77], v[18:19]
    v_pk_add_f32 v[16:17], v[16:17], v[78:79]
    v_pk_fma_f32 v[18:19], v[78:79], v[78:79], v[18:19]
    v_pk_add_f32 v[16:17], v[16:17], v[80:81]
    v_pk_fma_f32 v[18:19], v[80:81], v[80:81], v[18:19]
    v_pk_add_f32 v[16:17], v[16:17], v[82:83]
    v_pk_fma_f32 v[18:19], v[82:83], v[82:83], v[18:19]
    v_pk_add_f32 v[16:17], v[16:17], v[84:85]
    v_pk_fma_f32 v[18:19], v[84:85], v[84:85], v[18:19]
    v_pk_add_f32 v[16:17], v[16:17], v[86:87]
    v_pk_fma_f32 v[18:19], v[86:87], v[86:87], v[18:19]
    v_pk_add_f32 v[16:17], v[16:17], v[88:89]
    v_pk_fma_f32 v[18:19], v[88:89], v[88:89], v[18:19]
    v_pk_add_f32 v[16:17], v[16:17], v[90:91]
    v_pk_fma_f32 v[18:19], v[90:91], v[90:91], v[18:19]
    v_pk_add_f32 v[16:17], v[16:17], v[92:93]
    v_pk_fma_f32 v[18:19], v[92:93], v[92:93], v[18:19]
    v_pk_add_f32 v[16:17], v[16:17], v[94:95]
    v_pk_fma_f32 v[18:19], v[94:95], v[94:95], v[18:19]
    v_add_f32 v20, v16, v17
    v_add_f32 v21, v18, v19
    v_mov_b32 v22, v20
    v_mov_b32 v23, v21
    s_nop 0
    v_permlane32_swap_b32 v20, v22
    v_permlane32_swap_b32 v21, v23
    v_add_f32 v20, v20, v22
    v_add_f32 v21, v21, v23
    v_mov_b32 v22, v20
    v_mov_b32 v23, v21
    s_nop 0
    v_permlane16_swap_b32 v20, v22
    v_permlane16_swap_b32 v21, v23
    v_add_f32 v20, v20, v22
    v_add_f32 v21, v21, v23
    ds_write_b64 v34, v[20:21] offset:0
    s_waitcnt lgkmcnt(0)
    s_cmp_eq_u32 s74, 0
    s_cbranch_scc0 L_wy2
    s_waitcnt vmcnt(0)
L_wy2:
    s_cmp_eq_u32 s74, 9
    s_cbranch_scc0 L_wy3
    s_waitcnt vmcnt(9)
L_wy3:
    s_cmp_eq_u32 s74, 18
    s_cbranch_scc0 L_wy4
    s_waitcnt vmcnt(18)
L_wy4:
    s_waitcnt vmcnt(19)
    v_readfirstlane_b32 s86, v39
    s_nop 3
    s_add_u32 s86, s86, 1
    s_barrier
    ds_read_b128 v[16:19], v35 offset:0
    ds_read_b128 v[20:23], v35 offset:16
    s_cmp_lg_u32 s4, 2
    s_cbranch_scc1 L_ft5
    s_lshl_b32 s28, s5, 1
    s_add_u32 s28, s28, s6
    s_lshl_b32 s28, s28, 7
    s_add_u32 s28, s28, 0x2828000
    v_mov_b32 v5, s28
    v_mov_b32 v6, s86
    s_mov_b64 exec, 1
    global_store_dword v5, v6, s[8:9] sc1
    s_mov_b64 exec, -1
L_ft5:
    s_waitcnt lgkmcnt(1)
    v_pk_add_f32 v[16:17], v[16:17], v[18:19]
    s_waitcnt lgkmcnt(0)
    v_pk_add_f32 v[20:21], v[20:21], v[22:23]
    v_pk_add_f32 v[16:17], v[16:17], v[20:21]
    v_mul_f32 v32, 0x3ae38e39, v16
    v_mul_f32 v17, 0x3ae38e39, v17
    v_fma_f32 v17, -v32, v32, v17
    v_max_f32 v17, 0, v17
    v_add_f32 v17, 0x3727c5ac, v17
    v_rsq_f32 v33, v17
    s_cmp_ge_u32 s4, 2
    s_cbranch_scc1 interleave_layers__grouped_kv_mqa__ssm_conv_h3__prompt_kernel_wf1_end
    v_lshrrev_b32 v8, 2, v1
    v_mul_u32_u24 v8, 48, v8
    v_and_b32 v9, 3, v1
    v_lshl_add_u32 v8, v9, 3, v8
    s_lshl_b32 s28, s4, 5
    s_add_u32 s28, s28, 123904
    v_add_u32 v8, s28, v8
    ds_read_b64_tr_b16 v[96:97], v8 offset:0
    ds_read_b64_tr_b16 v[98:99], v8 offset:768
    ds_read_b64_tr_b16 v[100:101], v8 offset:1536
    ds_read_b64_tr_b16 v[102:103], v8 offset:2304
    ds_read_b64_tr_b16 v[104:105], v8 offset:3072
    ds_read_b64_tr_b16 v[106:107], v8 offset:3840
    ds_read_b64_tr_b16 v[108:109], v8 offset:4608
    ds_read_b64_tr_b16 v[110:111], v8 offset:5376
    ds_read_b64_tr_b16 v[112:113], v8 offset:6144
    ds_read_b64_tr_b16 v[114:115], v8 offset:6912
    ds_read_b64_tr_b16 v[116:117], v8 offset:7680
    ds_read_b64_tr_b16 v[118:119], v8 offset:8448
    ds_read_b64_tr_b16 v[120:121], v8 offset:9216
    ds_read_b64_tr_b16 v[122:123], v8 offset:9984
    ds_read_b64_tr_b16 v[124:125], v8 offset:10752
    ds_read_b64_tr_b16 v[126:127], v8 offset:11520
    ds_read_b64_tr_b16 v[128:129], v8 offset:12288
    ds_read_b64_tr_b16 v[130:131], v8 offset:13056
    ds_read_b64_tr_b16 v[132:133], v8 offset:13824
    ds_read_b64_tr_b16 v[134:135], v8 offset:14592
    ds_read_b64_tr_b16 v[136:137], v8 offset:15360
    ds_read_b64_tr_b16 v[138:139], v8 offset:16128
    ds_read_b64_tr_b16 v[140:141], v8 offset:16896
    ds_read_b64_tr_b16 v[142:143], v8 offset:17664
    ds_read_b64_tr_b16 v[144:145], v8 offset:18432
    ds_read_b64_tr_b16 v[146:147], v8 offset:19200
    ds_read_b64_tr_b16 v[148:149], v8 offset:19968
    ds_read_b64_tr_b16 v[150:151], v8 offset:20736
    ds_read_b64_tr_b16 v[152:153], v8 offset:21504
    ds_read_b64_tr_b16 v[154:155], v8 offset:22272
    ds_read_b64_tr_b16 v[156:157], v8 offset:23040
    ds_read_b64_tr_b16 v[158:159], v8 offset:23808
    ds_read_b64_tr_b16 v[160:161], v8 offset:24576
    ds_read_b64_tr_b16 v[162:163], v8 offset:25344
    ds_read_b64_tr_b16 v[164:165], v8 offset:26112
    ds_read_b64_tr_b16 v[166:167], v8 offset:26880
interleave_layers__grouped_kv_mqa__ssm_conv_h3__prompt_kernel_wf1_end:
    v_mov_b32 v16, v33
    v_mul_f32 v18, v32, v33
    v_sub_f32 v18, 0, v18
    v_pk_fma_f32 v[20:21], v[60:61], v[16:17], v[18:19] op_sel_hi:[1,0,0]
    v_pk_fma_f32 v[22:23], v[62:63], v[16:17], v[18:19] op_sel_hi:[1,0,0]
    v_cvt_pk_bf16_f32 v24, v20, v21
    v_cvt_pk_bf16_f32 v25, v22, v23
    ds_write_b64 v36, v[24:25] offset:0
    v_pk_fma_f32 v[20:21], v[64:65], v[16:17], v[18:19] op_sel_hi:[1,0,0]
    v_pk_fma_f32 v[22:23], v[66:67], v[16:17], v[18:19] op_sel_hi:[1,0,0]
    v_cvt_pk_bf16_f32 v26, v20, v21
    v_cvt_pk_bf16_f32 v27, v22, v23
    ds_write_b64 v37, v[26:27] offset:512
    v_pk_fma_f32 v[20:21], v[68:69], v[16:17], v[18:19] op_sel_hi:[1,0,0]
    v_pk_fma_f32 v[22:23], v[70:71], v[16:17], v[18:19] op_sel_hi:[1,0,0]
    v_cvt_pk_bf16_f32 v24, v20, v21
    v_cvt_pk_bf16_f32 v25, v22, v23
    ds_write_b64 v36, v[24:25] offset:1024
    v_pk_fma_f32 v[20:21], v[72:73], v[16:17], v[18:19] op_sel_hi:[1,0,0]
    v_pk_fma_f32 v[22:23], v[74:75], v[16:17], v[18:19] op_sel_hi:[1,0,0]
    v_cvt_pk_bf16_f32 v26, v20, v21
    v_cvt_pk_bf16_f32 v27, v22, v23
    ds_write_b64 v37, v[26:27] offset:1536
    v_pk_fma_f32 v[20:21], v[76:77], v[16:17], v[18:19] op_sel_hi:[1,0,0]
    v_pk_fma_f32 v[22:23], v[78:79], v[16:17], v[18:19] op_sel_hi:[1,0,0]
    v_cvt_pk_bf16_f32 v24, v20, v21
    v_cvt_pk_bf16_f32 v25, v22, v23
    ds_write_b64 v36, v[24:25] offset:2048
    v_pk_fma_f32 v[20:21], v[80:81], v[16:17], v[18:19] op_sel_hi:[1,0,0]
    v_pk_fma_f32 v[22:23], v[82:83], v[16:17], v[18:19] op_sel_hi:[1,0,0]
    v_cvt_pk_bf16_f32 v26, v20, v21
    v_cvt_pk_bf16_f32 v27, v22, v23
    ds_write_b64 v37, v[26:27] offset:2560
    v_pk_fma_f32 v[20:21], v[84:85], v[16:17], v[18:19] op_sel_hi:[1,0,0]
    v_pk_fma_f32 v[22:23], v[86:87], v[16:17], v[18:19] op_sel_hi:[1,0,0]
    v_cvt_pk_bf16_f32 v24, v20, v21
    v_cvt_pk_bf16_f32 v25, v22, v23
    ds_write_b64 v36, v[24:25] offset:3072
    v_pk_fma_f32 v[20:21], v[88:89], v[16:17], v[18:19] op_sel_hi:[1,0,0]
    v_pk_fma_f32 v[22:23], v[90:91], v[16:17], v[18:19] op_sel_hi:[1,0,0]
    v_cvt_pk_bf16_f32 v26, v20, v21
    v_cvt_pk_bf16_f32 v27, v22, v23
    ds_write_b64 v37, v[26:27] offset:3584
    v_pk_fma_f32 v[20:21], v[92:93], v[16:17], v[18:19] op_sel_hi:[1,0,0]
    v_pk_fma_f32 v[22:23], v[94:95], v[16:17], v[18:19] op_sel_hi:[1,0,0]
    v_cvt_pk_bf16_f32 v24, v20, v21
    v_cvt_pk_bf16_f32 v25, v22, v23
    ds_write_b64 v36, v[24:25] offset:4096
    s_waitcnt lgkmcnt(0)
    s_barrier
    s_add_u32 s40, s8, 0x160000
    s_addc_u32 s41, s9, 0
    s_cmp_ge_u32 s4, 2
    s_cbranch_scc1 interleave_layers__grouped_kv_mqa__ssm_conv_h3__prompt_kernel_kv1_end
    s_cmp_eq_u32 s6, 0
    s_cbranch_scc0 interleave_layers__grouped_kv_mqa__ssm_conv_h3__prompt_kernel_kv1_v
    ds_read_b128 v[168:171], v4 offset:1024
    ds_read_b128 v[172:175], v4 offset:2048
    ds_read_b128 v[176:179], v4 offset:3072
    ds_read_b128 v[180:183], v4 offset:4096
    s_waitcnt lgkmcnt(3)
    v_mfma_f32_16x16x32_bf16 v[16:19], v[96:99], v[168:171], 0
    ds_read_b128 v[168:171], v4 offset:5120
    s_waitcnt lgkmcnt(3)
    v_mfma_f32_16x16x32_bf16 v[16:19], v[100:103], v[172:175], v[16:19]
    ds_read_b128 v[172:175], v4 offset:6144
    s_waitcnt lgkmcnt(3)
    v_mfma_f32_16x16x32_bf16 v[16:19], v[104:107], v[176:179], v[16:19]
    ds_read_b128 v[176:179], v4 offset:7168
    s_waitcnt lgkmcnt(3)
    v_mfma_f32_16x16x32_bf16 v[16:19], v[108:111], v[180:183], v[16:19]
    ds_read_b128 v[180:183], v4 offset:8192
    s_waitcnt lgkmcnt(3)
    v_mfma_f32_16x16x32_bf16 v[16:19], v[112:115], v[168:171], v[16:19]
    ds_read_b128 v[168:171], v4 offset:9216
    s_waitcnt lgkmcnt(3)
    v_mfma_f32_16x16x32_bf16 v[16:19], v[116:119], v[172:175], v[16:19]
    ds_read_b128 v[172:175], v4 offset:10240
    s_waitcnt lgkmcnt(3)
    v_mfma_f32_16x16x32_bf16 v[16:19], v[120:123], v[176:179], v[16:19]
    ds_read_b128 v[176:179], v4 offset:11264
    s_waitcnt lgkmcnt(3)
    v_mfma_f32_16x16x32_bf16 v[16:19], v[124:127], v[180:183], v[16:19]
    ds_read_b128 v[180:183], v4 offset:12288
    s_waitcnt lgkmcnt(3)
    v_mfma_f32_16x16x32_bf16 v[16:19], v[128:131], v[168:171], v[16:19]
    ds_read_b128 v[168:171], v4 offset:13312
    s_waitcnt lgkmcnt(3)
    v_mfma_f32_16x16x32_bf16 v[16:19], v[132:135], v[172:175], v[16:19]
    ds_read_b128 v[172:175], v4 offset:14336
    s_waitcnt lgkmcnt(3)
    v_mfma_f32_16x16x32_bf16 v[16:19], v[136:139], v[176:179], v[16:19]
    ds_read_b128 v[176:179], v4 offset:15360
    s_waitcnt lgkmcnt(3)
    v_mfma_f32_16x16x32_bf16 v[16:19], v[140:143], v[180:183], v[16:19]
    ds_read_b128 v[180:183], v4 offset:16384
    s_waitcnt lgkmcnt(3)
    v_mfma_f32_16x16x32_bf16 v[16:19], v[144:147], v[168:171], v[16:19]
    ds_read_b128 v[168:171], v4 offset:17408
    s_waitcnt lgkmcnt(3)
    v_mfma_f32_16x16x32_bf16 v[16:19], v[148:151], v[172:175], v[16:19]
    ds_read_b128 v[172:175], v4 offset:18432
    s_waitcnt lgkmcnt(3)
    v_mfma_f32_16x16x32_bf16 v[16:19], v[152:155], v[176:179], v[16:19]
    s_waitcnt lgkmcnt(2)
    v_mfma_f32_16x16x32_bf16 v[16:19], v[156:159], v[180:183], v[16:19]
    s_waitcnt lgkmcnt(1)
    v_mfma_f32_16x16x32_bf16 v[16:19], v[160:163], v[168:171], v[16:19]
    s_waitcnt lgkmcnt(0)
    v_mfma_f32_16x16x32_bf16 v[16:19], v[164:167], v[172:175], v[16:19]
    s_lshr_b32 s28, s5, 1
    s_and_b32 s29, s5, 1
    s_lshl_b32 s29, s29, 4
    v_add_u32 v5, s29, v2
    s_mov_b32 s30, 0x3eae1a93
    s_nop 2
    v_mul_f32 v16, s30, v16
    v_mul_f32 v17, s30, v17
    v_mul_f32 v18, s30, v18
    v_mul_f32 v19, s30, v19
    v_cvt_pk_bf16_f32 v20, v16, v17
    v_cvt_pk_bf16_f32 v21, v18, v19
    s_cmp_eq_u32 s4, 0
    s_cbranch_scc0 interleave_layers__grouped_kv_mqa__ssm_conv_h3__prompt_kernel_kv1_kl
    v_lshrrev_b32 v6, 1, v3
    v_lshl_add_u32 v6, v6, 5, v5
    v_lshlrev_b32 v6, 4, v6
    v_and_b32 v7, 1, v3
    v_lshl_add_u32 v6, v7, 3, v6
    s_lshl_b32 s28, s28, 10
    v_add_u32 v6, s28, v6
    global_store_dwordx2 v6, v[20:21], s[40:41] offset:0 sc1
    s_branch interleave_layers__grouped_kv_mqa__ssm_conv_h3__prompt_kernel_kv1_end
interleave_layers__grouped_kv_mqa__ssm_conv_h3__prompt_kernel_kv1_kl:
    v_mov_b32 v21, 0x3f803f80
    s_lshl_b32 s28, s28, 5
    v_add_u32 v6, s28, v5
    v_lshlrev_b32 v6, 3, v6
    v_add_u32 v6, 0x10000, v6
    s_mov_b64 exec, 0xffff
    global_store_dwordx2 v6, v[20:21], s[40:41] sc1
    s_mov_b64 exec, -1
    s_branch interleave_layers__grouped_kv_mqa__ssm_conv_h3__prompt_kernel_kv1_end
interleave_layers__grouped_kv_mqa__ssm_conv_h3__prompt_kernel_kv1_v:
    ds_read_b128 v[168:171], v4 offset:1024
    ds_read_b128 v[172:175], v4 offset:2048
    ds_read_b128 v[176:179], v4 offset:3072
    ds_read_b128 v[180:183], v4 offset:4096
    s_waitcnt lgkmcnt(3)
    v_mfma_f32_16x16x32_bf16 v[16:19], v[168:171], v[96:99], 0
    ds_read_b128 v[168:171], v4 offset:5120
    s_waitcnt lgkmcnt(3)
    v_mfma_f32_16x16x32_bf16 v[16:19], v[172:175], v[100:103], v[16:19]
    ds_read_b128 v[172:175], v4 offset:6144
    s_waitcnt lgkmcnt(3)
    v_mfma_f32_16x16x32_bf16 v[16:19], v[176:179], v[104:107], v[16:19]
    ds_read_b128 v[176:179], v4 offset:7168
    s_waitcnt lgkmcnt(3)
    v_mfma_f32_16x16x32_bf16 v[16:19], v[180:183], v[108:111], v[16:19]
    ds_read_b128 v[180:183], v4 offset:8192
    s_waitcnt lgkmcnt(3)
    v_mfma_f32_16x16x32_bf16 v[16:19], v[168:171], v[112:115], v[16:19]
    ds_read_b128 v[168:171], v4 offset:9216
    s_waitcnt lgkmcnt(3)
    v_mfma_f32_16x16x32_bf16 v[16:19], v[172:175], v[116:119], v[16:19]
    ds_read_b128 v[172:175], v4 offset:10240
    s_waitcnt lgkmcnt(3)
    v_mfma_f32_16x16x32_bf16 v[16:19], v[176:179], v[120:123], v[16:19]
    ds_read_b128 v[176:179], v4 offset:11264
    s_waitcnt lgkmcnt(3)
    v_mfma_f32_16x16x32_bf16 v[16:19], v[180:183], v[124:127], v[16:19]
    ds_read_b128 v[180:183], v4 offset:12288
    s_waitcnt lgkmcnt(3)
    v_mfma_f32_16x16x32_bf16 v[16:19], v[168:171], v[128:131], v[16:19]
    ds_read_b128 v[168:171], v4 offset:13312
    s_waitcnt lgkmcnt(3)
    v_mfma_f32_16x16x32_bf16 v[16:19], v[172:175], v[132:135], v[16:19]
    ds_read_b128 v[172:175], v4 offset:14336
    s_waitcnt lgkmcnt(3)
    v_mfma_f32_16x16x32_bf16 v[16:19], v[176:179], v[136:139], v[16:19]
    ds_read_b128 v[176:179], v4 offset:15360
    s_waitcnt lgkmcnt(3)
    v_mfma_f32_16x16x32_bf16 v[16:19], v[180:183], v[140:143], v[16:19]
    ds_read_b128 v[180:183], v4 offset:16384
    s_waitcnt lgkmcnt(3)
    v_mfma_f32_16x16x32_bf16 v[16:19], v[168:171], v[144:147], v[16:19]
    ds_read_b128 v[168:171], v4 offset:17408
    s_waitcnt lgkmcnt(3)
    v_mfma_f32_16x16x32_bf16 v[16:19], v[172:175], v[148:151], v[16:19]
    ds_read_b128 v[172:175], v4 offset:18432
    s_waitcnt lgkmcnt(3)
    v_mfma_f32_16x16x32_bf16 v[16:19], v[176:179], v[152:155], v[16:19]
    s_waitcnt lgkmcnt(2)
    v_mfma_f32_16x16x32_bf16 v[16:19], v[180:183], v[156:159], v[16:19]
    s_waitcnt lgkmcnt(1)
    v_mfma_f32_16x16x32_bf16 v[16:19], v[168:171], v[160:163], v[16:19]
    s_waitcnt lgkmcnt(0)
    v_mfma_f32_16x16x32_bf16 v[16:19], v[172:175], v[164:167], v[16:19]
    s_lshl_b32 s29, s4, 4
    v_add_u32 v5, s29, v2
    v_cmp_eq_u32 vcc, 18, v5
    s_nop 1
    v_cndmask_b32 v7, 0, 1.0, vcc
    v_cmp_gt_u32 vcc, 18, v5
    s_nop 1
    v_cndmask_b32 v16, v7, v16, vcc
    v_cndmask_b32 v17, v7, v17, vcc
    v_cndmask_b32 v18, v7, v18, vcc
    v_cndmask_b32 v19, v7, v19, vcc
    v_cvt_pk_bf16_f32 v20, v16, v17
    v_cvt_pk_bf16_f32 v21, v18, v19
    v_and_b32 v6, 1, v3
    v_lshl_add_u32 v6, v6, 5, v5
    v_lshlrev_b32 v6, 4, v6
    v_lshrrev_b32 v7, 1, v3
    v_lshl_add_u32 v6, v7, 3, v6
    s_lshl_b32 s28, s5, 10
    s_add_u32 s28, s28, 0x18000
    v_add_u32 v6, s28, v6
    global_store_dwordx2 v6, v[20:21], s[40:41] sc1
interleave_layers__grouped_kv_mqa__ssm_conv_h3__prompt_kernel_kv1_end:
    s_cmp_eq_u32 s81, 0
    s_cbranch_scc0 interleave_layers__grouped_kv_mqa__ssm_conv_h3__prompt_kernel_norl
    s_waitcnt vmcnt(0)
    s_barrier
    s_cmp_eq_u32 s96, 0
    s_cbranch_scc1 interleave_layers__grouped_kv_mqa__ssm_conv_h3__prompt_kernel_rl_fin
    v_add_u32 v5, s94, v4
    s_cmp_eq_u32 s96, 9
    s_cbranch_scc1 interleave_layers__grouped_kv_mqa__ssm_conv_h3__prompt_kernel_rl_fo
    v_add_u32 v6, s99, v59
    ds_read_b64_tr_b16 v[104:105], v59
    ds_read_b64_tr_b16 v[106:107], v6
    v_add_u32 v59, s98, v59
    v_add_u32 v6, s98, v6
    s_waitcnt lgkmcnt(0)
    global_store_dwordx4 v5, v[104:107], s[8:9] sc1
    v_add_u32 v5, s95, v5
    ds_read_b64_tr_b16 v[108:109], v59
    ds_read_b64_tr_b16 v[110:111], v6
    v_add_u32 v59, s98, v59
    v_add_u32 v6, s98, v6
    s_waitcnt lgkmcnt(0)
    global_store_dwordx4 v5, v[108:111], s[8:9] sc1
    v_add_u32 v5, s95, v5
    ds_read_b64_tr_b16 v[104:105], v59
    ds_read_b64_tr_b16 v[106:107], v6
    v_add_u32 v59, s98, v59
    v_add_u32 v6, s98, v6
    s_waitcnt lgkmcnt(0)
    global_store_dwordx4 v5, v[104:107], s[8:9] sc1
    v_add_u32 v5, s95, v5
    ds_read_b64_tr_b16 v[108:109], v59
    ds_read_b64_tr_b16 v[110:111], v6
    v_add_u32 v59, s98, v59
    v_add_u32 v6, s98, v6
    s_waitcnt lgkmcnt(0)
    global_store_dwordx4 v5, v[108:111], s[8:9] sc1
    v_add_u32 v5, s95, v5
    s_cmp_lt_u32 s96, 5
    s_cbranch_scc1 interleave_layers__grouped_kv_mqa__ssm_conv_h3__prompt_kernel_rl_fin
    ds_read_b64_tr_b16 v[104:105], v59
    ds_read_b64_tr_b16 v[106:107], v6
    v_add_u32 v59, s98, v59
    v_add_u32 v6, s98, v6
    s_waitcnt lgkmcnt(0)
    global_store_dwordx4 v5, v[104:107], s[8:9] sc1
    v_add_u32 v5, s95, v5
    s_branch interleave_layers__grouped_kv_mqa__ssm_conv_h3__prompt_kernel_rl_fin
interleave_layers__grouped_kv_mqa__ssm_conv_h3__prompt_kernel_rl_fo:
    ds_read_b64_tr_b16 v[104:105], v59 offset:0
    ds_read_b64_tr_b16 v[106:107], v59 offset:1024
    ds_read_b64_tr_b16 v[108:109], v59 offset:32
    ds_read_b64_tr_b16 v[110:111], v59 offset:1056
    ds_read_b64_tr_b16 v[112:113], v59 offset:64
    ds_read_b64_tr_b16 v[114:115], v59 offset:1088
    ds_read_b64_tr_b16 v[116:117], v59 offset:96
    ds_read_b64_tr_b16 v[118:119], v59 offset:1120
    ds_read_b64_tr_b16 v[120:121], v59 offset:128
    ds_read_b64_tr_b16 v[122:123], v59 offset:1152
    ds_read_b64_tr_b16 v[124:125], v59 offset:160
    ds_read_b64_tr_b16 v[126:127], v59 offset:1184
    ds_read_b64_tr_b16 v[128:129], v59 offset:192
    ds_read_b64_tr_b16 v[130:131], v59 offset:1216
    ds_read_b64_tr_b16 v[132:133], v59 offset:224
    ds_read_b64_tr_b16 v[134:135], v59 offset:1248
    ds_read_b64_tr_b16 v[136:137], v13
    ds_read_b64_tr_b16 v[138:139], v13 offset:128
    s_waitcnt lgkmcnt(0)
    global_store_dwordx4 v5, v[104:107], s[8:9] sc1
    v_add_u32 v5, 1024, v5
    global_store_dwordx4 v5, v[108:111], s[8:9] sc1
    v_add_u32 v5, 1024, v5
    global_store_dwordx4 v5, v[112:115], s[8:9] sc1
    v_add_u32 v5, 1024, v5
    global_store_dwordx4 v5, v[116:119], s[8:9] sc1
    v_add_u32 v5, 1024, v5
    global_store_dwordx4 v5, v[120:123], s[8:9] sc1
    v_add_u32 v5, 1024, v5
    global_store_dwordx4 v5, v[124:127], s[8:9] sc1
    v_add_u32 v5, 1024, v5
    global_store_dwordx4 v5, v[128:131], s[8:9] sc1
    v_add_u32 v5, 1024, v5
    global_store_dwordx4 v5, v[132:135], s[8:9] sc1
    v_add_u32 v5, 1024, v5
    global_store_dwordx4 v5, v[136:139], s[8:9] sc1
    v_add_u32 v5, 1024, v5
interleave_layers__grouped_kv_mqa__ssm_conv_h3__prompt_kernel_rl_fin:
interleave_layers__grouped_kv_mqa__ssm_conv_h3__prompt_kernel_norl:
    v_accvgpr_write_b32 a240, v40
    v_accvgpr_write_b32 a241, v41
    v_accvgpr_write_b32 a242, v42
    v_accvgpr_write_b32 a243, v43
    v_accvgpr_write_b32 a244, v44
    v_accvgpr_write_b32 a245, v45
    v_accvgpr_write_b32 a246, v46
    v_accvgpr_write_b32 a247, v47
    v_accvgpr_write_b32 a248, v48
    v_accvgpr_write_b32 a249, v49
    v_accvgpr_write_b32 a250, v50
    v_accvgpr_write_b32 a251, v51
    v_accvgpr_write_b32 a252, v52
    v_accvgpr_write_b32 a253, v53
    v_accvgpr_write_b32 a254, v54
    v_accvgpr_write_b32 a255, v55
    v_mov_b32 v252, v56
    v_mov_b32 v253, v57
    v_mov_b32 v8, 151616
    s_not_b32 s3, s86
    v_mov_b32 v9, s3
    ds_write_b32 v8, v9
    s_waitcnt vmcnt(0)
    s_barrier
    s_cmp_lg_u32 s4, 0
    s_cbranch_scc1 L_fs6
    s_lshl_b32 s28, s5, 1
    s_add_u32 s28, s28, s6
    s_lshl_b32 s28, s28, 7
    s_add_u32 s28, s28, 0x2800000
    v_mov_b32 v5, s28
    v_mov_b32 v6, s86
    s_mov_b64 exec, 1
    global_store_dword v5, v6, s[8:9] sc1
    s_mov_b64 exec, -1
L_fs6:
    s_cmp_eq_u32 s81, 1
    s_cbranch_scc0 interleave_layers__grouped_kv_mqa__ssm_conv_h3__prompt_kernel_nofb0
    v_lshlrev_b32 v5, 4, v0
    v_add_u32 v5, 23968, v5
    v_lshlrev_b32 v6, 4, v0
    v_add_u32 v6, 32752, v6
    v_lshlrev_b32 v7, 4, v0
    v_add_u32 v7, 41424, v7
    v_lshlrev_b32 v8, 4, v0
    v_add_u32 v8, 50080, v8
    v_accvgpr_read_b32 v172, a68
    v_accvgpr_read_b32 v173, a69
    v_accvgpr_read_b32 v174, a70
    v_accvgpr_read_b32 v175, a71
    v_accvgpr_read_b32 v176, a72
    v_accvgpr_read_b32 v177, a73
    v_accvgpr_read_b32 v178, a74
    v_accvgpr_read_b32 v179, a75
    v_alignbit_b32 v236, v173, v172, 16
    v_alignbit_b32 v237, v174, v173, 16
    v_alignbit_b32 v238, v175, v174, 16
    v_alignbit_b32 v239, v176, v175, 16
    v_alignbit_b32 v240, v177, v176, 16
    v_alignbit_b32 v241, v178, v177, 16
    ds_write_b128 v5, v[236:239] offset:0
    ds_write_b128 v7, v[238:241] offset:0
    v_alignbit_b32 v244, v174, v173, 16
    v_alignbit_b32 v245, v175, v174, 16
    v_alignbit_b32 v246, v176, v175, 16
    v_alignbit_b32 v247, v177, v176, 16
    v_alignbit_b32 v248, v178, v177, 16
    v_alignbit_b32 v249, v179, v178, 16
    ds_write_b128 v6, v[244:247] offset:0
    ds_write_b128 v8, v[246:249] offset:0
    v_accvgpr_read_b32 v172, a76
    v_accvgpr_read_b32 v173, a77
    v_accvgpr_read_b32 v174, a78
    v_accvgpr_read_b32 v175, a79
    v_accvgpr_read_b32 v176, a80
    v_accvgpr_read_b32 v177, a81
    v_accvgpr_read_b32 v178, a82
    v_accvgpr_read_b32 v179, a83
    v_add_u32 v5, 34816, v5
    v_add_u32 v6, 34816, v6
    v_add_u32 v7, 34816, v7
    v_add_u32 v8, 34816, v8
    v_alignbit_b32 v236, v173, v172, 16
    v_alignbit_b32 v237, v174, v173, 16
    v_alignbit_b32 v238, v175, v174, 16
    v_alignbit_b32 v239, v176, v175, 16
    v_alignbit_b32 v240, v177, v176, 16
    v_alignbit_b32 v241, v178, v177, 16
    ds_write_b128 v5, v[236:239] offset:0
    ds_write_b128 v7, v[238:241] offset:0
    v_alignbit_b32 v244, v174, v173, 16
    v_alignbit_b32 v245, v175, v174, 16
    v_alignbit_b32 v246, v176, v175, 16
    v_alignbit_b32 v247, v177, v176, 16
    v_alignbit_b32 v248, v178, v177, 16
    v_alignbit_b32 v249, v179, v178, 16
    ds_write_b128 v6, v[244:247] offset:0
    ds_write_b128 v8, v[246:249] offset:0
    v_accvgpr_read_b32 v172, a84
    v_accvgpr_read_b32 v173, a85
    v_accvgpr_read_b32 v174, a86
    v_accvgpr_read_b32 v175, a87
    v_accvgpr_read_b32 v176, a88
    v_accvgpr_read_b32 v177, a89
    v_accvgpr_read_b32 v178, a90
    v_accvgpr_read_b32 v179, a91
    v_alignbit_b32 v236, v173, v172, 16
    v_alignbit_b32 v237, v174, v173, 16
    v_alignbit_b32 v238, v175, v174, 16
    v_alignbit_b32 v239, v176, v175, 16
    v_alignbit_b32 v240, v177, v176, 16
    v_alignbit_b32 v241, v178, v177, 16
    ds_write_b128 v5, v[236:239] offset:34816
    ds_write_b128 v7, v[238:241] offset:34816
    v_alignbit_b32 v244, v174, v173, 16
    v_alignbit_b32 v245, v175, v174, 16
    v_alignbit_b32 v246, v176, v175, 16
    v_alignbit_b32 v247, v177, v176, 16
    v_alignbit_b32 v248, v178, v177, 16
    v_alignbit_b32 v249, v179, v178, 16
    ds_write_b128 v6, v[244:247] offset:34816
    ds_write_b128 v8, v[246:249] offset:34816
    v_mov_b32 v236, 0
    v_mov_b32 v237, 0
    v_mov_b32 v238, 0
    v_mov_b32 v239, 0
    s_min_u32 s28, s4, 2
    s_mul_i32 s29, s28, 34816
    s_add_u32 s29, s29, 19456
    v_and_b32 v5, 31, v1
    v_lshrrev_b32 v6, 2, v5
    v_lshlrev_b32 v7, 2, v6
    v_mov_b32 v8, 0x6e9cb261
    v_lshrrev_b32 v7, v7, v8
    v_and_b32 v7, 15, v7
    v_mul_u32_u24 v6, 272, v6
    v_add_u32 v6, v6, v7
    v_and_b32 v7, 3, v5
    v_add_lshl_u32 v6, v6, v7, 4
    v_add_u32 v6, s29, v6
    ds_write_b128 v6, v[236:239]
    s_mul_i32 s30, s28, 7680
    s_add_u32 s30, s30, 123904
    v_add_u32 v7, s30, v4
    ds_write_b128 v7, v[236:239]
    ds_write_b128 v7, v[236:239] offset:416
    s_lshl_b32 s31, s28, 5
    s_add_u32 s31, s31, 146944
    v_mov_b32 v8, s31
    ds_write_b128 v8, v[236:239]
    ds_write_b128 v8, a[92:95] offset:16
    v_and_b32 v5, 7, v1
    v_lshl_add_u32 v8, v5, 1, v8
    s_waitcnt lgkmcnt(0)
    ds_read_b128 v[240:243], v8
    v_lshlrev_b32 v7, 2, v5
    v_mov_b32 v6, 0x6e9cb261
    v_lshrrev_b32 v7, v7, v6
    v_and_b32 v7, 15, v7
    v_mul_u32_u24 v6, 272, v5
    v_add_lshl_u32 v6, v6, v7, 4
    v_add_u32 v6, s29, v6
    s_waitcnt lgkmcnt(0)
    ds_write_b128 v6, v[240:243] offset:48
    s_waitcnt lgkmcnt(0)
    s_and_b32 s32, s80, 1
    s_lshl_b32 s32, s32, 4
    s_lshr_b64 s[72:73], s[72:73], s32
    s_lshl_b32 s76, s72, 16
    s_and_b32 s77, s72, 0xffff0000
    s_lshl_b32 s78, s73, 16
interleave_layers__grouped_kv_mqa__ssm_conv_h3__prompt_kernel_nofb0:
    s_mul_i32 s28, s4, 6144
    s_add_u32 s28, s28, 19456
    v_add_u32 v234, s28, v4
    s_lshr_b32 s29, s4, 1
    s_and_b32 s30, s4, 1
    s_mul_i32 s31, s29, 3072
    s_add_u32 s31, s31, 19456
    s_lshl_b32 s32, s30, 10
    s_add_u32 s32, s32, s31
    v_add_u32 v235, s32, v4
    v_and_b32 v5, 31, v1
    v_lshlrev_b32 v6, 4, v5
    s_add_u32 s31, s31, 2048
    v_add_u32 v236, s31, v6
    s_lshl_b32 s31, s29, 10
    s_lshl_b32 s32, s30, 3
    s_add_u32 s31, s31, s32
    s_add_u32 s32, s31, 44032
    v_add_u32 v237, s32, v4
    s_add_u32 s32, s31, 147200
    v_add_u32 v239, s32, v4
    v_lshlrev_b32 v238, 4, v2
    v_lshrrev_b32 v5, 4, v5
    v_lshl_add_u32 v238, v5, 2, v238
    s_lshl_b32 s31, s29, 3
    s_add_u32 s31, s31, 46080
    v_add_u32 v238, s31, v238
    v_add_u32 v241, 147200, v4
    v_lshlrev_b32 v240, 2, v1
    v_add_u32 v240, 149248, v240
    s_lshl_b32 s28, s4, 14
    s_add_u32 s28, s28, 4096
    v_add_u32 v244, s28, v4
    s_lshl_b32 s28, s4, 12
    s_add_u32 s28, s28, 0x10000
    v_lshlrev_b32 v245, 3, v1
    v_add_u32 v245, s28, v245
    v_and_b32 v5, 31, v1
    v_min_u32 v5, 19, v5
    v_and_b32 v6, 32, v1
    v_add_lshl_u32 v246, v5, v6, 4
    s_lshl_b32 s28, s4, 15
    s_add_u32 s28, s28, 0x19000
    v_add_u32 v246, s28, v246
    s_mul_i32 s28, s6, 331776
    s_mul_i32 s29, s4, 18432
    s_add_u32 s28, s28, s29
    s_add_u32 s28, s28, 0x1000
    v_add_u32 v232, s28, v4
    s_mul_i32 s28, s6, 331776
    s_mul_i32 s29, s4, 9216
    s_add_u32 s28, s28, s29
    s_add_u32 s28, s28, 0xa3000
    v_add_u32 v233, s28, v4
    s_cmp_eq_u32 s81, 1
    s_cbranch_scc0 interleave_layers__grouped_kv_mqa__ssm_conv_h3__prompt_kernel_nofb
    s_min_u32 s34, s4, 2
    v_add_u32 v7, 1, v2
    v_and_b32 v8, 7, v7
    v_lshrrev_b32 v7, 3, v7
    v_sub_u32 v7, v7, v3
    v_add_u32 v7, 3, v7
    v_lshlrev_b32 v9, 2, v8
    v_mov_b32 v10, 0x6e9cb261
    v_lshrrev_b32 v9, v9, v10
    v_and_b32 v9, 15, v9
    v_mul_u32_u24 v8, 272, v8
    v_add3_u32 v7, v7, v8, v9
    v_lshlrev_b32 v7, 4, v7
    s_mul_i32 s29, s34, 34816
    s_add_u32 s29, s29, 19456
    v_add_u32 v144, s29, v7
    v_mul_u32_u24 v7, 96, v2
    v_lshl_add_u32 v7, v3, 4, v7
    s_mul_i32 s30, s34, 7680
    s_add_u32 s30, s30, 123904
    v_add_u32 v145, s30, v7
    v_mov_b32 v16, 0
    v_mov_b32 v17, 0
    v_mov_b32 v18, 0
    v_mov_b32 v19, 0
    v_mov_b32 v20, 0
    v_mov_b32 v21, 0
    v_mov_b32 v22, 0
    v_mov_b32 v23, 0
    v_mov_b32 v24, 0
    v_mov_b32 v25, 0
    v_mov_b32 v26, 0
    v_mov_b32 v27, 0
    v_mov_b32 v28, 0
    v_mov_b32 v29, 0
    v_mov_b32 v30, 0
    v_mov_b32 v31, 0
    v_mov_b32 v32, 0
    v_mov_b32 v33, 0
    v_mov_b32 v34, 0
    v_mov_b32 v35, 0
    v_mov_b32 v36, 0
    v_mov_b32 v37, 0
    v_mov_b32 v38, 0
    v_mov_b32 v39, 0
    v_mov_b32 v40, 0
    v_mov_b32 v41, 0
    v_mov_b32 v42, 0
    v_mov_b32 v43, 0
    v_mov_b32 v44, 0
    v_mov_b32 v45, 0
    v_mov_b32 v46, 0
    v_mov_b32 v47, 0
    v_subrev_u32 v145, 96, v145
    s_lshl_b32 s28, s4, 13
    s_add_u32 s28, s28, 0x2828000
    v_lshlrev_b32 v5, 7, v1
    v_add_u32 v5, s28, v5
    s_mov_b32 s29, 0
L_pl7:
    global_load_dword v6, v5, s[8:9] sc1
    s_add_u32 s29, s29, 1
    s_waitcnt vmcnt(0)
    v_cmp_ne_u32 vcc, s86, v6
    s_cmp_gt_u32 s29, 400000
    s_cbranch_scc1 L_pl7_x
    s_cbranch_vccz L_pl7_x
    s_sleep 8
    s_branch L_pl7
L_pl7_x:
    s_barrier
    s_add_u32 s28, s8, 0x2000000
    s_addc_u32 s29, s9, 0
    s_mov_b32 s20, s28
    s_and_b32 s21, s29, 0xffff
    s_mov_b32 s22, 0x240000
    s_mov_b32 s23, 0x00020000
    s_lshl_b32 s30, s4, 6
    s_add_u32 s30, s30, 0
    v_add_u32 v5, s30, v1
    v_mul_u32_u24 v7, 43691, v5
    v_lshrrev_b32 v7, 18, v7
    v_mul_u32_u24 v8, 6, v7
    v_sub_u32 v8, v5, v8
    v_min_u32 v8, 3, v8
    v_lshl_add_u32 v8, v7, 2, v8
    v_lshlrev_b32 v5, 4, v8
    s_lshl_b32 s30, s4, 6
    s_add_u32 s30, s30, 256
    v_add_u32 v6, s30, v1
    v_mul_u32_u24 v7, 43691, v6
    v_lshrrev_b32 v7, 18, v7
    v_mul_u32_u24 v8, 6, v7
    v_sub_u32 v8, v6, v8
    v_min_u32 v8, 3, v8
    v_lshl_add_u32 v8, v7, 2, v8
    v_lshlrev_b32 v6, 4, v8
    s_lshl_b32 s31, s80, 12
    s_lshl_b32 s32, s4, 10
    s_add_u32 s32, s32, 125344
    s_add_u32 m0, s32, 0
    s_nop 0
    buffer_load_dwordx4 v5, s[20:23], s31 offen sc1 lds
    s_add_u32 s31, s31, 4096
    s_add_u32 m0, s32, 7680
    s_nop 0
    buffer_load_dwordx4 v5, s[20:23], s31 offen sc1 lds
    s_add_u32 s31, s31, 4096
    s_add_u32 m0, s32, 15360
    s_nop 0
    buffer_load_dwordx4 v5, s[20:23], s31 offen sc1 lds
    s_cmp_ge_u32 s4, 2
    s_cbranch_scc1 L_cvu_no2
    s_lshl_b32 s31, s80, 12
    s_add_u32 m0, s32, 4096
    s_nop 0
    buffer_load_dwordx4 v6, s[20:23], s31 offen sc1 lds
    s_add_u32 s31, s31, 4096
    s_add_u32 m0, s32, 11776
    s_nop 0
    buffer_load_dwordx4 v6, s[20:23], s31 offen sc1 lds
    s_add_u32 s31, s31, 4096
    s_add_u32 m0, s32, 19456
    s_nop 0
    buffer_load_dwordx4 v6, s[20:23], s31 offen sc1 lds
L_cvu_no2:
    s_waitcnt vmcnt(0) lgkmcnt(0)
    s_barrier
interleave_layers__grouped_kv_mqa__ssm_conv_h3__prompt_kernel_nofb:
    s_lshl_b32 s28, s4, 13
    s_add_u32 s28, s28, 0x2800000
    v_lshlrev_b32 v251, 7, v1
    v_add_u32 v251, s28, v251
    global_load_dword v250, v251, s[8:9] sc1
    s_add_u32 s42, s8, 0x200000
    s_addc_u32 s43, s9, 0
    s_cmp_eq_u32 s87, 0
    s_cbranch_scc1 interleave_layers__grouped_kv_mqa__ssm_conv_h3__prompt_kernel_cv_h1
    ds_read_b128 v[80:83], v145 offset:1536
    ds_read_b128 v[84:87], v145 offset:3072
    ds_read_b128 v[88:91], v145 offset:4608
    ds_read_b128 v[92:95], v145 offset:6144
    ds_read_b128 v[48:51], v144 offset:0
    ds_read_b128 v[52:55], v144 offset:32
    ds_read_b128 v[56:59], v144 offset:1024
    ds_read_b128 v[60:63], v144 offset:1056
    ds_read_b128 v[64:67], v144 offset:2048
    ds_read_b128 v[68:71], v144 offset:2080
    ds_read_b128 v[72:75], v144 offset:3072
    ds_read_b128 v[76:79], v144 offset:3104
    s_mov_b32 s79, 3
interleave_layers__grouped_kv_mqa__ssm_conv_h3__prompt_kernel_cv_loopa:
    s_waitcnt lgkmcnt(0)
    v_mfma_f32_16x16x32_bf16 v[16:19], v[48:51], v[80:83], v[16:19]
    ds_read_b128 v[128:131], v145 offset:1440
    v_mfma_f32_16x16x32_bf16 v[20:23], v[52:55], v[80:83], v[20:23]
    ds_read_b128 v[132:135], v145 offset:2976
    v_mfma_f32_16x16x32_bf16 v[24:27], v[48:51], v[84:87], v[24:27]
    ds_read_b128 v[136:139], v145 offset:4512
    v_mfma_f32_16x16x32_bf16 v[28:31], v[52:55], v[84:87], v[28:31]
    ds_read_b128 v[140:143], v145 offset:6048
    v_mfma_f32_16x16x32_bf16 v[32:35], v[48:51], v[88:91], v[32:35]
    ds_read_b128 v[96:99], v144 offset:64
    v_mfma_f32_16x16x32_bf16 v[36:39], v[52:55], v[88:91], v[36:39]
    ds_read_b128 v[100:103], v144 offset:96
    v_mfma_f32_16x16x32_bf16 v[40:43], v[48:51], v[92:95], v[40:43]
    ds_read_b128 v[104:107], v144 offset:1088
    v_mfma_f32_16x16x32_bf16 v[44:47], v[52:55], v[92:95], v[44:47]
    ds_read_b128 v[108:111], v144 offset:1120
    v_mfma_f32_16x16x32_bf16 v[24:27], v[56:59], v[80:83], v[24:27]
    ds_read_b128 v[112:115], v144 offset:2112
    v_mfma_f32_16x16x32_bf16 v[28:31], v[60:63], v[80:83], v[28:31]
    ds_read_b128 v[116:119], v144 offset:2144
    v_mfma_f32_16x16x32_bf16 v[32:35], v[56:59], v[84:87], v[32:35]
    ds_read_b128 v[120:123], v144 offset:3136
    v_mfma_f32_16x16x32_bf16 v[36:39], v[60:63], v[84:87], v[36:39]
    ds_read_b128 v[124:127], v144 offset:3168
    v_mfma_f32_16x16x32_bf16 v[40:43], v[56:59], v[88:91], v[40:43]
    v_mfma_f32_16x16x32_bf16 v[44:47], v[60:63], v[88:91], v[44:47]
    v_mfma_f32_16x16x32_bf16 v[32:35], v[64:67], v[80:83], v[32:35]
    v_mfma_f32_16x16x32_bf16 v[36:39], v[68:71], v[80:83], v[36:39]
    v_mfma_f32_16x16x32_bf16 v[40:43], v[64:67], v[84:87], v[40:43]
    v_mfma_f32_16x16x32_bf16 v[44:47], v[68:71], v[84:87], v[44:47]
    v_mfma_f32_16x16x32_bf16 v[40:43], v[72:75], v[80:83], v[40:43]
    v_mfma_f32_16x16x32_bf16 v[44:47], v[76:79], v[80:83], v[44:47]
    s_waitcnt lgkmcnt(0)
    v_add_u32 v144, 128, v144
    v_subrev_u32 v145, 192, v145
    v_mfma_f32_16x16x32_bf16 v[16:19], v[96:99], v[128:131], v[16:19]
    ds_read_b128 v[80:83], v145 offset:1536
    v_mfma_f32_16x16x32_bf16 v[20:23], v[100:103], v[128:131], v[20:23]
    ds_read_b128 v[84:87], v145 offset:3072
    v_mfma_f32_16x16x32_bf16 v[24:27], v[96:99], v[132:135], v[24:27]
    ds_read_b128 v[88:91], v145 offset:4608
    v_mfma_f32_16x16x32_bf16 v[28:31], v[100:103], v[132:135], v[28:31]
    ds_read_b128 v[92:95], v145 offset:6144
    v_mfma_f32_16x16x32_bf16 v[32:35], v[96:99], v[136:139], v[32:35]
    ds_read_b128 v[48:51], v144 offset:0
    v_mfma_f32_16x16x32_bf16 v[36:39], v[100:103], v[136:139], v[36:39]
    ds_read_b128 v[52:55], v144 offset:32
    v_mfma_f32_16x16x32_bf16 v[40:43], v[96:99], v[140:143], v[40:43]
    ds_read_b128 v[56:59], v144 offset:1024
    v_mfma_f32_16x16x32_bf16 v[44:47], v[100:103], v[140:143], v[44:47]
    ds_read_b128 v[60:63], v144 offset:1056
    v_mfma_f32_16x16x32_bf16 v[24:27], v[104:107], v[128:131], v[24:27]
    ds_read_b128 v[64:67], v144 offset:2048
    v_mfma_f32_16x16x32_bf16 v[28:31], v[108:111], v[128:131], v[28:31]
    ds_read_b128 v[68:71], v144 offset:2080
    v_mfma_f32_16x16x32_bf16 v[32:35], v[104:107], v[132:135], v[32:35]
    ds_read_b128 v[72:75], v144 offset:3072
    v_mfma_f32_16x16x32_bf16 v[36:39], v[108:111], v[132:135], v[36:39]
    ds_read_b128 v[76:79], v144 offset:3104
    v_mfma_f32_16x16x32_bf16 v[40:43], v[104:107], v[136:139], v[40:43]
    v_mfma_f32_16x16x32_bf16 v[44:47], v[108:111], v[136:139], v[44:47]
    v_mfma_f32_16x16x32_bf16 v[32:35], v[112:115], v[128:131], v[32:35]
    v_mfma_f32_16x16x32_bf16 v[36:39], v[116:119], v[128:131], v[36:39]
    v_mfma_f32_16x16x32_bf16 v[40:43], v[112:115], v[132:135], v[40:43]
    v_mfma_f32_16x16x32_bf16 v[44:47], v[116:119], v[132:135], v[44:47]
    v_mfma_f32_16x16x32_bf16 v[40:43], v[120:123], v[128:131], v[40:43]
    v_mfma_f32_16x16x32_bf16 v[44:47], v[124:127], v[128:131], v[44:47]
    s_sub_u32 s79, s79, 1
    s_cmp_lg_u32 s79, 0
    s_cbranch_scc1 interleave_layers__grouped_kv_mqa__ssm_conv_h3__prompt_kernel_cv_loopa
interleave_layers__grouped_kv_mqa__ssm_conv_h3__prompt_kernel_cv_h1:
    s_waitcnt vmcnt(0)
    v_cmp_ne_u32 vcc, s86, v250
    s_nop 0
    s_cbranch_vccz L_lk8
    s_mov_b32 s29, 0
L_pl9:
    global_load_dword v6, v251, s[8:9] sc1
    s_add_u32 s29, s29, 1
    s_waitcnt vmcnt(0)
    v_cmp_ne_u32 vcc, s86, v6
    s_cmp_gt_u32 s29, 400000
    s_cbranch_scc1 L_pl9_x
    s_cbranch_vccz L_pl9_x
    s_sleep 3
    s_branch L_pl9
L_pl9_x:
L_lk8:
    s_barrier
    s_or_b32 s28, s2, s4
    s_cmp_lg_u32 s28, 0
    s_cbranch_scc1 L_ep10
    v_mov_b32 v5, 0x27f0000
    v_mov_b32 v6, s86
    s_mov_b64 exec, 1
    global_store_dword v5, v6, s[8:9] sc1
    s_mov_b64 exec, -1
L_ep10:
    s_add_u32 s40, s8, 0x160000
    s_addc_u32 s41, s9, 0
    s_cmp_eq_u32 s87, 0
    s_cbranch_scc0 L_nb11
    global_load_dwordx4 a[0:3], v244, s[40:41] offset:-4096 sc1
    global_load_dwordx2 a[64:65], v245, s[40:41] offset:0 sc1
    global_load_dwordx4 a[80:83], v246, s[40:41] offset:-4096 sc1
    global_load_dwordx4 a[84:87], v246, s[40:41] offset:-3072 sc1
    global_load_dwordx4 a[4:7], v244, s[40:41] offset:-3072 sc1
    global_load_dwordx4 a[88:91], v246, s[40:41] offset:-2048 sc1
    global_load_dwordx4 a[92:95], v246, s[40:41] offset:-1024 sc1
    global_load_dwordx4 a[8:11], v244, s[40:41] offset:-2048 sc1
    global_load_dwordx2 a[66:67], v245, s[40:41] offset:512 sc1
    global_load_dwordx4 a[96:99], v246, s[40:41] offset:0 sc1
    global_load_dwordx4 a[100:103], v246, s[40:41] offset:1024 sc1
    global_load_dwordx4 a[12:15], v244, s[40:41] offset:-1024 sc1
    global_load_dwordx4 a[104:107], v246, s[40:41] offset:2048 sc1
    global_load_dwordx4 a[108:111], v246, s[40:41] offset:3072 sc1
    global_load_dwordx4 v[148:151], v232, s[8:9] offset:-4096 sc1
    global_load_dwordx4 v[152:155], v232, s[8:9] offset:-3072 sc1
    global_load_dwordx4 v[156:159], v232, s[8:9] offset:-2048 sc1
    global_load_dwordx4 v[160:163], v232, s[8:9] offset:-1024 sc1
    global_load_dwordx4 v[164:167], v232, s[8:9] offset:0 sc1
    global_load_dwordx4 v[168:171], v232, s[8:9] offset:1024 sc1
    global_load_dwordx4 v[172:175], v232, s[8:9] offset:2048 sc1
    global_load_dwordx4 v[176:179], v232, s[8:9] offset:3072 sc1
    v_add_u32 v232, 8192, v232
    global_load_dwordx4 v[180:183], v232, s[8:9] offset:-4096 sc1
    global_load_dwordx4 v[184:187], v232, s[8:9] offset:-3072 sc1
    global_load_dwordx4 v[188:191], v232, s[8:9] offset:-2048 sc1
    global_load_dwordx4 v[192:195], v232, s[8:9] offset:-1024 sc1
    global_load_dwordx4 v[196:199], v232, s[8:9] offset:0 sc1
    global_load_dwordx4 v[200:203], v232, s[8:9] offset:1024 sc1
    global_load_dwordx4 v[204:207], v232, s[8:9] offset:2048 sc1
    global_load_dwordx4 v[208:211], v232, s[8:9] offset:3072 sc1
    v_add_u32 v232, 8192, v232
    global_load_dwordx4 v[212:215], v232, s[8:9] offset:-4096 sc1
    global_load_dwordx4 v[216:219], v232, s[8:9] offset:-3072 sc1
    v_add_u32 v232, 57344, v232
L_nb11:
    s_cmp_lg_u32 s4, 3
    s_cbranch_scc1 interleave_layers__grouped_kv_mqa__ssm_conv_h3__prompt_kernel_ql1_nol
    s_mul_i32 s28, s6, 331776
    s_mov_b32 s29, 0
    s_mul_i32 s30, s29, 18432
    s_add_u32 s28, s28, s30
    s_add_u32 s28, s28, 0x49000
    v_add_u32 v5, s28, v4
    global_load_dwordx4 v[16:19], v5, s[8:9] offset:-4096 sc1
    global_load_dwordx4 v[20:23], v5, s[8:9] offset:-3072 sc1
    global_load_dwordx4 v[24:27], v5, s[8:9] offset:-2048 sc1
    global_load_dwordx4 v[28:31], v5, s[8:9] offset:-1024 sc1
    global_load_dwordx4 v[32:35], v5, s[8:9] offset:0 sc1
    global_load_dwordx4 v[36:39], v5, s[8:9] offset:1024 sc1
    global_load_dwordx4 v[40:43], v5, s[8:9] offset:2048 sc1
    global_load_dwordx4 v[44:47], v5, s[8:9] offset:3072 sc1
    v_add_u32 v5, 8192, v5
    s_waitcnt lgkmcnt(7)
    global_load_dwordx4 v[48:51], v5, s[8:9] offset:-4096 sc1
    s_waitcnt lgkmcnt(6)
    global_load_dwordx4 v[52:55], v5, s[8:9] offset:-3072 sc1
    s_waitcnt lgkmcnt(5)
    global_load_dwordx4 v[56:59], v5, s[8:9] offset:-2048 sc1
    s_waitcnt lgkmcnt(4)
    global_load_dwordx4 v[60:63], v5, s[8:9] offset:-1024 sc1
    s_waitcnt lgkmcnt(3)
    global_load_dwordx4 v[64:67], v5, s[8:9] offset:0 sc1
    s_waitcnt lgkmcnt(2)
    global_load_dwordx4 v[68:71], v5, s[8:9] offset:1024 sc1
    s_waitcnt lgkmcnt(1)
    global_load_dwordx4 v[72:75], v5, s[8:9] offset:2048 sc1
    s_waitcnt lgkmcnt(0)
    global_load_dwordx4 v[76:79], v5, s[8:9] offset:3072 sc1
    v_add_u32 v5, 8192, v5
    global_load_dwordx4 v[80:83], v5, s[8:9] offset:-4096 sc1
    global_load_dwordx4 v[84:87], v5, s[8:9] offset:-3072 sc1
    ds_read_b128 v[220:223], v4 offset:1024
    ds_read_b128 v[224:227], v4 offset:2048
    ds_read_b128 v[228:231], v4 offset:3072
    s_waitcnt vmcnt(17) lgkmcnt(2)
    v_mfma_f32_16x16x32_bf16 v[88:91], v[16:19], v[220:223], 0
    ds_read_b128 v[220:223], v4 offset:4096
    s_waitcnt vmcnt(16) lgkmcnt(2)
    v_mfma_f32_16x16x32_bf16 v[88:91], v[20:23], v[224:227], v[88:91]
    ds_read_b128 v[224:227], v4 offset:5120
    s_waitcnt vmcnt(15) lgkmcnt(2)
    v_mfma_f32_16x16x32_bf16 v[88:91], v[24:27], v[228:231], v[88:91]
    ds_read_b128 v[228:231], v4 offset:6144
    s_waitcnt vmcnt(14) lgkmcnt(2)
    v_mfma_f32_16x16x32_bf16 v[88:91], v[28:31], v[220:223], v[88:91]
    ds_read_b128 v[220:223], v4 offset:7168
    s_waitcnt vmcnt(13) lgkmcnt(2)
    v_mfma_f32_16x16x32_bf16 v[88:91], v[32:35], v[224:227], v[88:91]
    ds_read_b128 v[224:227], v4 offset:8192
    s_waitcnt vmcnt(12) lgkmcnt(2)
    v_mfma_f32_16x16x32_bf16 v[88:91], v[36:39], v[228:231], v[88:91]
    ds_read_b128 v[228:231], v4 offset:9216
    s_waitcnt vmcnt(11) lgkmcnt(2)
    v_mfma_f32_16x16x32_bf16 v[88:91], v[40:43], v[220:223], v[88:91]
    ds_read_b128 v[220:223], v4 offset:10240
    s_waitcnt vmcnt(10) lgkmcnt(2)
    v_mfma_f32_16x16x32_bf16 v[88:91], v[44:47], v[224:227], v[88:91]
    ds_read_b128 v[224:227], v4 offset:11264
    s_waitcnt vmcnt(9) lgkmcnt(2)
    v_mfma_f32_16x16x32_bf16 v[88:91], v[48:51], v[228:231], v[88:91]
    ds_read_b128 v[228:231], v4 offset:12288
    s_waitcnt vmcnt(8) lgkmcnt(2)
    v_mfma_f32_16x16x32_bf16 v[88:91], v[52:55], v[220:223], v[88:91]
    ds_read_b128 v[220:223], v4 offset:13312
    s_waitcnt vmcnt(7) lgkmcnt(2)
    v_mfma_f32_16x16x32_bf16 v[88:91], v[56:59], v[224:227], v[88:91]
    ds_read_b128 v[224:227], v4 offset:14336
    s_waitcnt vmcnt(6) lgkmcnt(2)
    v_mfma_f32_16x16x32_bf16 v[88:91], v[60:63], v[228:231], v[88:91]
    ds_read_b128 v[228:231], v4 offset:15360
    s_waitcnt vmcnt(5) lgkmcnt(2)
    v_mfma_f32_16x16x32_bf16 v[88:91], v[64:67], v[220:223], v[88:91]
    ds_read_b128 v[220:223], v4 offset:16384
    s_waitcnt vmcnt(4) lgkmcnt(2)
    v_mfma_f32_16x16x32_bf16 v[88:91], v[68:71], v[224:227], v[88:91]
    ds_read_b128 v[224:227], v4 offset:17408
    s_waitcnt vmcnt(3) lgkmcnt(2)
    v_mfma_f32_16x16x32_bf16 v[88:91], v[72:75], v[228:231], v[88:91]
    ds_read_b128 v[228:231], v4 offset:18432
    s_waitcnt vmcnt(2) lgkmcnt(2)
    v_mfma_f32_16x16x32_bf16 v[88:91], v[76:79], v[220:223], v[88:91]
    s_waitcnt vmcnt(1) lgkmcnt(1)
    v_mfma_f32_16x16x32_bf16 v[88:91], v[80:83], v[224:227], v[88:91]
    s_waitcnt vmcnt(0) lgkmcnt(0)
    v_mfma_f32_16x16x32_bf16 v[88:91], v[84:87], v[228:231], v[88:91]
    s_nop 7
    v_cvt_pk_bf16_f32 v92, v88, v89
    v_cvt_pk_bf16_f32 v93, v90, v91
    s_lshl_b32 s29, s29, 9
    s_add_u32 s29, s29, 149248
    v_lshlrev_b32 v5, 2, v1
    v_add_u32 v5, s29, v5
    ds_write_b32 v5, v92
    ds_write_b32 v5, v93 offset:256
    s_mul_i32 s28, s6, 331776
    s_mov_b32 s29, 1
    s_mul_i32 s30, s29, 18432
    s_add_u32 s28, s28, s30
    s_add_u32 s28, s28, 0x49000
    v_add_u32 v5, s28, v4
    global_load_dwordx4 v[16:19], v5, s[8:9] offset:-4096 sc1
    global_load_dwordx4 v[20:23], v5, s[8:9] offset:-3072 sc1
    global_load_dwordx4 v[24:27], v5, s[8:9] offset:-2048 sc1
    global_load_dwordx4 v[28:31], v5, s[8:9] offset:-1024 sc1
    global_load_dwordx4 v[32:35], v5, s[8:9] offset:0 sc1
    global_load_dwordx4 v[36:39], v5, s[8:9] offset:1024 sc1
    global_load_dwordx4 v[40:43], v5, s[8:9] offset:2048 sc1
    global_load_dwordx4 v[44:47], v5, s[8:9] offset:3072 sc1
    v_add_u32 v5, 8192, v5
    global_load_dwordx4 v[48:51], v5, s[8:9] offset:-4096 sc1
    global_load_dwordx4 v[52:55], v5, s[8:9] offset:-3072 sc1
    global_load_dwordx4 v[56:59], v5, s[8:9] offset:-2048 sc1
    global_load_dwordx4 v[60:63], v5, s[8:9] offset:-1024 sc1
    global_load_dwordx4 v[64:67], v5, s[8:9] offset:0 sc1
    global_load_dwordx4 v[68:71], v5, s[8:9] offset:1024 sc1
    global_load_dwordx4 v[72:75], v5, s[8:9] offset:2048 sc1
    global_load_dwordx4 v[76:79], v5, s[8:9] offset:3072 sc1
    v_add_u32 v5, 8192, v5
    global_load_dwordx4 v[80:83], v5, s[8:9] offset:-4096 sc1
    global_load_dwordx4 v[84:87], v5, s[8:9] offset:-3072 sc1
    ds_read_b128 v[220:223], v4 offset:1024
    ds_read_b128 v[224:227], v4 offset:2048
    ds_read_b128 v[228:231], v4 offset:3072
    s_waitcnt vmcnt(17) lgkmcnt(2)
    v_mfma_f32_16x16x32_bf16 v[88:91], v[16:19], v[220:223], 0
    ds_read_b128 v[220:223], v4 offset:4096
    s_waitcnt vmcnt(16) lgkmcnt(2)
    v_mfma_f32_16x16x32_bf16 v[88:91], v[20:23], v[224:227], v[88:91]
    ds_read_b128 v[224:227], v4 offset:5120
    s_waitcnt vmcnt(15) lgkmcnt(2)
    v_mfma_f32_16x16x32_bf16 v[88:91], v[24:27], v[228:231], v[88:91]
    ds_read_b128 v[228:231], v4 offset:6144
    s_waitcnt vmcnt(14) lgkmcnt(2)
    v_mfma_f32_16x16x32_bf16 v[88:91], v[28:31], v[220:223], v[88:91]
    ds_read_b128 v[220:223], v4 offset:7168
    s_waitcnt vmcnt(13) lgkmcnt(2)
    v_mfma_f32_16x16x32_bf16 v[88:91], v[32:35], v[224:227], v[88:91]
    ds_read_b128 v[224:227], v4 offset:8192
    s_waitcnt vmcnt(12) lgkmcnt(2)
    v_mfma_f32_16x16x32_bf16 v[88:91], v[36:39], v[228:231], v[88:91]
    ds_read_b128 v[228:231], v4 offset:9216
    s_waitcnt vmcnt(11) lgkmcnt(2)
    v_mfma_f32_16x16x32_bf16 v[88:91], v[40:43], v[220:223], v[88:91]
    ds_read_b128 v[220:223], v4 offset:10240
    s_waitcnt vmcnt(10) lgkmcnt(2)
    v_mfma_f32_16x16x32_bf16 v[88:91], v[44:47], v[224:227], v[88:91]
    ds_read_b128 v[224:227], v4 offset:11264
    s_waitcnt vmcnt(9) lgkmcnt(2)
    v_mfma_f32_16x16x32_bf16 v[88:91], v[48:51], v[228:231], v[88:91]
    ds_read_b128 v[228:231], v4 offset:12288
    s_waitcnt vmcnt(8) lgkmcnt(2)
    v_mfma_f32_16x16x32_bf16 v[88:91], v[52:55], v[220:223], v[88:91]
    ds_read_b128 v[220:223], v4 offset:13312
    s_waitcnt vmcnt(7) lgkmcnt(2)
    v_mfma_f32_16x16x32_bf16 v[88:91], v[56:59], v[224:227], v[88:91]
    ds_read_b128 v[224:227], v4 offset:14336
    s_waitcnt vmcnt(6) lgkmcnt(2)
    v_mfma_f32_16x16x32_bf16 v[88:91], v[60:63], v[228:231], v[88:91]
    ds_read_b128 v[228:231], v4 offset:15360
    s_waitcnt vmcnt(5) lgkmcnt(2)
    v_mfma_f32_16x16x32_bf16 v[88:91], v[64:67], v[220:223], v[88:91]
    ds_read_b128 v[220:223], v4 offset:16384
    s_waitcnt vmcnt(4) lgkmcnt(2)
    v_mfma_f32_16x16x32_bf16 v[88:91], v[68:71], v[224:227], v[88:91]
    ds_read_b128 v[224:227], v4 offset:17408
    s_waitcnt vmcnt(3) lgkmcnt(2)
    v_mfma_f32_16x16x32_bf16 v[88:91], v[72:75], v[228:231], v[88:91]
    ds_read_b128 v[228:231], v4 offset:18432
    s_waitcnt vmcnt(2) lgkmcnt(2)
    v_mfma_f32_16x16x32_bf16 v[88:91], v[76:79], v[220:223], v[88:91]
    s_waitcnt vmcnt(1) lgkmcnt(1)
    v_mfma_f32_16x16x32_bf16 v[88:91], v[80:83], v[224:227], v[88:91]
    s_waitcnt vmcnt(0) lgkmcnt(0)
    v_mfma_f32_16x16x32_bf16 v[88:91], v[84:87], v[228:231], v[88:91]
    s_nop 7
    v_cvt_pk_bf16_f32 v92, v88, v89
    v_cvt_pk_bf16_f32 v93, v90, v91
    s_lshl_b32 s29, s29, 9
    s_add_u32 s29, s29, 149248
    v_lshlrev_b32 v5, 2, v1
    v_add_u32 v5, s29, v5
    ds_write_b32 v5, v92
    ds_write_b32 v5, v93 offset:256
interleave_layers__grouped_kv_mqa__ssm_conv_h3__prompt_kernel_ql1_nol:
    s_cmp_eq_u32 s87, 0
    s_cbranch_scc1 interleave_layers__grouped_kv_mqa__ssm_conv_h3__prompt_kernel_cv_end
    s_waitcnt lgkmcnt(0)
    v_mfma_f32_16x16x32_bf16 v[16:19], v[48:51], v[80:83], v[16:19]
    ds_read_b128 v[128:131], v145 offset:1440
    v_mfma_f32_16x16x32_bf16 v[20:23], v[52:55], v[80:83], v[20:23]
    ds_read_b128 v[132:135], v145 offset:2976
    v_mfma_f32_16x16x32_bf16 v[24:27], v[48:51], v[84:87], v[24:27]
    s_waitcnt vmcnt(31)
    global_load_dwordx4 a[0:3], v244, s[40:41] offset:-4096 sc1
    ds_read_b128 v[136:139], v145 offset:4512
    v_mfma_f32_16x16x32_bf16 v[28:31], v[52:55], v[84:87], v[28:31]
    ds_read_b128 v[140:143], v145 offset:6048
    v_mfma_f32_16x16x32_bf16 v[32:35], v[48:51], v[88:91], v[32:35]
    ds_read_b128 v[96:99], v144 offset:64
    v_mfma_f32_16x16x32_bf16 v[36:39], v[52:55], v[88:91], v[36:39]
    ds_read_b128 v[100:103], v144 offset:96
    v_mfma_f32_16x16x32_bf16 v[40:43], v[48:51], v[92:95], v[40:43]
    ds_read_b128 v[104:107], v144 offset:1088
    s_waitcnt vmcnt(31)
    global_load_dwordx2 a[64:65], v245, s[40:41] offset:0 sc1
    v_mfma_f32_16x16x32_bf16 v[44:47], v[52:55], v[92:95], v[44:47]
    ds_read_b128 v[108:111], v144 offset:1120
    v_mfma_f32_16x16x32_bf16 v[24:27], v[56:59], v[80:83], v[24:27]
    ds_read_b128 v[112:115], v144 offset:2112
    v_mfma_f32_16x16x32_bf16 v[28:31], v[60:63], v[80:83], v[28:31]
    ds_read_b128 v[116:119], v144 offset:2144
    v_mfma_f32_16x16x32_bf16 v[32:35], v[56:59], v[84:87], v[32:35]
    ds_read_b128 v[120:123], v144 offset:3136
    v_mfma_f32_16x16x32_bf16 v[36:39], v[60:63], v[84:87], v[36:39]
    s_waitcnt vmcnt(31)
    global_load_dwordx4 a[80:83], v246, s[40:41] offset:-4096 sc1
    ds_read_b128 v[124:127], v144 offset:3168
    v_mfma_f32_16x16x32_bf16 v[40:43], v[56:59], v[88:91], v[40:43]
    v_mfma_f32_16x16x32_bf16 v[44:47], v[60:63], v[88:91], v[44:47]
    v_mfma_f32_16x16x32_bf16 v[32:35], v[64:67], v[80:83], v[32:35]
    v_mfma_f32_16x16x32_bf16 v[36:39], v[68:71], v[80:83], v[36:39]
    v_mfma_f32_16x16x32_bf16 v[40:43], v[64:67], v[84:87], v[40:43]
    v_mfma_f32_16x16x32_bf16 v[44:47], v[68:71], v[84:87], v[44:47]
    v_mfma_f32_16x16x32_bf16 v[40:43], v[72:75], v[80:83], v[40:43]
    v_mfma_f32_16x16x32_bf16 v[44:47], v[76:79], v[80:83], v[44:47]
    s_waitcnt vmcnt(31)
    global_load_dwordx4 a[84:87], v246, s[40:41] offset:-3072 sc1
    s_waitcnt lgkmcnt(0)
    v_add_u32 v144, 128, v144
    v_subrev_u32 v145, 192, v145
    v_mfma_f32_16x16x32_bf16 v[16:19], v[96:99], v[128:131], v[16:19]
    ds_read_b128 v[80:83], v145 offset:1536
    v_mfma_f32_16x16x32_bf16 v[20:23], v[100:103], v[128:131], v[20:23]
    ds_read_b128 v[84:87], v145 offset:3072
    v_mfma_f32_16x16x32_bf16 v[24:27], v[96:99], v[132:135], v[24:27]
    ds_read_b128 v[88:91], v145 offset:4608
    v_mfma_f32_16x16x32_bf16 v[28:31], v[100:103], v[132:135], v[28:31]
    s_waitcnt vmcnt(31)
    global_load_dwordx4 a[4:7], v244, s[40:41] offset:-3072 sc1
    ds_read_b128 v[92:95], v145 offset:6144
    v_mfma_f32_16x16x32_bf16 v[32:35], v[96:99], v[136:139], v[32:35]
    ds_read_b128 v[48:51], v144 offset:0
    v_mfma_f32_16x16x32_bf16 v[36:39], v[100:103], v[136:139], v[36:39]
    ds_read_b128 v[52:55], v144 offset:32
    v_mfma_f32_16x16x32_bf16 v[40:43], v[96:99], v[140:143], v[40:43]
    ds_read_b128 v[56:59], v144 offset:1024
    v_mfma_f32_16x16x32_bf16 v[44:47], v[100:103], v[140:143], v[44:47]
    ds_read_b128 v[60:63], v144 offset:1056
    s_waitcnt vmcnt(31)
    global_load_dwordx4 a[88:91], v246, s[40:41] offset:-2048 sc1
    v_mfma_f32_16x16x32_bf16 v[24:27], v[104:107], v[128:131], v[24:27]
    ds_read_b128 v[64:67], v144 offset:2048
    v_mfma_f32_16x16x32_bf16 v[28:31], v[108:111], v[128:131], v[28:31]
    ds_read_b128 v[68:71], v144 offset:2080
    v_mfma_f32_16x16x32_bf16 v[32:35], v[104:107], v[132:135], v[32:35]
    ds_read_b128 v[72:75], v144 offset:3072
    v_mfma_f32_16x16x32_bf16 v[36:39], v[108:111], v[132:135], v[36:39]
    ds_read_b128 v[76:79], v144 offset:3104
    v_mfma_f32_16x16x32_bf16 v[40:43], v[104:107], v[136:139], v[40:43]
    s_waitcnt vmcnt(31)
    global_load_dwordx4 a[92:95], v246, s[40:41] offset:-1024 sc1
    v_mfma_f32_16x16x32_bf16 v[44:47], v[108:111], v[136:139], v[44:47]
    v_mfma_f32_16x16x32_bf16 v[32:35], v[112:115], v[128:131], v[32:35]
    v_mfma_f32_16x16x32_bf16 v[36:39], v[116:119], v[128:131], v[36:39]
    v_mfma_f32_16x16x32_bf16 v[40:43], v[112:115], v[132:135], v[40:43]
    v_mfma_f32_16x16x32_bf16 v[44:47], v[116:119], v[132:135], v[44:47]
    v_mfma_f32_16x16x32_bf16 v[40:43], v[120:123], v[128:131], v[40:43]
    v_mfma_f32_16x16x32_bf16 v[44:47], v[124:127], v[128:131], v[44:47]
    s_waitcnt lgkmcnt(0)
    v_mfma_f32_16x16x32_bf16 v[16:19], v[48:51], v[80:83], v[16:19]
    ds_read_b128 v[128:131], v145 offset:1440
    s_waitcnt vmcnt(31)
    global_load_dwordx4 a[8:11], v244, s[40:41] offset:-2048 sc1
    v_mfma_f32_16x16x32_bf16 v[20:23], v[52:55], v[80:83], v[20:23]
    ds_read_b128 v[132:135], v145 offset:2976
    v_mfma_f32_16x16x32_bf16 v[24:27], v[48:51], v[84:87], v[24:27]
    ds_read_b128 v[136:139], v145 offset:4512
    v_mfma_f32_16x16x32_bf16 v[28:31], v[52:55], v[84:87], v[28:31]
    ds_read_b128 v[140:143], v145 offset:6048
    v_mfma_f32_16x16x32_bf16 v[32:35], v[48:51], v[88:91], v[32:35]
    ds_read_b128 v[96:99], v144 offset:64
    v_mfma_f32_16x16x32_bf16 v[36:39], v[52:55], v[88:91], v[36:39]
    s_waitcnt vmcnt(31)
    global_load_dwordx2 a[66:67], v245, s[40:41] offset:512 sc1
    ds_read_b128 v[100:103], v144 offset:96
    v_mfma_f32_16x16x32_bf16 v[40:43], v[48:51], v[92:95], v[40:43]
    ds_read_b128 v[104:107], v144 offset:1088
    v_mfma_f32_16x16x32_bf16 v[44:47], v[52:55], v[92:95], v[44:47]
    ds_read_b128 v[108:111], v144 offset:1120
    v_mfma_f32_16x16x32_bf16 v[24:27], v[56:59], v[80:83], v[24:27]
    ds_read_b128 v[112:115], v144 offset:2112
    v_mfma_f32_16x16x32_bf16 v[28:31], v[60:63], v[80:83], v[28:31]
    ds_read_b128 v[116:119], v144 offset:2144
    s_waitcnt vmcnt(31)
    global_load_dwordx4 a[96:99], v246, s[40:41] offset:0 sc1
    v_mfma_f32_16x16x32_bf16 v[32:35], v[56:59], v[84:87], v[32:35]
    ds_read_b128 v[120:123], v144 offset:3136
    v_mfma_f32_16x16x32_bf16 v[36:39], v[60:63], v[84:87], v[36:39]
    ds_read_b128 v[124:127], v144 offset:3168
    v_mfma_f32_16x16x32_bf16 v[40:43], v[56:59], v[88:91], v[40:43]
    v_mfma_f32_16x16x32_bf16 v[44:47], v[60:63], v[88:91], v[44:47]
    v_mfma_f32_16x16x32_bf16 v[32:35], v[64:67], v[80:83], v[32:35]
    v_mfma_f32_16x16x32_bf16 v[36:39], v[68:71], v[80:83], v[36:39]
    v_mfma_f32_16x16x32_bf16 v[40:43], v[64:67], v[84:87], v[40:43]
    s_waitcnt vmcnt(31)
    global_load_dwordx4 a[100:103], v246, s[40:41] offset:1024 sc1
    v_mfma_f32_16x16x32_bf16 v[44:47], v[68:71], v[84:87], v[44:47]
    v_mfma_f32_16x16x32_bf16 v[40:43], v[72:75], v[80:83], v[40:43]
    v_mfma_f32_16x16x32_bf16 v[44:47], v[76:79], v[80:83], v[44:47]
    s_waitcnt lgkmcnt(0)
    v_add_u32 v144, 128, v144
    v_subrev_u32 v145, 192, v145
    v_mfma_f32_16x16x32_bf16 v[16:19], v[96:99], v[128:131], v[16:19]
    ds_read_b128 v[80:83], v145 offset:1536
    v_mfma_f32_16x16x32_bf16 v[20:23], v[100:103], v[128:131], v[20:23]
    ds_read_b128 v[84:87], v145 offset:3072
    s_waitcnt vmcnt(31)
    global_load_dwordx4 a[12:15], v244, s[40:41] offset:-1024 sc1
    v_mfma_f32_16x16x32_bf16 v[24:27], v[96:99], v[132:135], v[24:27]
    ds_read_b128 v[88:91], v145 offset:4608
    v_mfma_f32_16x16x32_bf16 v[28:31], v[100:103], v[132:135], v[28:31]
    ds_read_b128 v[92:95], v145 offset:6144
    v_mfma_f32_16x16x32_bf16 v[32:35], v[96:99], v[136:139], v[32:35]
    ds_read_b128 v[48:51], v144 offset:0
    v_mfma_f32_16x16x32_bf16 v[36:39], v[100:103], v[136:139], v[36:39]
    ds_read_b128 v[52:55], v144 offset:32
    v_mfma_f32_16x16x32_bf16 v[40:43], v[96:99], v[140:143], v[40:43]
    s_waitcnt vmcnt(31)
    global_load_dwordx4 a[104:107], v246, s[40:41] offset:2048 sc1
    ds_read_b128 v[56:59], v144 offset:1024
    v_mfma_f32_16x16x32_bf16 v[44:47], v[100:103], v[140:143], v[44:47]
    ds_read_b128 v[60:63], v144 offset:1056
    v_mfma_f32_16x16x32_bf16 v[24:27], v[104:107], v[128:131], v[24:27]
    ds_read_b128 v[64:67], v144 offset:2048
    v_mfma_f32_16x16x32_bf16 v[28:31], v[108:111], v[128:131], v[28:31]
    ds_read_b128 v[68:71], v144 offset:2080
    v_mfma_f32_16x16x32_bf16 v[32:35], v[104:107], v[132:135], v[32:35]
    ds_read_b128 v[72:75], v144 offset:3072
    s_waitcnt vmcnt(31)
    global_load_dwordx4 a[108:111], v246, s[40:41] offset:3072 sc1
    v_mfma_f32_16x16x32_bf16 v[36:39], v[108:111], v[132:135], v[36:39]
    ds_read_b128 v[76:79], v144 offset:3104
    v_mfma_f32_16x16x32_bf16 v[40:43], v[104:107], v[136:139], v[40:43]
    v_mfma_f32_16x16x32_bf16 v[44:47], v[108:111], v[136:139], v[44:47]
    v_mfma_f32_16x16x32_bf16 v[32:35], v[112:115], v[128:131], v[32:35]
    v_mfma_f32_16x16x32_bf16 v[36:39], v[116:119], v[128:131], v[36:39]
    v_mfma_f32_16x16x32_bf16 v[40:43], v[112:115], v[132:135], v[40:43]
    v_mfma_f32_16x16x32_bf16 v[44:47], v[116:119], v[132:135], v[44:47]
    v_mfma_f32_16x16x32_bf16 v[40:43], v[120:123], v[128:131], v[40:43]
    s_waitcnt vmcnt(31)
    global_load_dwordx4 v[148:151], v232, s[8:9] offset:-4096 sc1
    v_mfma_f32_16x16x32_bf16 v[44:47], v[124:127], v[128:131], v[44:47]
    s_waitcnt lgkmcnt(0)
    v_mfma_f32_16x16x32_bf16 v[16:19], v[48:51], v[80:83], v[16:19]
    ds_read_b128 v[128:131], v145 offset:1440
    v_mfma_f32_16x16x32_bf16 v[20:23], v[52:55], v[80:83], v[20:23]
    ds_read_b128 v[132:135], v145 offset:2976
    v_mfma_f32_16x16x32_bf16 v[24:27], v[48:51], v[84:87], v[24:27]
    ds_read_b128 v[136:139], v145 offset:4512
    v_mfma_f32_16x16x32_bf16 v[28:31], v[52:55], v[84:87], v[28:31]
    ds_read_b128 v[140:143], v145 offset:6048
    s_waitcnt vmcnt(31)
    global_load_dwordx4 v[152:155], v232, s[8:9] offset:-3072 sc1
    v_mfma_f32_16x16x32_bf16 v[32:35], v[48:51], v[88:91], v[32:35]
    ds_read_b128 v[96:99], v144 offset:64
    v_mfma_f32_16x16x32_bf16 v[36:39], v[52:55], v[88:91], v[36:39]
    ds_read_b128 v[100:103], v144 offset:96
    v_mfma_f32_16x16x32_bf16 v[40:43], v[48:51], v[92:95], v[40:43]
    ds_read_b128 v[104:107], v144 offset:1088
    v_mfma_f32_16x16x32_bf16 v[44:47], v[52:55], v[92:95], v[44:47]
    ds_read_b128 v[108:111], v144 offset:1120
    v_mfma_f32_16x16x32_bf16 v[24:27], v[56:59], v[80:83], v[24:27]
    s_waitcnt vmcnt(31)
    global_load_dwordx4 v[156:159], v232, s[8:9] offset:-2048 sc1
    ds_read_b128 v[112:115], v144 offset:2112
    v_mfma_f32_16x16x32_bf16 v[28:31], v[60:63], v[80:83], v[28:31]
    ds_read_b128 v[116:119], v144 offset:2144
    v_mfma_f32_16x16x32_bf16 v[32:35], v[56:59], v[84:87], v[32:35]
    ds_read_b128 v[120:123], v144 offset:3136
    v_mfma_f32_16x16x32_bf16 v[36:39], v[60:63], v[84:87], v[36:39]
    ds_read_b128 v[124:127], v144 offset:3168
    v_mfma_f32_16x16x32_bf16 v[40:43], v[56:59], v[88:91], v[40:43]
    v_mfma_f32_16x16x32_bf16 v[44:47], v[60:63], v[88:91], v[44:47]
    s_waitcnt vmcnt(31)
    global_load_dwordx4 v[160:163], v232, s[8:9] offset:-1024 sc1
    v_mfma_f32_16x16x32_bf16 v[32:35], v[64:67], v[80:83], v[32:35]
    v_mfma_f32_16x16x32_bf16 v[36:39], v[68:71], v[80:83], v[36:39]
    v_mfma_f32_16x16x32_bf16 v[40:43], v[64:67], v[84:87], v[40:43]
    v_mfma_f32_16x16x32_bf16 v[44:47], v[68:71], v[84:87], v[44:47]
    v_mfma_f32_16x16x32_bf16 v[40:43], v[72:75], v[80:83], v[40:43]
    v_mfma_f32_16x16x32_bf16 v[44:47], v[76:79], v[80:83], v[44:47]
    s_waitcnt lgkmcnt(0)
    v_add_u32 v144, 128, v144
    v_subrev_u32 v145, 192, v145
    v_mfma_f32_16x16x32_bf16 v[16:19], v[96:99], v[128:131], v[16:19]
    s_waitcnt vmcnt(31)
    global_load_dwordx4 v[164:167], v232, s[8:9] offset:0 sc1
    ds_read_b128 v[80:83], v145 offset:1536
    v_mfma_f32_16x16x32_bf16 v[20:23], v[100:103], v[128:131], v[20:23]
    ds_read_b128 v[84:87], v145 offset:3072
    v_mfma_f32_16x16x32_bf16 v[24:27], v[96:99], v[132:135], v[24:27]
    ds_read_b128 v[88:91], v145 offset:4608
    v_mfma_f32_16x16x32_bf16 v[28:31], v[100:103], v[132:135], v[28:31]
    ds_read_b128 v[92:95], v145 offset:6144
    v_mfma_f32_16x16x32_bf16 v[32:35], v[96:99], v[136:139], v[32:35]
    ds_read_b128 v[48:51], v144 offset:0
    s_waitcnt vmcnt(31)
    global_load_dwordx4 v[168:171], v232, s[8:9] offset:1024 sc1
    v_mfma_f32_16x16x32_bf16 v[36:39], v[100:103], v[136:139], v[36:39]
    ds_read_b128 v[52:55], v144 offset:32
    v_mfma_f32_16x16x32_bf16 v[40:43], v[96:99], v[140:143], v[40:43]
    ds_read_b128 v[56:59], v144 offset:1024
    v_mfma_f32_16x16x32_bf16 v[44:47], v[100:103], v[140:143], v[44:47]
    ds_read_b128 v[60:63], v144 offset:1056
    v_mfma_f32_16x16x32_bf16 v[24:27], v[104:107], v[128:131], v[24:27]
    ds_read_b128 v[64:67], v144 offset:2048
    v_mfma_f32_16x16x32_bf16 v[28:31], v[108:111], v[128:131], v[28:31]
    s_waitcnt vmcnt(31)
    global_load_dwordx4 v[172:175], v232, s[8:9] offset:2048 sc1
    ds_read_b128 v[68:71], v144 offset:2080
    v_mfma_f32_16x16x32_bf16 v[32:35], v[104:107], v[132:135], v[32:35]
    ds_read_b128 v[72:75], v144 offset:3072
    v_mfma_f32_16x16x32_bf16 v[36:39], v[108:111], v[132:135], v[36:39]
    ds_read_b128 v[76:79], v144 offset:3104
    v_mfma_f32_16x16x32_bf16 v[40:43], v[104:107], v[136:139], v[40:43]
    v_mfma_f32_16x16x32_bf16 v[44:47], v[108:111], v[136:139], v[44:47]
    v_mfma_f32_16x16x32_bf16 v[32:35], v[112:115], v[128:131], v[32:35]
    v_mfma_f32_16x16x32_bf16 v[36:39], v[116:119], v[128:131], v[36:39]
    s_waitcnt vmcnt(31)
    global_load_dwordx4 v[176:179], v232, s[8:9] offset:3072 sc1
    v_mfma_f32_16x16x32_bf16 v[40:43], v[112:115], v[132:135], v[40:43]
    v_mfma_f32_16x16x32_bf16 v[44:47], v[116:119], v[132:135], v[44:47]
    v_mfma_f32_16x16x32_bf16 v[40:43], v[120:123], v[128:131], v[40:43]
    v_mfma_f32_16x16x32_bf16 v[44:47], v[124:127], v[128:131], v[44:47]
    s_waitcnt lgkmcnt(0)
    v_mfma_f32_16x16x32_bf16 v[16:19], v[48:51], v[80:83], v[16:19]
    ds_read_b128 v[128:131], v145 offset:1440
    v_mfma_f32_16x16x32_bf16 v[20:23], v[52:55], v[80:83], v[20:23]
    ds_read_b128 v[132:135], v145 offset:2976
    v_mfma_f32_16x16x32_bf16 v[24:27], v[48:51], v[84:87], v[24:27]
    v_add_u32 v232, 8192, v232
    ds_read_b128 v[136:139], v145 offset:4512
    v_mfma_f32_16x16x32_bf16 v[28:31], v[52:55], v[84:87], v[28:31]
    ds_read_b128 v[140:143], v145 offset:6048
    v_mfma_f32_16x16x32_bf16 v[32:35], v[48:51], v[88:91], v[32:35]
    ds_read_b128 v[96:99], v144 offset:64
    v_mfma_f32_16x16x32_bf16 v[36:39], v[52:55], v[88:91], v[36:39]
    ds_read_b128 v[100:103], v144 offset:96
    v_mfma_f32_16x16x32_bf16 v[40:43], v[48:51], v[92:95], v[40:43]
    ds_read_b128 v[104:107], v144 offset:1088
    s_waitcnt vmcnt(31)
    global_load_dwordx4 v[180:183], v232, s[8:9] offset:-4096 sc1
    v_mfma_f32_16x16x32_bf16 v[44:47], v[52:55], v[92:95], v[44:47]
    ds_read_b128 v[108:111], v144 offset:1120
    v_mfma_f32_16x16x32_bf16 v[24:27], v[56:59], v[80:83], v[24:27]
    ds_read_b128 v[112:115], v144 offset:2112
    v_mfma_f32_16x16x32_bf16 v[28:31], v[60:63], v[80:83], v[28:31]
    ds_read_b128 v[116:119], v144 offset:2144
    v_mfma_f32_16x16x32_bf16 v[32:35], v[56:59], v[84:87], v[32:35]
    ds_read_b128 v[120:123], v144 offset:3136
    v_mfma_f32_16x16x32_bf16 v[36:39], v[60:63], v[84:87], v[36:39]
    s_waitcnt vmcnt(31)
    global_load_dwordx4 v[184:187], v232, s[8:9] offset:-3072 sc1
    ds_read_b128 v[124:127], v144 offset:3168
    v_mfma_f32_16x16x32_bf16 v[40:43], v[56:59], v[88:91], v[40:43]
    v_mfma_f32_16x16x32_bf16 v[44:47], v[60:63], v[88:91], v[44:47]
    v_mfma_f32_16x16x32_bf16 v[32:35], v[64:67], v[80:83], v[32:35]
    v_mfma_f32_16x16x32_bf16 v[36:39], v[68:71], v[80:83], v[36:39]
    v_mfma_f32_16x16x32_bf16 v[40:43], v[64:67], v[84:87], v[40:43]
    v_mfma_f32_16x16x32_bf16 v[44:47], v[68:71], v[84:87], v[44:47]
    v_mfma_f32_16x16x32_bf16 v[40:43], v[72:75], v[80:83], v[40:43]
    v_mfma_f32_16x16x32_bf16 v[44:47], v[76:79], v[80:83], v[44:47]
    s_waitcnt vmcnt(31)
    global_load_dwordx4 v[188:191], v232, s[8:9] offset:-2048 sc1
    s_waitcnt lgkmcnt(0)
    v_add_u32 v144, 128, v144
    v_subrev_u32 v145, 192, v145
    v_mfma_f32_16x16x32_bf16 v[16:19], v[96:99], v[128:131], v[16:19]
    ds_read_b128 v[80:83], v145 offset:1536
    v_mfma_f32_16x16x32_bf16 v[20:23], v[100:103], v[128:131], v[20:23]
    ds_read_b128 v[84:87], v145 offset:3072
    v_mfma_f32_16x16x32_bf16 v[24:27], v[96:99], v[132:135], v[24:27]
    ds_read_b128 v[88:91], v145 offset:4608
    v_mfma_f32_16x16x32_bf16 v[28:31], v[100:103], v[132:135], v[28:31]
    s_waitcnt vmcnt(31)
    global_load_dwordx4 v[192:195], v232, s[8:9] offset:-1024 sc1
    ds_read_b128 v[92:95], v145 offset:6144
    v_mfma_f32_16x16x32_bf16 v[32:35], v[96:99], v[136:139], v[32:35]
    ds_read_b128 v[48:51], v144 offset:0
    v_mfma_f32_16x16x32_bf16 v[36:39], v[100:103], v[136:139], v[36:39]
    ds_read_b128 v[52:55], v144 offset:32
    v_mfma_f32_16x16x32_bf16 v[40:43], v[96:99], v[140:143], v[40:43]
    ds_read_b128 v[56:59], v144 offset:1024
    v_mfma_f32_16x16x32_bf16 v[44:47], v[100:103], v[140:143], v[44:47]
    ds_read_b128 v[60:63], v144 offset:1056
    s_waitcnt vmcnt(31)
    global_load_dwordx4 v[196:199], v232, s[8:9] offset:0 sc1
    v_mfma_f32_16x16x32_bf16 v[24:27], v[104:107], v[128:131], v[24:27]
    ds_read_b128 v[64:67], v144 offset:2048
    v_mfma_f32_16x16x32_bf16 v[28:31], v[108:111], v[128:131], v[28:31]
    ds_read_b128 v[68:71], v144 offset:2080
    v_mfma_f32_16x16x32_bf16 v[32:35], v[104:107], v[132:135], v[32:35]
    ds_read_b128 v[72:75], v144 offset:3072
    v_mfma_f32_16x16x32_bf16 v[36:39], v[108:111], v[132:135], v[36:39]
    ds_read_b128 v[76:79], v144 offset:3104
    v_mfma_f32_16x16x32_bf16 v[40:43], v[104:107], v[136:139], v[40:43]
    s_waitcnt vmcnt(31)
    global_load_dwordx4 v[200:203], v232, s[8:9] offset:1024 sc1
    v_mfma_f32_16x16x32_bf16 v[44:47], v[108:111], v[136:139], v[44:47]
    v_mfma_f32_16x16x32_bf16 v[32:35], v[112:115], v[128:131], v[32:35]
    v_mfma_f32_16x16x32_bf16 v[36:39], v[116:119], v[128:131], v[36:39]
    v_mfma_f32_16x16x32_bf16 v[40:43], v[112:115], v[132:135], v[40:43]
    v_mfma_f32_16x16x32_bf16 v[44:47], v[116:119], v[132:135], v[44:47]
    v_mfma_f32_16x16x32_bf16 v[40:43], v[120:123], v[128:131], v[40:43]
    v_mfma_f32_16x16x32_bf16 v[44:47], v[124:127], v[128:131], v[44:47]
    s_waitcnt lgkmcnt(0)
    v_mfma_f32_16x16x32_bf16 v[16:19], v[48:51], v[80:83], v[16:19]
    ds_read_b128 v[128:131], v145 offset:1440
    s_waitcnt vmcnt(31)
    global_load_dwordx4 v[204:207], v232, s[8:9] offset:2048 sc1
    v_mfma_f32_16x16x32_bf16 v[20:23], v[52:55], v[80:83], v[20:23]
    ds_read_b128 v[132:135], v145 offset:2976
    v_mfma_f32_16x16x32_bf16 v[24:27], v[48:51], v[84:87], v[24:27]
    ds_read_b128 v[136:139], v145 offset:4512
    v_mfma_f32_16x16x32_bf16 v[28:31], v[52:55], v[84:87], v[28:31]
    ds_read_b128 v[140:143], v145 offset:6048
    v_mfma_f32_16x16x32_bf16 v[32:35], v[48:51], v[88:91], v[32:35]
    ds_read_b128 v[96:99], v144 offset:64
    v_mfma_f32_16x16x32_bf16 v[36:39], v[52:55], v[88:91], v[36:39]
    s_waitcnt vmcnt(31)
    global_load_dwordx4 v[208:211], v232, s[8:9] offset:3072 sc1
    ds_read_b128 v[100:103], v144 offset:96
    v_mfma_f32_16x16x32_bf16 v[40:43], v[48:51], v[92:95], v[40:43]
    ds_read_b128 v[104:107], v144 offset:1088
    v_mfma_f32_16x16x32_bf16 v[44:47], v[52:55], v[92:95], v[44:47]
    ds_read_b128 v[108:111], v144 offset:1120
    v_mfma_f32_16x16x32_bf16 v[24:27], v[56:59], v[80:83], v[24:27]
    ds_read_b128 v[112:115], v144 offset:2112
    v_mfma_f32_16x16x32_bf16 v[28:31], v[60:63], v[80:83], v[28:31]
    ds_read_b128 v[116:119], v144 offset:2144
    v_add_u32 v232, 8192, v232
    v_mfma_f32_16x16x32_bf16 v[32:35], v[56:59], v[84:87], v[32:35]
    ds_read_b128 v[120:123], v144 offset:3136
    v_mfma_f32_16x16x32_bf16 v[36:39], v[60:63], v[84:87], v[36:39]
    ds_read_b128 v[124:127], v144 offset:3168
    v_mfma_f32_16x16x32_bf16 v[40:43], v[56:59], v[88:91], v[40:43]
    v_mfma_f32_16x16x32_bf16 v[44:47], v[60:63], v[88:91], v[44:47]
    v_mfma_f32_16x16x32_bf16 v[32:35], v[64:67], v[80:83], v[32:35]
    v_mfma_f32_16x16x32_bf16 v[36:39], v[68:71], v[80:83], v[36:39]
    v_mfma_f32_16x16x32_bf16 v[40:43], v[64:67], v[84:87], v[40:43]
    s_waitcnt vmcnt(31)
    global_load_dwordx4 v[212:215], v232, s[8:9] offset:-4096 sc1
    v_mfma_f32_16x16x32_bf16 v[44:47], v[68:71], v[84:87], v[44:47]
    v_mfma_f32_16x16x32_bf16 v[40:43], v[72:75], v[80:83], v[40:43]
    v_mfma_f32_16x16x32_bf16 v[44:47], v[76:79], v[80:83], v[44:47]
    s_waitcnt lgkmcnt(0)
    v_add_u32 v144, 128, v144
    v_subrev_u32 v145, 192, v145
    v_mfma_f32_16x16x32_bf16 v[16:19], v[96:99], v[128:131], v[16:19]
    ds_read_b128 v[80:83], v145 offset:1536
    v_mfma_f32_16x16x32_bf16 v[20:23], v[100:103], v[128:131], v[20:23]
    ds_read_b128 v[84:87], v145 offset:3072
    s_waitcnt vmcnt(31)
    global_load_dwordx4 v[216:219], v232, s[8:9] offset:-3072 sc1
    v_mfma_f32_16x16x32_bf16 v[24:27], v[96:99], v[132:135], v[24:27]
    ds_read_b128 v[88:91], v145 offset:4608
    v_mfma_f32_16x16x32_bf16 v[28:31], v[100:103], v[132:135], v[28:31]
    ds_read_b128 v[92:95], v145 offset:6144
    v_mfma_f32_16x16x32_bf16 v[32:35], v[96:99], v[136:139], v[32:35]
    ds_read_b128 v[48:51], v144 offset:0
    v_mfma_f32_16x16x32_bf16 v[36:39], v[100:103], v[136:139], v[36:39]
    ds_read_b128 v[52:55], v144 offset:32
    v_mfma_f32_16x16x32_bf16 v[40:43], v[96:99], v[140:143], v[40:43]
    v_add_u32 v232, 57344, v232
    ds_read_b128 v[56:59], v144 offset:1024
    v_mfma_f32_16x16x32_bf16 v[44:47], v[100:103], v[140:143], v[44:47]
    ds_read_b128 v[60:63], v144 offset:1056
    v_mfma_f32_16x16x32_bf16 v[24:27], v[104:107], v[128:131], v[24:27]
    ds_read_b128 v[64:67], v144 offset:2048
    v_mfma_f32_16x16x32_bf16 v[28:31], v[108:111], v[128:131], v[28:31]
    ds_read_b128 v[68:71], v144 offset:2080
    v_mfma_f32_16x16x32_bf16 v[32:35], v[104:107], v[132:135], v[32:35]
    ds_read_b128 v[72:75], v144 offset:3072
    v_mfma_f32_16x16x32_bf16 v[36:39], v[108:111], v[132:135], v[36:39]
    ds_read_b128 v[76:79], v144 offset:3104
    v_mfma_f32_16x16x32_bf16 v[40:43], v[104:107], v[136:139], v[40:43]
    v_mfma_f32_16x16x32_bf16 v[44:47], v[108:111], v[136:139], v[44:47]
    v_mfma_f32_16x16x32_bf16 v[32:35], v[112:115], v[128:131], v[32:35]
    v_mfma_f32_16x16x32_bf16 v[36:39], v[116:119], v[128:131], v[36:39]
    v_mfma_f32_16x16x32_bf16 v[40:43], v[112:115], v[132:135], v[40:43]
    v_mfma_f32_16x16x32_bf16 v[44:47], v[116:119], v[132:135], v[44:47]
    v_mfma_f32_16x16x32_bf16 v[40:43], v[120:123], v[128:131], v[40:43]
    v_mfma_f32_16x16x32_bf16 v[44:47], v[124:127], v[128:131], v[44:47]
    s_cmp_eq_u32 s4, 0
    s_cselect_b32 s32, s76, s77
    s_cmp_eq_u32 s4, 2
    s_cselect_b32 s32, s78, s32
    s_mul_i32 s30, s4, 7680
    s_add_u32 s30, s30, 123904
    v_mul_u32_u24 v7, 96, v2
    v_lshrrev_b32 v8, 1, v3
    v_lshl_add_u32 v7, v8, 4, v7
    v_and_b32 v8, 1, v3
    v_xor_b32 v8, 1, v8
    v_lshl_add_u32 v7, v8, 3, v7
    v_add_u32 v7, s30, v7
    s_add_u32 s31, s80, s4
    s_lshl_b32 s31, s31, 12
    v_lshlrev_b32 v8, 6, v2
    v_lshl_add_u32 v8, v3, 3, v8
    v_add_u32 v8, s31, v8
    s_waitcnt lgkmcnt(7)
    ds_read_b64 v[48:49], v7 offset:1440
    ds_read_b64 v[50:51], v7 offset:1472
    s_waitcnt lgkmcnt(8)
    ds_read_b64 v[52:53], v7 offset:2976
    ds_read_b64 v[54:55], v7 offset:3008
    s_waitcnt lgkmcnt(9)
    ds_read_b64 v[56:57], v7 offset:4512
    ds_read_b64 v[58:59], v7 offset:4544
    s_waitcnt lgkmcnt(10)
    ds_read_b64 v[60:61], v7 offset:6048
    ds_read_b64 v[62:63], v7 offset:6080
    s_waitcnt lgkmcnt(7)
    v_and_b32 v72, 0xffff0000, v49
    v_lshlrev_b32 v73, 16, v49
    v_and_b32 v74, 0xffff0000, v48
    v_lshlrev_b32 v75, 16, v48
    v_fmac_f32 v16, s32, v72
    v_fmac_f32 v17, s32, v73
    v_fmac_f32 v18, s32, v74
    v_fmac_f32 v19, s32, v75
    v_cvt_pk_bf16_f32 v80, v16, v17
    v_cvt_pk_bf16_f32 v81, v18, v19
    global_store_dwordx2 v8, v[80:81], s[42:43] offset:0 sc1
    s_waitcnt lgkmcnt(6)
    v_and_b32 v76, 0xffff0000, v51
    v_lshlrev_b32 v77, 16, v51
    v_and_b32 v78, 0xffff0000, v50
    v_lshlrev_b32 v79, 16, v50
    v_fmac_f32 v20, s32, v76
    v_fmac_f32 v21, s32, v77
    v_fmac_f32 v22, s32, v78
    v_fmac_f32 v23, s32, v79
    v_cvt_pk_bf16_f32 v82, v20, v21
    v_cvt_pk_bf16_f32 v83, v22, v23
    global_store_dwordx2 v8, v[82:83], s[42:43] offset:32 sc1
    s_waitcnt lgkmcnt(5)
    v_and_b32 v72, 0xffff0000, v53
    v_lshlrev_b32 v73, 16, v53
    v_and_b32 v74, 0xffff0000, v52
    v_lshlrev_b32 v75, 16, v52
    v_fmac_f32 v24, s32, v72
    v_fmac_f32 v25, s32, v73
    v_fmac_f32 v26, s32, v74
    v_fmac_f32 v27, s32, v75
    v_cvt_pk_bf16_f32 v84, v24, v25
    v_cvt_pk_bf16_f32 v85, v26, v27
    global_store_dwordx2 v8, v[84:85], s[42:43] offset:1024 sc1
    s_waitcnt lgkmcnt(4)
    v_and_b32 v76, 0xffff0000, v55
    v_lshlrev_b32 v77, 16, v55
    v_and_b32 v78, 0xffff0000, v54
    v_lshlrev_b32 v79, 16, v54
    v_fmac_f32 v28, s32, v76
    v_fmac_f32 v29, s32, v77
    v_fmac_f32 v30, s32, v78
    v_fmac_f32 v31, s32, v79
    v_cvt_pk_bf16_f32 v86, v28, v29
    v_cvt_pk_bf16_f32 v87, v30, v31
    global_store_dwordx2 v8, v[86:87], s[42:43] offset:1056 sc1
    s_waitcnt lgkmcnt(3)
    v_and_b32 v72, 0xffff0000, v57
    v_lshlrev_b32 v73, 16, v57
    v_and_b32 v74, 0xffff0000, v56
    v_lshlrev_b32 v75, 16, v56
    v_fmac_f32 v32, s32, v72
    v_fmac_f32 v33, s32, v73
    v_fmac_f32 v34, s32, v74
    v_fmac_f32 v35, s32, v75
    v_cvt_pk_bf16_f32 v80, v32, v33
    v_cvt_pk_bf16_f32 v81, v34, v35
    global_store_dwordx2 v8, v[80:81], s[42:43] offset:2048 sc1
    s_waitcnt lgkmcnt(2)
    v_and_b32 v76, 0xffff0000, v59
    v_lshlrev_b32 v77, 16, v59
    v_and_b32 v78, 0xffff0000, v58
    v_lshlrev_b32 v79, 16, v58
    v_fmac_f32 v36, s32, v76
    v_fmac_f32 v37, s32, v77
    v_fmac_f32 v38, s32, v78
    v_fmac_f32 v39, s32, v79
    v_cvt_pk_bf16_f32 v82, v36, v37
    v_cvt_pk_bf16_f32 v83, v38, v39
    global_store_dwordx2 v8, v[82:83], s[42:43] offset:2080 sc1
    s_waitcnt lgkmcnt(1)
    v_and_b32 v72, 0xffff0000, v61
    v_lshlrev_b32 v73, 16, v61
    v_and_b32 v74, 0xffff0000, v60
    v_lshlrev_b32 v75, 16, v60
    v_fmac_f32 v40, s32, v72
    v_fmac_f32 v41, s32, v73
    v_fmac_f32 v42, s32, v74
    v_fmac_f32 v43, s32, v75
    v_cvt_pk_bf16_f32 v84, v40, v41
    v_cvt_pk_bf16_f32 v85, v42, v43
    global_store_dwordx2 v8, v[84:85], s[42:43] offset:3072 sc1
    s_waitcnt lgkmcnt(0)
    v_and_b32 v76, 0xffff0000, v63
    v_lshlrev_b32 v77, 16, v63
    v_and_b32 v78, 0xffff0000, v62
    v_lshlrev_b32 v79, 16, v62
    v_fmac_f32 v44, s32, v76
    v_fmac_f32 v45, s32, v77
    v_fmac_f32 v46, s32, v78
    v_fmac_f32 v47, s32, v79
    v_cvt_pk_bf16_f32 v86, v44, v45
    v_cvt_pk_bf16_f32 v87, v46, v47
    global_store_dwordx2 v8, v[86:87], s[42:43] offset:3104 sc1
interleave_layers__grouped_kv_mqa__ssm_conv_h3__prompt_kernel_cv_end:
    v_mov_b32 v96, 0
    v_mov_b32 v97, 0
    v_mov_b32 v98, 0
    v_mov_b32 v99, 0
    v_mov_b32 v100, 0
    v_mov_b32 v101, 0
    v_mov_b32 v102, 0
    v_mov_b32 v103, 0
    v_mov_b32 v104, 0
    v_mov_b32 v105, 0
    v_mov_b32 v106, 0
    v_mov_b32 v107, 0
    v_mov_b32 v108, 0
    v_mov_b32 v109, 0
    v_mov_b32 v110, 0
    v_mov_b32 v111, 0
    v_mov_b32 v112, 0
    v_mov_b32 v113, 0
    v_mov_b32 v114, 0
    v_mov_b32 v115, 0
    v_mov_b32 v116, 0
    v_mov_b32 v117, 0
    v_mov_b32 v118, 0
    v_mov_b32 v119, 0
    v_mov_b32 v120, 0
    v_mov_b32 v121, 0
    v_mov_b32 v122, 0
    v_mov_b32 v123, 0
    v_mov_b32 v124, 0
    v_mov_b32 v125, 0
    v_mov_b32 v126, 0
    v_mov_b32 v127, 0
    v_mov_b32 v128, 0
    v_mov_b32 v129, 0
    v_mov_b32 v130, 0
    v_mov_b32 v131, 0
    ds_read_b128 v[220:223], v4 offset:1024
    ds_read_b128 v[224:227], v4 offset:2048
    ds_read_b128 v[228:231], v4 offset:3072
    s_waitcnt vmcnt(17) lgkmcnt(2)
    v_mfma_f32_16x16x32_bf16 v[88:91], v[148:151], v[220:223], 0
    ds_read_b128 v[220:223], v4 offset:4096
    s_waitcnt vmcnt(16) lgkmcnt(2)
    v_mfma_f32_16x16x32_bf16 v[88:91], v[152:155], v[224:227], v[88:91]
    ds_read_b128 v[224:227], v4 offset:5120
    s_waitcnt vmcnt(15) lgkmcnt(2)
    v_mfma_f32_16x16x32_bf16 v[88:91], v[156:159], v[228:231], v[88:91]
    ds_read_b128 v[228:231], v4 offset:6144
    s_waitcnt vmcnt(14) lgkmcnt(2)
    v_mfma_f32_16x16x32_bf16 v[88:91], v[160:163], v[220:223], v[88:91]
    ds_read_b128 v[220:223], v4 offset:7168
    s_waitcnt vmcnt(13) lgkmcnt(2)
    v_mfma_f32_16x16x32_bf16 v[88:91], v[164:167], v[224:227], v[88:91]
    ds_read_b128 v[224:227], v4 offset:8192
    s_waitcnt vmcnt(12) lgkmcnt(2)
    v_mfma_f32_16x16x32_bf16 v[88:91], v[168:171], v[228:231], v[88:91]
    ds_read_b128 v[228:231], v4 offset:9216
    s_waitcnt vmcnt(11) lgkmcnt(2)
    v_mfma_f32_16x16x32_bf16 v[88:91], v[172:175], v[220:223], v[88:91]
    ds_read_b128 v[220:223], v4 offset:10240
    s_waitcnt vmcnt(10) lgkmcnt(2)
    v_mfma_f32_16x16x32_bf16 v[88:91], v[176:179], v[224:227], v[88:91]
    ds_read_b128 v[224:227], v4 offset:11264
    s_waitcnt vmcnt(9) lgkmcnt(2)
    v_mfma_f32_16x16x32_bf16 v[88:91], v[180:183], v[228:231], v[88:91]
    ds_read_b128 v[228:231], v4 offset:12288
    s_waitcnt vmcnt(8) lgkmcnt(2)
    v_mfma_f32_16x16x32_bf16 v[88:91], v[184:187], v[220:223], v[88:91]
    ds_read_b128 v[220:223], v4 offset:13312
    s_waitcnt vmcnt(7) lgkmcnt(2)
    v_mfma_f32_16x16x32_bf16 v[88:91], v[188:191], v[224:227], v[88:91]
    ds_read_b128 v[224:227], v4 offset:14336
    s_waitcnt vmcnt(6) lgkmcnt(2)
    v_mfma_f32_16x16x32_bf16 v[88:91], v[192:195], v[228:231], v[88:91]
    ds_read_b128 v[228:231], v4 offset:15360
    s_waitcnt vmcnt(5) lgkmcnt(2)
    v_mfma_f32_16x16x32_bf16 v[88:91], v[196:199], v[220:223], v[88:91]
    ds_read_b128 v[220:223], v4 offset:16384
    s_waitcnt vmcnt(4) lgkmcnt(2)
    v_mfma_f32_16x16x32_bf16 v[88:91], v[200:203], v[224:227], v[88:91]
    ds_read_b128 v[224:227], v4 offset:17408
    s_waitcnt vmcnt(3) lgkmcnt(2)
    v_mfma_f32_16x16x32_bf16 v[88:91], v[204:207], v[228:231], v[88:91]
    ds_read_b128 v[228:231], v4 offset:18432
    s_waitcnt vmcnt(2) lgkmcnt(2)
    v_mfma_f32_16x16x32_bf16 v[88:91], v[208:211], v[220:223], v[88:91]
    s_waitcnt vmcnt(1) lgkmcnt(1)
    v_mfma_f32_16x16x32_bf16 v[88:91], v[212:215], v[224:227], v[88:91]
    s_waitcnt vmcnt(0) lgkmcnt(0)
    v_mfma_f32_16x16x32_bf16 v[88:91], v[216:219], v[228:231], v[88:91]
    s_nop 7
    v_cvt_pk_bf16_f32 v92, v88, v89
    v_cvt_pk_bf16_f32 v93, v90, v91
    ds_write_b64 v239, v[92:93]
    global_load_dwordx4 v[132:135], v232, s[8:9] offset:-4096 sc1
    global_load_dwordx4 v[136:139], v232, s[8:9] offset:-3072 sc1
    global_load_dwordx4 v[140:143], v232, s[8:9] offset:-2048 sc1
    global_load_dwordx4 v[144:147], v232, s[8:9] offset:-1024 sc1
    global_load_dwordx4 v[148:151], v232, s[8:9] offset:0 sc1
    global_load_dwordx4 v[152:155], v232, s[8:9] offset:1024 sc1
    global_load_dwordx4 v[156:159], v232, s[8:9] offset:2048 sc1
    global_load_dwordx4 v[160:163], v232, s[8:9] offset:3072 sc1
    v_add_u32 v232, 8192, v232
    global_load_dwordx4 v[164:167], v232, s[8:9] offset:-4096 sc1
    s_waitcnt lgkmcnt(0)
    s_barrier
    ds_read_b128 v[80:83], v241
    ds_read_b128 v[84:87], v241 offset:1024
    ds_read_b32 v88, v240
    v_mov_b32 v89, 0
    s_mov_b32 s83, 0
interleave_layers__grouped_kv_mqa__ssm_conv_h3__prompt_kernel_layer:
    s_mov_b64 s[84:85], 0
    s_waitcnt vmcnt(13) lgkmcnt(2)
    v_mfma_f32_32x32x16_bf16 v[16:31], a[0:3], v[80:83], 0
    s_waitcnt lgkmcnt(1)
    v_mfma_f32_32x32x16_bf16 v[32:47], a[0:3], v[84:87], 0
    s_waitcnt vmcnt(12) lgkmcnt(0)
    s_nop 8
    v_mfma_f32_32x32x4_2b_bf16 v[16:47], a[64:65], v[88:89], v[16:47] cbsz:1 abid:0
    s_nop 15
    s_nop 4
    .p2align 3
    s_waitcnt vmcnt(9)
    v_mfma_f32_32x32x16_bf16 v[48:63], a[4:7], v[80:83], 0
    global_load_dwordx4 a[16:19], v244, s[40:41] offset:0 sc1
    global_load_dwordx2 a[68:69], v245, s[40:41] offset:1024 sc1
    v_add_u32 v246, 8192, v246
    v_exp_f32 v16, v16
    v_mfma_f32_32x32x16_bf16 v[64:79], a[4:7], v[84:87], 0
    global_load_dwordx4 a[112:115], v246, s[40:41] offset:-4096 sc1
    global_load_dwordx4 a[116:119], v246, s[40:41] offset:-3072 sc1
    ds_read_b128 v[168:171], v4 offset:1024
    v_exp_f32 v17, v17
    ds_read_b128 v[172:175], v4 offset:2048
    ds_read_b128 v[176:179], v4 offset:3072
    v_exp_f32 v18, v18
    v_exp_f32 v19, v19
    v_exp_f32 v20, v20
    v_exp_f32 v21, v21
    v_mfma_f32_32x32x4_2b_bf16 v[48:79], a[64:65], v[88:89], v[48:79] cbsz:1 abid:1
    v_exp_f32 v22, v22
    v_exp_f32 v23, v23
    v_cvt_pk_bf16_f32 v16, v16, v17
    v_cvt_pk_bf16_f32 v17, v18, v19
    v_cvt_pk_bf16_f32 v18, v20, v21
    v_cvt_pk_bf16_f32 v19, v22, v23
    v_exp_f32 v24, v24
    v_exp_f32 v25, v25
    v_exp_f32 v26, v26
    v_exp_f32 v27, v27
    v_mfma_f32_32x32x16_bf16 a[208:223], a[80:83], v[16:19], 0
    v_exp_f32 v28, v28
    v_exp_f32 v29, v29
    v_exp_f32 v30, v30
    v_exp_f32 v31, v31
    v_cvt_pk_bf16_f32 v24, v24, v25
    v_cvt_pk_bf16_f32 v25, v26, v27
    v_cvt_pk_bf16_f32 v26, v28, v29
    v_cvt_pk_bf16_f32 v27, v30, v31
    v_exp_f32 v32, v32
    v_exp_f32 v33, v33
    v_exp_f32 v34, v34
    v_exp_f32 v35, v35
    v_mfma_f32_32x32x16_bf16 a[208:223], a[84:87], v[24:27], a[208:223]
    v_exp_f32 v36, v36
    v_exp_f32 v37, v37
    v_exp_f32 v38, v38
    v_exp_f32 v39, v39
    v_cvt_pk_bf16_f32 v32, v32, v33
    v_cvt_pk_bf16_f32 v33, v34, v35
    v_cvt_pk_bf16_f32 v34, v36, v37
    v_cvt_pk_bf16_f32 v35, v38, v39
    v_exp_f32 v40, v40
    v_exp_f32 v41, v41
    v_exp_f32 v42, v42
    v_exp_f32 v43, v43
    v_mfma_f32_32x32x16_bf16 a[224:239], a[80:83], v[32:35], 0
    v_exp_f32 v44, v44
    v_exp_f32 v45, v45
    v_exp_f32 v46, v46
    v_exp_f32 v47, v47
    v_cvt_pk_bf16_f32 v40, v40, v41
    v_cvt_pk_bf16_f32 v41, v42, v43
    v_cvt_pk_bf16_f32 v42, v44, v45
    v_cvt_pk_bf16_f32 v43, v46, v47
    s_waitcnt vmcnt(9)
    v_mfma_f32_32x32x16_bf16 v[16:31], a[8:11], v[80:83], 0
    global_load_dwordx4 a[20:23], v244, s[40:41] offset:1024 sc1
    global_load_dwordx4 a[120:123], v246, s[40:41] offset:-2048 sc1
    global_load_dwordx4 a[124:127], v246, s[40:41] offset:-1024 sc1
    v_exp_f32 v48, v48
    v_exp_f32 v49, v49
    v_exp_f32 v50, v50
    v_exp_f32 v51, v51
    v_mfma_f32_32x32x16_bf16 a[224:239], a[84:87], v[40:43], a[224:239]
    v_exp_f32 v52, v52
    v_exp_f32 v53, v53
    v_exp_f32 v54, v54
    v_mfma_f32_32x32x16_bf16 v[32:47], a[8:11], v[84:87], 0
    v_exp_f32 v55, v55
    v_cvt_pk_bf16_f32 v48, v48, v49
    v_cvt_pk_bf16_f32 v49, v50, v51
    v_cvt_pk_bf16_f32 v50, v52, v53
    v_cvt_pk_bf16_f32 v51, v54, v55
    v_exp_f32 v56, v56
    v_exp_f32 v57, v57
    v_exp_f32 v58, v58
    v_exp_f32 v59, v59
    v_mfma_f32_32x32x16_bf16 a[208:223], a[88:91], v[48:51], a[208:223]
    v_exp_f32 v60, v60
    v_exp_f32 v61, v61
    v_exp_f32 v62, v62
    v_mfma_f32_32x32x4_2b_bf16 v[16:47], a[66:67], v[88:89], v[16:47] cbsz:1 abid:0
    s_waitcnt lgkmcnt(0)
    v_exp_f32 v63, v63
    v_cvt_pk_bf16_f32 v56, v56, v57
    v_cvt_pk_bf16_f32 v57, v58, v59
    v_cvt_pk_bf16_f32 v58, v60, v61
    v_cvt_pk_bf16_f32 v59, v62, v63
    v_exp_f32 v64, v64
    v_exp_f32 v65, v65
    v_exp_f32 v66, v66
    v_exp_f32 v67, v67
    v_mfma_f32_32x32x16_bf16 a[208:223], a[92:95], v[56:59], a[208:223]
    v_exp_f32 v68, v68
    v_exp_f32 v69, v69
    v_exp_f32 v70, v70
    v_mfma_f32_16x16x32_bf16 v[180:183], v[132:135], v[168:171], 0
    global_load_dwordx4 v[132:135], v232, s[8:9] offset:-3072 sc1
    ds_read_b128 v[168:171], v4 offset:4096
    v_exp_f32 v71, v71
    v_cvt_pk_bf16_f32 v64, v64, v65
    v_cvt_pk_bf16_f32 v65, v66, v67
    v_cvt_pk_bf16_f32 v66, v68, v69
    v_cvt_pk_bf16_f32 v67, v70, v71
    v_exp_f32 v72, v72
    v_exp_f32 v73, v73
    v_exp_f32 v74, v74
    v_exp_f32 v75, v75
    v_mfma_f32_32x32x16_bf16 a[224:239], a[88:91], v[64:67], a[224:239]
    v_exp_f32 v76, v76
    v_exp_f32 v77, v77
    v_exp_f32 v78, v78
    v_exp_f32 v79, v79
    v_cvt_pk_bf16_f32 v72, v72, v73
    v_cvt_pk_bf16_f32 v73, v74, v75
    v_cvt_pk_bf16_f32 v74, v76, v77
    v_cvt_pk_bf16_f32 v75, v78, v79
    s_waitcnt vmcnt(10)
    v_mfma_f32_32x32x16_bf16 v[48:63], a[12:15], v[80:83], 0
    global_load_dwordx4 a[24:27], v244, s[40:41] offset:2048 sc1
    global_load_dwordx2 a[70:71], v245, s[40:41] offset:1536 sc1
    global_load_dwordx4 a[128:131], v246, s[40:41] offset:0 sc1
    v_exp_f32 v16, v16
    global_load_dwordx4 a[132:135], v246, s[40:41] offset:1024 sc1
    v_mfma_f32_16x16x32_bf16 v[180:183], v[136:139], v[172:175], v[180:183]
    global_load_dwordx4 v[136:139], v232, s[8:9] offset:-2048 sc1
    v_exp_f32 v17, v17
    ds_read_b128 v[172:175], v4 offset:5120
    v_exp_f32 v18, v18
    v_exp_f32 v19, v19
    v_mfma_f32_32x32x16_bf16 a[224:239], a[92:95], v[72:75], a[224:239]
    v_exp_f32 v20, v20
    v_exp_f32 v21, v21
    v_exp_f32 v22, v22
    v_mfma_f32_32x32x16_bf16 v[64:79], a[12:15], v[84:87], 0
    v_exp_f32 v23, v23
    v_cvt_pk_bf16_f32 v16, v16, v17
    v_cvt_pk_bf16_f32 v17, v18, v19
    v_cvt_pk_bf16_f32 v18, v20, v21
    v_cvt_pk_bf16_f32 v19, v22, v23
    v_exp_f32 v24, v24
    v_exp_f32 v25, v25
    v_exp_f32 v26, v26
    v_exp_f32 v27, v27
    v_mfma_f32_32x32x16_bf16 a[208:223], a[96:99], v[16:19], a[208:223]
    v_exp_f32 v28, v28
    v_exp_f32 v29, v29
    v_exp_f32 v30, v30
    v_mfma_f32_32x32x4_2b_bf16 v[48:79], a[66:67], v[88:89], v[48:79] cbsz:1 abid:1
    v_exp_f32 v31, v31
    v_cvt_pk_bf16_f32 v24, v24, v25
    v_cvt_pk_bf16_f32 v25, v26, v27
    v_cvt_pk_bf16_f32 v26, v28, v29
    v_cvt_pk_bf16_f32 v27, v30, v31
    v_exp_f32 v32, v32
    v_exp_f32 v33, v33
    v_exp_f32 v34, v34
    v_exp_f32 v35, v35
    v_exp_f32 v36, v36
    v_mfma_f32_32x32x16_bf16 a[208:223], a[100:103], v[24:27], a[208:223]
    v_exp_f32 v37, v37
    v_exp_f32 v38, v38
    v_exp_f32 v39, v39
    v_mfma_f32_16x16x32_bf16 v[180:183], v[140:143], v[176:179], v[180:183]
    global_load_dwordx4 v[140:143], v232, s[8:9] offset:-1024 sc1
    ds_read_b128 v[176:179], v4 offset:6144
    v_cvt_pk_bf16_f32 v32, v32, v33
    v_cvt_pk_bf16_f32 v33, v34, v35
    v_cvt_pk_bf16_f32 v34, v36, v37
    v_cvt_pk_bf16_f32 v35, v38, v39
    v_exp_f32 v40, v40
    v_exp_f32 v41, v41
    v_exp_f32 v42, v42
    v_exp_f32 v43, v43
    v_mfma_f32_32x32x16_bf16 a[224:239], a[96:99], v[32:35], a[224:239]
    v_exp_f32 v44, v44
    v_exp_f32 v45, v45
    v_exp_f32 v46, v46
    v_exp_f32 v47, v47
    v_cvt_pk_bf16_f32 v40, v40, v41
    v_cvt_pk_bf16_f32 v41, v42, v43
    v_cvt_pk_bf16_f32 v42, v44, v45
    v_cvt_pk_bf16_f32 v43, v46, v47
    s_waitcnt vmcnt(12)
    v_mfma_f32_32x32x16_bf16 v[16:31], a[16:19], v[80:83], 0
    global_load_dwordx4 a[28:31], v244, s[40:41] offset:3072 sc1
    global_load_dwordx4 a[136:139], v246, s[40:41] offset:2048 sc1
    global_load_dwordx4 a[140:143], v246, s[40:41] offset:3072 sc1
    v_exp_f32 v48, v48
    v_exp_f32 v49, v49
    v_exp_f32 v50, v50
    v_exp_f32 v51, v51
    v_mfma_f32_32x32x16_bf16 a[224:239], a[100:103], v[40:43], a[224:239]
    v_exp_f32 v52, v52
    v_exp_f32 v53, v53
    v_exp_f32 v54, v54
    v_mfma_f32_32x32x16_bf16 v[32:47], a[16:19], v[84:87], 0
    s_waitcnt lgkmcnt(0)
    v_exp_f32 v55, v55
    v_cvt_pk_bf16_f32 v48, v48, v49
    v_cvt_pk_bf16_f32 v49, v50, v51
    v_cvt_pk_bf16_f32 v50, v52, v53
    v_mfma_f32_16x16x32_bf16 v[180:183], v[144:147], v[168:171], v[180:183]
    global_load_dwordx4 v[144:147], v232, s[8:9] offset:0 sc1
    ds_read_b128 v[168:171], v4 offset:7168
    v_cvt_pk_bf16_f32 v51, v54, v55
    v_exp_f32 v56, v56
    v_mfma_f32_32x32x4_2b_bf16 v[16:47], a[68:69], v[88:89], v[16:47] cbsz:1 abid:0
    v_exp_f32 v57, v57
    v_exp_f32 v58, v58
    v_exp_f32 v59, v59
    v_exp_f32 v60, v60
    v_exp_f32 v61, v61
    v_exp_f32 v62, v62
    v_exp_f32 v63, v63
    v_cvt_pk_bf16_f32 v56, v56, v57
    v_mfma_f32_32x32x16_bf16 a[208:223], a[104:107], v[48:51], a[208:223]
    v_cvt_pk_bf16_f32 v57, v58, v59
    v_cvt_pk_bf16_f32 v58, v60, v61
    v_cvt_pk_bf16_f32 v59, v62, v63
    v_exp_f32 v64, v64
    v_exp_f32 v65, v65
    v_exp_f32 v66, v66
    v_exp_f32 v67, v67
    v_mfma_f32_32x32x16_bf16 a[208:223], a[108:111], v[56:59], a[208:223]
    v_exp_f32 v68, v68
    v_exp_f32 v69, v69
    v_exp_f32 v70, v70
    v_exp_f32 v71, v71
    v_cvt_pk_bf16_f32 v64, v64, v65
    v_cvt_pk_bf16_f32 v65, v66, v67
    v_cvt_pk_bf16_f32 v66, v68, v69
    v_cvt_pk_bf16_f32 v67, v70, v71
    v_exp_f32 v72, v72
    v_exp_f32 v73, v73
    v_exp_f32 v74, v74
    v_exp_f32 v75, v75
    v_mfma_f32_32x32x16_bf16 a[224:239], a[104:107], v[64:67], a[224:239]
    v_exp_f32 v76, v76
    v_exp_f32 v77, v77
    v_exp_f32 v78, v78
    v_mfma_f32_16x16x32_bf16 v[180:183], v[148:151], v[172:175], v[180:183]
    global_load_dwordx4 v[148:151], v232, s[8:9] offset:1024 sc1
    ds_read_b128 v[172:175], v4 offset:8192
    v_exp_f32 v79, v79
    v_cvt_pk_bf16_f32 v72, v72, v73
    v_cvt_pk_bf16_f32 v73, v74, v75
    v_cvt_pk_bf16_f32 v74, v76, v77
    v_cvt_pk_bf16_f32 v75, v78, v79
    s_waitcnt vmcnt(14)
    v_mfma_f32_32x32x16_bf16 v[48:63], a[20:23], v[80:83], 0
    v_add_u32 v244, 8192, v244
    global_load_dwordx4 a[32:35], v244, s[40:41] offset:-4096 sc1
    global_load_dwordx2 a[72:73], v245, s[40:41] offset:2048 sc1
    v_exp_f32 v16, v16
    v_add_u32 v246, 8192, v246
    global_load_dwordx4 a[144:147], v246, s[40:41] offset:-4096 sc1
    global_load_dwordx4 a[148:151], v246, s[40:41] offset:-3072 sc1
    v_exp_f32 v17, v17
    v_exp_f32 v18, v18
    v_exp_f32 v19, v19
    v_mfma_f32_32x32x16_bf16 a[224:239], a[108:111], v[72:75], a[224:239]
    v_exp_f32 v20, v20
    v_exp_f32 v21, v21
    v_exp_f32 v22, v22
    v_mfma_f32_32x32x16_bf16 v[64:79], a[20:23], v[84:87], 0
    v_exp_f32 v23, v23
    v_cvt_pk_bf16_f32 v16, v16, v17
    v_cvt_pk_bf16_f32 v17, v18, v19
    v_cvt_pk_bf16_f32 v18, v20, v21
    v_cvt_pk_bf16_f32 v19, v22, v23
    v_exp_f32 v24, v24
    v_exp_f32 v25, v25
    v_exp_f32 v26, v26
    v_exp_f32 v27, v27
    v_mfma_f32_32x32x16_bf16 a[208:223], a[112:115], v[16:19], a[208:223]
    v_exp_f32 v28, v28
    v_exp_f32 v29, v29
    v_exp_f32 v30, v30
    v_mfma_f32_32x32x4_2b_bf16 v[48:79], a[68:69], v[88:89], v[48:79] cbsz:1 abid:1
    v_exp_f32 v31, v31
    v_cvt_pk_bf16_f32 v24, v24, v25
    v_cvt_pk_bf16_f32 v25, v26, v27
    v_cvt_pk_bf16_f32 v26, v28, v29
    v_cvt_pk_bf16_f32 v27, v30, v31
    v_exp_f32 v32, v32
    v_exp_f32 v33, v33
    v_exp_f32 v34, v34
    v_exp_f32 v35, v35
    v_exp_f32 v36, v36
    v_mfma_f32_32x32x16_bf16 a[208:223], a[116:119], v[24:27], a[208:223]
    v_exp_f32 v37, v37
    v_exp_f32 v38, v38
    v_exp_f32 v39, v39
    v_mfma_f32_16x16x32_bf16 v[180:183], v[152:155], v[176:179], v[180:183]
    global_load_dwordx4 v[152:155], v232, s[8:9] offset:2048 sc1
    ds_read_b128 v[176:179], v4 offset:9216
    v_cvt_pk_bf16_f32 v32, v32, v33
    v_cvt_pk_bf16_f32 v33, v34, v35
    v_cvt_pk_bf16_f32 v34, v36, v37
    v_cvt_pk_bf16_f32 v35, v38, v39
    v_exp_f32 v40, v40
    v_exp_f32 v41, v41
    v_exp_f32 v42, v42
    v_exp_f32 v43, v43
    v_mfma_f32_32x32x16_bf16 a[224:239], a[112:115], v[32:35], a[224:239]
    v_exp_f32 v44, v44
    v_exp_f32 v45, v45
    v_exp_f32 v46, v46
    v_exp_f32 v47, v47
    v_cvt_pk_bf16_f32 v40, v40, v41
    v_cvt_pk_bf16_f32 v41, v42, v43
    v_cvt_pk_bf16_f32 v42, v44, v45
    v_cvt_pk_bf16_f32 v43, v46, v47
    s_waitcnt vmcnt(14)
    v_mfma_f32_32x32x16_bf16 v[16:31], a[24:27], v[80:83], 0
    global_load_dwordx4 a[36:39], v244, s[40:41] offset:-3072 sc1
    global_load_dwordx4 a[152:155], v246, s[40:41] offset:-2048 sc1
    global_load_dwordx4 a[156:159], v246, s[40:41] offset:-1024 sc1
    v_exp_f32 v48, v48
    s_waitcnt lgkmcnt(0)
    v_mfma_f32_16x16x32_bf16 v[180:183], v[156:159], v[168:171], v[180:183]
    global_load_dwordx4 v[156:159], v232, s[8:9] offset:3072 sc1
    v_exp_f32 v49, v49
    ds_read_b128 v[168:171], v4 offset:10240
    v_exp_f32 v50, v50
    v_exp_f32 v51, v51
    v_mfma_f32_32x32x16_bf16 a[224:239], a[116:119], v[40:43], a[224:239]
    v_exp_f32 v52, v52
    v_exp_f32 v53, v53
    v_exp_f32 v54, v54
    v_mfma_f32_32x32x16_bf16 v[32:47], a[24:27], v[84:87], 0
    v_exp_f32 v55, v55
    v_cvt_pk_bf16_f32 v48, v48, v49
    v_cvt_pk_bf16_f32 v49, v50, v51
    v_cvt_pk_bf16_f32 v50, v52, v53
    v_cvt_pk_bf16_f32 v51, v54, v55
    v_exp_f32 v56, v56
    v_exp_f32 v57, v57
    v_exp_f32 v58, v58
    v_exp_f32 v59, v59
    v_mfma_f32_32x32x16_bf16 a[208:223], a[120:123], v[48:51], a[208:223]
    v_exp_f32 v60, v60
    v_exp_f32 v61, v61
    v_exp_f32 v62, v62
    v_mfma_f32_32x32x4_2b_bf16 v[16:47], a[70:71], v[88:89], v[16:47] cbsz:1 abid:0
    v_exp_f32 v63, v63
    v_cvt_pk_bf16_f32 v56, v56, v57
    v_cvt_pk_bf16_f32 v57, v58, v59
    v_cvt_pk_bf16_f32 v58, v60, v61
    v_cvt_pk_bf16_f32 v59, v62, v63
    v_exp_f32 v64, v64
    v_exp_f32 v65, v65
    v_exp_f32 v66, v66
    v_exp_f32 v67, v67
    v_exp_f32 v68, v68
    v_mfma_f32_32x32x16_bf16 a[208:223], a[124:127], v[56:59], a[208:223]
    v_exp_f32 v69, v69
    v_exp_f32 v70, v70
    v_exp_f32 v71, v71
    v_mfma_f32_16x16x32_bf16 v[180:183], v[160:163], v[172:175], v[180:183]
    v_add_u32 v232, 8192, v232
    global_load_dwordx4 v[160:163], v232, s[8:9] offset:-4096 sc1
    v_cvt_pk_bf16_f32 v64, v64, v65
    ds_read_b128 v[172:175], v4 offset:11264
    v_cvt_pk_bf16_f32 v65, v66, v67
    v_cvt_pk_bf16_f32 v66, v68, v69
    v_cvt_pk_bf16_f32 v67, v70, v71
    v_exp_f32 v72, v72
    v_exp_f32 v73, v73
    v_exp_f32 v74, v74
    v_exp_f32 v75, v75
    v_mfma_f32_32x32x16_bf16 a[224:239], a[120:123], v[64:67], a[224:239]
    v_exp_f32 v76, v76
    v_exp_f32 v77, v77
    v_exp_f32 v78, v78
    v_exp_f32 v79, v79
    v_cvt_pk_bf16_f32 v72, v72, v73
    v_cvt_pk_bf16_f32 v73, v74, v75
    v_cvt_pk_bf16_f32 v74, v76, v77
    v_cvt_pk_bf16_f32 v75, v78, v79
    s_waitcnt vmcnt(14)
    v_mfma_f32_32x32x16_bf16 v[48:63], a[28:31], v[80:83], 0
    global_load_dwordx4 a[40:43], v244, s[40:41] offset:-2048 sc1
    global_load_dwordx2 a[74:75], v245, s[40:41] offset:2560 sc1
    global_load_dwordx4 a[160:163], v246, s[40:41] offset:0 sc1
    v_exp_f32 v16, v16
    global_load_dwordx4 a[164:167], v246, s[40:41] offset:1024 sc1
    v_exp_f32 v17, v17
    v_exp_f32 v18, v18
    v_exp_f32 v19, v19
    v_mfma_f32_32x32x16_bf16 a[224:239], a[124:127], v[72:75], a[224:239]
    v_exp_f32 v20, v20
    v_exp_f32 v21, v21
    v_exp_f32 v22, v22
    v_mfma_f32_32x32x16_bf16 v[64:79], a[28:31], v[84:87], 0
    v_exp_f32 v23, v23
    v_cvt_pk_bf16_f32 v16, v16, v17
    v_cvt_pk_bf16_f32 v17, v18, v19
    v_cvt_pk_bf16_f32 v18, v20, v21
    v_cvt_pk_bf16_f32 v19, v22, v23
    v_mfma_f32_16x16x32_bf16 v[180:183], v[164:167], v[176:179], v[180:183]
    global_load_dwordx4 v[164:167], v232, s[8:9] offset:-3072 sc1
    v_add_u32 v232, 57344, v232
    v_exp_f32 v24, v24
    ds_read_b128 v[176:179], v4 offset:12288
    v_mfma_f32_32x32x4_2b_bf16 v[48:79], a[70:71], v[88:89], v[48:79] cbsz:1 abid:1
    v_exp_f32 v25, v25
    v_exp_f32 v26, v26
    v_exp_f32 v27, v27
    v_exp_f32 v28, v28
    v_exp_f32 v29, v29
    v_exp_f32 v30, v30
    v_exp_f32 v31, v31
    v_cvt_pk_bf16_f32 v24, v24, v25
    v_mfma_f32_32x32x16_bf16 a[208:223], a[128:131], v[16:19], a[208:223]
    v_cvt_pk_bf16_f32 v25, v26, v27
    v_cvt_pk_bf16_f32 v26, v28, v29
    v_cvt_pk_bf16_f32 v27, v30, v31
    v_exp_f32 v32, v32
    v_exp_f32 v33, v33
    v_exp_f32 v34, v34
    v_exp_f32 v35, v35
    v_mfma_f32_32x32x16_bf16 a[208:223], a[132:135], v[24:27], a[208:223]
    v_exp_f32 v36, v36
    v_exp_f32 v37, v37
    v_exp_f32 v38, v38
    v_exp_f32 v39, v39
    v_cvt_pk_bf16_f32 v32, v32, v33
    v_cvt_pk_bf16_f32 v33, v34, v35
    v_cvt_pk_bf16_f32 v34, v36, v37
    v_cvt_pk_bf16_f32 v35, v38, v39
    v_exp_f32 v40, v40
    s_waitcnt lgkmcnt(0)
    v_exp_f32 v41, v41
    v_mfma_f32_16x16x32_bf16 v[180:183], v[132:135], v[168:171], v[180:183]
    global_load_dwordx4 v[132:135], v232, s[8:9] offset:-4096 sc1
    ds_read_b128 v[168:171], v4 offset:13312
    v_exp_f32 v42, v42
    v_exp_f32 v43, v43
    v_mfma_f32_32x32x16_bf16 a[224:239], a[128:131], v[32:35], a[224:239]
    v_exp_f32 v44, v44
    v_exp_f32 v45, v45
    v_exp_f32 v46, v46
    v_exp_f32 v47, v47
    v_cvt_pk_bf16_f32 v40, v40, v41
    v_cvt_pk_bf16_f32 v41, v42, v43
    v_cvt_pk_bf16_f32 v42, v44, v45
    v_cvt_pk_bf16_f32 v43, v46, v47
    s_waitcnt vmcnt(14)
    v_mfma_f32_32x32x16_bf16 v[16:31], a[32:35], v[80:83], 0
    global_load_dwordx4 a[44:47], v244, s[40:41] offset:-1024 sc1
    global_load_dwordx4 a[168:171], v246, s[40:41] offset:2048 sc1
    global_load_dwordx4 a[172:175], v246, s[40:41] offset:3072 sc1
    v_exp_f32 v48, v48
    v_exp_f32 v49, v49
    v_exp_f32 v50, v50
    v_exp_f32 v51, v51
    v_mfma_f32_32x32x16_bf16 a[224:239], a[132:135], v[40:43], a[224:239]
    v_exp_f32 v52, v52
    v_exp_f32 v53, v53
    v_exp_f32 v54, v54
    v_mfma_f32_32x32x16_bf16 v[32:47], a[32:35], v[84:87], 0
    v_exp_f32 v55, v55
    v_cvt_pk_bf16_f32 v48, v48, v49
    v_cvt_pk_bf16_f32 v49, v50, v51
    v_cvt_pk_bf16_f32 v50, v52, v53
    v_cvt_pk_bf16_f32 v51, v54, v55
    v_exp_f32 v56, v56
    v_exp_f32 v57, v57
    v_exp_f32 v58, v58
    v_exp_f32 v59, v59
    v_mfma_f32_32x32x16_bf16 a[208:223], a[136:139], v[48:51], a[208:223]
    v_exp_f32 v60, v60
    v_exp_f32 v61, v61
    v_exp_f32 v62, v62
    v_mfma_f32_32x32x4_2b_bf16 v[16:47], a[72:73], v[88:89], v[16:47] cbsz:1 abid:0
    v_exp_f32 v63, v63
    v_cvt_pk_bf16_f32 v56, v56, v57
    v_cvt_pk_bf16_f32 v57, v58, v59
    v_cvt_pk_bf16_f32 v58, v60, v61
    v_cvt_pk_bf16_f32 v59, v62, v63
    v_exp_f32 v64, v64
    v_exp_f32 v65, v65
    v_exp_f32 v66, v66
    v_exp_f32 v67, v67
    v_exp_f32 v68, v68
    v_mfma_f32_32x32x16_bf16 a[208:223], a[140:143], v[56:59], a[208:223]
    v_exp_f32 v69, v69
    v_exp_f32 v70, v70
    v_exp_f32 v71, v71
    v_mfma_f32_16x16x32_bf16 v[180:183], v[136:139], v[172:175], v[180:183]
    global_load_dwordx4 v[136:139], v232, s[8:9] offset:-3072 sc1
    ds_read_b128 v[172:175], v4 offset:14336
    v_cvt_pk_bf16_f32 v64, v64, v65
    v_cvt_pk_bf16_f32 v65, v66, v67
    v_cvt_pk_bf16_f32 v66, v68, v69
    v_cvt_pk_bf16_f32 v67, v70, v71
    v_exp_f32 v72, v72
    v_exp_f32 v73, v73
    v_exp_f32 v74, v74
    v_exp_f32 v75, v75
    v_mfma_f32_32x32x16_bf16 a[224:239], a[136:139], v[64:67], a[224:239]
    v_exp_f32 v76, v76
    v_exp_f32 v77, v77
    v_exp_f32 v78, v78
    v_exp_f32 v79, v79
    v_cvt_pk_bf16_f32 v72, v72, v73
    v_cvt_pk_bf16_f32 v73, v74, v75
    v_cvt_pk_bf16_f32 v74, v76, v77
    v_cvt_pk_bf16_f32 v75, v78, v79
    s_waitcnt vmcnt(14)
    v_mfma_f32_32x32x16_bf16 v[48:63], a[36:39], v[80:83], 0
    global_load_dwordx4 a[48:51], v244, s[40:41] offset:0 sc1
    global_load_dwordx2 a[76:77], v245, s[40:41] offset:3072 sc1
    v_add_u32 v246, 8192, v246
    v_exp_f32 v16, v16
    global_load_dwordx4 a[176:179], v246, s[40:41] offset:-4096 sc1
    global_load_dwordx4 a[180:183], v246, s[40:41] offset:-3072 sc1
    v_mfma_f32_16x16x32_bf16 v[180:183], v[140:143], v[176:179], v[180:183]
    v_exp_f32 v17, v17
    global_load_dwordx4 v[140:143], v232, s[8:9] offset:-2048 sc1
    ds_read_b128 v[176:179], v4 offset:15360
    v_exp_f32 v18, v18
    v_exp_f32 v19, v19
    v_mfma_f32_32x32x16_bf16 a[224:239], a[140:143], v[72:75], a[224:239]
    v_exp_f32 v20, v20
    v_exp_f32 v21, v21
    v_exp_f32 v22, v22
    v_mfma_f32_32x32x16_bf16 v[64:79], a[36:39], v[84:87], 0
    v_exp_f32 v23, v23
    v_cvt_pk_bf16_f32 v16, v16, v17
    v_cvt_pk_bf16_f32 v17, v18, v19
    v_cvt_pk_bf16_f32 v18, v20, v21
    v_cvt_pk_bf16_f32 v19, v22, v23
    v_exp_f32 v24, v24
    v_exp_f32 v25, v25
    v_exp_f32 v26, v26
    v_exp_f32 v27, v27
    v_mfma_f32_32x32x16_bf16 a[208:223], a[144:147], v[16:19], a[208:223]
    v_exp_f32 v28, v28
    v_exp_f32 v29, v29
    v_exp_f32 v30, v30
    v_mfma_f32_32x32x4_2b_bf16 v[48:79], a[72:73], v[88:89], v[48:79] cbsz:1 abid:1
    v_exp_f32 v31, v31
    v_cvt_pk_bf16_f32 v24, v24, v25
    v_cvt_pk_bf16_f32 v25, v26, v27
    v_cvt_pk_bf16_f32 v26, v28, v29
    v_cvt_pk_bf16_f32 v27, v30, v31
    v_exp_f32 v32, v32
    s_waitcnt lgkmcnt(0)
    v_exp_f32 v33, v33
    v_exp_f32 v34, v34
    v_exp_f32 v35, v35
    v_mfma_f32_32x32x16_bf16 a[208:223], a[148:151], v[24:27], a[208:223]
    v_exp_f32 v36, v36
    v_exp_f32 v37, v37
    v_exp_f32 v38, v38
    v_mfma_f32_16x16x32_bf16 v[180:183], v[144:147], v[168:171], v[180:183]
    global_load_dwordx4 v[144:147], v232, s[8:9] offset:-1024 sc1
    ds_read_b128 v[168:171], v4 offset:16384
    v_exp_f32 v39, v39
    v_cvt_pk_bf16_f32 v32, v32, v33
    v_cvt_pk_bf16_f32 v33, v34, v35
    v_cvt_pk_bf16_f32 v34, v36, v37
    v_cvt_pk_bf16_f32 v35, v38, v39
    v_exp_f32 v40, v40
    v_exp_f32 v41, v41
    v_exp_f32 v42, v42
    v_exp_f32 v43, v43
    v_mfma_f32_32x32x16_bf16 a[224:239], a[144:147], v[32:35], a[224:239]
    v_exp_f32 v44, v44
    v_exp_f32 v45, v45
    v_exp_f32 v46, v46
    v_exp_f32 v47, v47
    v_cvt_pk_bf16_f32 v40, v40, v41
    v_cvt_pk_bf16_f32 v41, v42, v43
    v_cvt_pk_bf16_f32 v42, v44, v45
    v_cvt_pk_bf16_f32 v43, v46, v47
    s_waitcnt vmcnt(14)
    v_mfma_f32_32x32x16_bf16 v[16:31], a[40:43], v[80:83], 0
    global_load_dwordx4 a[52:55], v244, s[40:41] offset:1024 sc1
    global_load_dwordx4 a[184:187], v246, s[40:41] offset:-2048 sc1
    global_load_dwordx4 a[188:191], v246, s[40:41] offset:-1024 sc1
    v_exp_f32 v48, v48
    v_exp_f32 v49, v49
    v_exp_f32 v50, v50
    v_exp_f32 v51, v51
    v_mfma_f32_32x32x16_bf16 a[224:239], a[148:151], v[40:43], a[224:239]
    v_exp_f32 v52, v52
    v_exp_f32 v53, v53
    v_exp_f32 v54, v54
    v_mfma_f32_32x32x16_bf16 v[32:47], a[40:43], v[84:87], 0
    v_exp_f32 v55, v55
    v_cvt_pk_bf16_f32 v48, v48, v49
    v_cvt_pk_bf16_f32 v49, v50, v51
    v_cvt_pk_bf16_f32 v50, v52, v53
    v_cvt_pk_bf16_f32 v51, v54, v55
    v_mfma_f32_16x16x32_bf16 v[180:183], v[148:151], v[172:175], v[180:183]
    global_load_dwordx4 v[148:151], v232, s[8:9] offset:0 sc1
    ds_read_b128 v[172:175], v4 offset:17408
    v_exp_f32 v56, v56
    v_exp_f32 v57, v57
    v_mfma_f32_32x32x4_2b_bf16 v[16:47], a[74:75], v[88:89], v[16:47] cbsz:1 abid:0
    v_exp_f32 v58, v58
    v_exp_f32 v59, v59
    v_exp_f32 v60, v60
    v_exp_f32 v61, v61
    v_exp_f32 v62, v62
    v_exp_f32 v63, v63
    v_cvt_pk_bf16_f32 v56, v56, v57
    v_cvt_pk_bf16_f32 v57, v58, v59
    v_cvt_pk_bf16_f32 v58, v60, v61
    v_mfma_f32_32x32x16_bf16 a[208:223], a[152:155], v[48:51], a[208:223]
    v_cvt_pk_bf16_f32 v59, v62, v63
    v_exp_f32 v64, v64
    v_exp_f32 v65, v65
    v_exp_f32 v66, v66
    v_exp_f32 v67, v67
    v_mfma_f32_32x32x16_bf16 a[208:223], a[156:159], v[56:59], a[208:223]
    v_exp_f32 v68, v68
    v_exp_f32 v69, v69
    v_exp_f32 v70, v70
    v_exp_f32 v71, v71
    v_cvt_pk_bf16_f32 v64, v64, v65
    v_cvt_pk_bf16_f32 v65, v66, v67
    v_cvt_pk_bf16_f32 v66, v68, v69
    v_cvt_pk_bf16_f32 v67, v70, v71
    v_exp_f32 v72, v72
    v_mfma_f32_16x16x32_bf16 v[180:183], v[152:155], v[176:179], v[180:183]
    global_load_dwordx4 v[152:155], v232, s[8:9] offset:1024 sc1
    ds_read_b128 v[176:179], v4 offset:18432
    v_exp_f32 v73, v73
    v_exp_f32 v74, v74
    v_exp_f32 v75, v75
    v_mfma_f32_32x32x16_bf16 a[224:239], a[152:155], v[64:67], a[224:239]
    v_exp_f32 v76, v76
    v_exp_f32 v77, v77
    v_exp_f32 v78, v78
    v_exp_f32 v79, v79
    v_cvt_pk_bf16_f32 v72, v72, v73
    v_cvt_pk_bf16_f32 v73, v74, v75
    v_cvt_pk_bf16_f32 v74, v76, v77
    v_cvt_pk_bf16_f32 v75, v78, v79
    s_waitcnt vmcnt(14)
    v_mfma_f32_32x32x16_bf16 v[48:63], a[44:47], v[80:83], 0
    global_load_dwordx4 a[56:59], v244, s[40:41] offset:2048 sc1
    global_load_dwordx2 a[78:79], v245, s[40:41] offset:3584 sc1
    global_load_dwordx4 a[192:195], v246, s[40:41] offset:0 sc1
    v_exp_f32 v16, v16
    global_load_dwordx4 a[196:199], v246, s[40:41] offset:1024 sc1
    v_exp_f32 v17, v17
    v_exp_f32 v18, v18
    v_exp_f32 v19, v19
    v_mfma_f32_32x32x16_bf16 a[224:239], a[156:159], v[72:75], a[224:239]
    v_exp_f32 v20, v20
    v_exp_f32 v21, v21
    v_exp_f32 v22, v22
    v_mfma_f32_32x32x16_bf16 v[64:79], a[44:47], v[84:87], 0
    v_exp_f32 v23, v23
    v_cvt_pk_bf16_f32 v16, v16, v17
    v_cvt_pk_bf16_f32 v17, v18, v19
    v_cvt_pk_bf16_f32 v18, v20, v21
    v_cvt_pk_bf16_f32 v19, v22, v23
    v_exp_f32 v24, v24
    s_waitcnt lgkmcnt(0)
    v_exp_f32 v25, v25
    v_mfma_f32_16x16x32_bf16 v[180:183], v[156:159], v[168:171], v[180:183]
    global_load_dwordx4 v[156:159], v232, s[8:9] offset:2048 sc1
    v_mfma_f32_32x32x4_2b_bf16 v[48:79], a[74:75], v[88:89], v[48:79] cbsz:1 abid:1
    v_exp_f32 v26, v26
    v_exp_f32 v27, v27
    v_exp_f32 v28, v28
    v_exp_f32 v29, v29
    v_exp_f32 v30, v30
    v_exp_f32 v31, v31
    v_cvt_pk_bf16_f32 v24, v24, v25
    v_cvt_pk_bf16_f32 v25, v26, v27
    v_cvt_pk_bf16_f32 v26, v28, v29
    v_mfma_f32_32x32x16_bf16 a[208:223], a[160:163], v[16:19], a[208:223]
    v_cvt_pk_bf16_f32 v27, v30, v31
    v_exp_f32 v32, v32
    v_exp_f32 v33, v33
    v_exp_f32 v34, v34
    v_exp_f32 v35, v35
    v_mfma_f32_32x32x16_bf16 a[208:223], a[164:167], v[24:27], a[208:223]
    v_exp_f32 v36, v36
    v_exp_f32 v37, v37
    v_exp_f32 v38, v38
    v_exp_f32 v39, v39
    v_cvt_pk_bf16_f32 v32, v32, v33
    v_cvt_pk_bf16_f32 v33, v34, v35
    v_cvt_pk_bf16_f32 v34, v36, v37
    v_cvt_pk_bf16_f32 v35, v38, v39
    v_exp_f32 v40, v40
    v_exp_f32 v41, v41
    v_exp_f32 v42, v42
    v_exp_f32 v43, v43
    v_mfma_f32_32x32x16_bf16 a[224:239], a[160:163], v[32:35], a[224:239]
    v_exp_f32 v44, v44
    v_exp_f32 v45, v45
    v_exp_f32 v46, v46
    v_exp_f32 v47, v47
    v_cvt_pk_bf16_f32 v40, v40, v41
    v_cvt_pk_bf16_f32 v41, v42, v43
    v_cvt_pk_bf16_f32 v42, v44, v45
    v_cvt_pk_bf16_f32 v43, v46, v47
    s_waitcnt vmcnt(14)
    v_mfma_f32_32x32x16_bf16 v[16:31], a[48:51], v[80:83], 0
    global_load_dwordx4 a[60:63], v244, s[40:41] offset:3072 sc1
    global_load_dwordx4 a[200:203], v246, s[40:41] offset:2048 sc1
    global_load_dwordx4 a[204:207], v246, s[40:41] offset:3072 sc1
    v_exp_f32 v48, v48
    v_mfma_f32_16x16x32_bf16 v[180:183], v[160:163], v[172:175], v[180:183]
    global_load_dwordx4 v[160:163], v232, s[8:9] offset:3072 sc1
    v_exp_f32 v49, v49
    v_exp_f32 v50, v50
    v_exp_f32 v51, v51
    v_mfma_f32_32x32x16_bf16 a[224:239], a[164:167], v[40:43], a[224:239]
    v_exp_f32 v52, v52
    v_exp_f32 v53, v53
    v_exp_f32 v54, v54
    v_mfma_f32_32x32x16_bf16 v[32:47], a[48:51], v[84:87], 0
    v_exp_f32 v55, v55
    v_cvt_pk_bf16_f32 v48, v48, v49
    v_cvt_pk_bf16_f32 v49, v50, v51
    v_cvt_pk_bf16_f32 v50, v52, v53
    v_cvt_pk_bf16_f32 v51, v54, v55
    v_exp_f32 v56, v56
    v_exp_f32 v57, v57
    v_exp_f32 v58, v58
    v_exp_f32 v59, v59
    v_mfma_f32_32x32x16_bf16 a[208:223], a[168:171], v[48:51], a[208:223]
    v_exp_f32 v60, v60
    v_exp_f32 v61, v61
    v_exp_f32 v62, v62
    v_mfma_f32_32x32x4_2b_bf16 v[16:47], a[76:77], v[88:89], v[16:47] cbsz:1 abid:0
    v_exp_f32 v63, v63
    v_cvt_pk_bf16_f32 v56, v56, v57
    v_cvt_pk_bf16_f32 v57, v58, v59
    v_cvt_pk_bf16_f32 v58, v60, v61
    v_cvt_pk_bf16_f32 v59, v62, v63
    v_exp_f32 v64, v64
    v_exp_f32 v65, v65
    v_exp_f32 v66, v66
    v_exp_f32 v67, v67
    v_exp_f32 v68, v68
    v_mfma_f32_32x32x16_bf16 a[208:223], a[172:175], v[56:59], a[208:223]
    v_exp_f32 v69, v69
    v_exp_f32 v70, v70
    v_exp_f32 v71, v71
    v_mfma_f32_16x16x32_bf16 v[180:183], v[164:167], v[176:179], v[180:183]
    v_add_u32 v232, 8192, v232
    global_load_dwordx4 v[164:167], v232, s[8:9] offset:-4096 sc1
    v_cvt_pk_bf16_f32 v64, v64, v65
    v_cvt_pk_bf16_f32 v65, v66, v67
    v_cvt_pk_bf16_f32 v66, v68, v69
    v_cvt_pk_bf16_f32 v67, v70, v71
    v_exp_f32 v72, v72
    v_exp_f32 v73, v73
    v_exp_f32 v74, v74
    v_cvt_pk_bf16_f32 v184, v180, v181
    v_cvt_pk_bf16_f32 v185, v182, v183
    ds_write_b64 v239, v[184:185]
    v_exp_f32 v75, v75
    v_mfma_f32_32x32x16_bf16 a[224:239], a[168:171], v[64:67], a[224:239]
    v_exp_f32 v76, v76
    v_exp_f32 v77, v77
    v_exp_f32 v78, v78
    v_exp_f32 v79, v79
    v_cvt_pk_bf16_f32 v72, v72, v73
    v_cvt_pk_bf16_f32 v73, v74, v75
    v_cvt_pk_bf16_f32 v74, v76, v77
    v_cvt_pk_bf16_f32 v75, v78, v79
    s_waitcnt vmcnt(14)
    v_mfma_f32_32x32x16_bf16 v[48:63], a[52:55], v[80:83], 0
    v_exp_f32 v16, v16
    v_exp_f32 v17, v17
    v_exp_f32 v18, v18
    v_exp_f32 v19, v19
    v_mfma_f32_32x32x16_bf16 a[224:239], a[172:175], v[72:75], a[224:239]
    v_exp_f32 v20, v20
    v_exp_f32 v21, v21
    v_exp_f32 v22, v22
    v_mfma_f32_32x32x16_bf16 v[64:79], a[52:55], v[84:87], 0
    s_waitcnt lgkmcnt(0)
    s_barrier
    v_exp_f32 v23, v23
    v_cvt_pk_bf16_f32 v16, v16, v17
    v_cvt_pk_bf16_f32 v17, v18, v19
    v_cvt_pk_bf16_f32 v18, v20, v21
    v_cvt_pk_bf16_f32 v19, v22, v23
    v_exp_f32 v24, v24
    v_exp_f32 v25, v25
    v_exp_f32 v26, v26
    v_mfma_f32_32x32x4_2b_bf16 v[48:79], a[76:77], v[88:89], v[48:79] cbsz:1 abid:1
    v_exp_f32 v27, v27
    v_exp_f32 v28, v28
    v_exp_f32 v29, v29
    v_exp_f32 v30, v30
    v_exp_f32 v31, v31
    v_cvt_pk_bf16_f32 v24, v24, v25
    v_cvt_pk_bf16_f32 v25, v26, v27
    v_cvt_pk_bf16_f32 v26, v28, v29
    v_cvt_pk_bf16_f32 v27, v30, v31
    v_exp_f32 v32, v32
    v_mfma_f32_32x32x16_bf16 a[208:223], a[176:179], v[16:19], a[208:223]
    v_exp_f32 v33, v33
    v_exp_f32 v34, v34
    v_exp_f32 v35, v35
    v_mfma_f32_32x32x16_bf16 a[208:223], a[180:183], v[24:27], a[208:223]
    v_exp_f32 v36, v36
    v_exp_f32 v37, v37
    v_exp_f32 v38, v38
    v_exp_f32 v39, v39
    v_cvt_pk_bf16_f32 v32, v32, v33
    v_cvt_pk_bf16_f32 v33, v34, v35
    v_cvt_pk_bf16_f32 v34, v36, v37
    v_cvt_pk_bf16_f32 v35, v38, v39
    v_exp_f32 v40, v40
    v_exp_f32 v41, v41
    v_exp_f32 v42, v42
    v_exp_f32 v43, v43
    v_mfma_f32_32x32x16_bf16 a[224:239], a[176:179], v[32:35], a[224:239]
    v_exp_f32 v44, v44
    v_exp_f32 v45, v45
    v_exp_f32 v46, v46
    v_exp_f32 v47, v47
    v_cvt_pk_bf16_f32 v40, v40, v41
    v_cvt_pk_bf16_f32 v41, v42, v43
    v_cvt_pk_bf16_f32 v42, v44, v45
    v_cvt_pk_bf16_f32 v43, v46, v47
    s_waitcnt vmcnt(8)
    v_mfma_f32_32x32x16_bf16 v[16:31], a[56:59], v[80:83], 0
    v_exp_f32 v48, v48
    v_exp_f32 v49, v49
    v_exp_f32 v50, v50
    v_exp_f32 v51, v51
    v_mfma_f32_32x32x16_bf16 a[224:239], a[180:183], v[40:43], a[224:239]
    v_exp_f32 v52, v52
    v_exp_f32 v53, v53
    v_exp_f32 v54, v54
    v_mfma_f32_32x32x16_bf16 v[32:47], a[56:59], v[84:87], 0
    v_exp_f32 v55, v55
    v_cvt_pk_bf16_f32 v48, v48, v49
    v_cvt_pk_bf16_f32 v49, v50, v51
    v_cvt_pk_bf16_f32 v50, v52, v53
    v_cvt_pk_bf16_f32 v51, v54, v55
    v_exp_f32 v56, v56
    v_exp_f32 v57, v57
    v_exp_f32 v58, v58
    v_exp_f32 v59, v59
    v_mfma_f32_32x32x16_bf16 a[208:223], a[184:187], v[48:51], a[208:223]
    v_exp_f32 v60, v60
    v_exp_f32 v61, v61
    v_exp_f32 v62, v62
    v_mfma_f32_32x32x4_2b_bf16 v[16:47], a[78:79], v[88:89], v[16:47] cbsz:1 abid:0
    v_exp_f32 v63, v63
    v_cvt_pk_bf16_f32 v56, v56, v57
    v_cvt_pk_bf16_f32 v57, v58, v59
    v_cvt_pk_bf16_f32 v58, v60, v61
    v_cvt_pk_bf16_f32 v59, v62, v63
    v_exp_f32 v64, v64
    v_exp_f32 v65, v65
    v_exp_f32 v66, v66
    v_exp_f32 v67, v67
    v_exp_f32 v68, v68
    v_mfma_f32_32x32x16_bf16 a[208:223], a[188:191], v[56:59], a[208:223]
    v_exp_f32 v69, v69
    v_exp_f32 v70, v70
    v_exp_f32 v71, v71
    v_cvt_pk_bf16_f32 v64, v64, v65
    v_cvt_pk_bf16_f32 v65, v66, v67
    v_cvt_pk_bf16_f32 v66, v68, v69
    v_cvt_pk_bf16_f32 v67, v70, v71
    v_exp_f32 v72, v72
    v_exp_f32 v73, v73
    v_exp_f32 v74, v74
    v_exp_f32 v75, v75
    v_mfma_f32_32x32x16_bf16 a[224:239], a[184:187], v[64:67], a[224:239]
    v_exp_f32 v76, v76
    v_exp_f32 v77, v77
    v_exp_f32 v78, v78
    v_exp_f32 v79, v79
    v_cvt_pk_bf16_f32 v72, v72, v73
    v_cvt_pk_bf16_f32 v73, v74, v75
    v_cvt_pk_bf16_f32 v74, v76, v77
    v_cvt_pk_bf16_f32 v75, v78, v79
    s_waitcnt vmcnt(4)
    v_mfma_f32_32x32x16_bf16 v[48:63], a[60:63], v[80:83], 0
    v_exp_f32 v16, v16
    v_exp_f32 v17, v17
    v_exp_f32 v18, v18
    v_exp_f32 v19, v19
    v_mfma_f32_32x32x16_bf16 a[224:239], a[188:191], v[72:75], a[224:239]
    v_exp_f32 v20, v20
    v_exp_f32 v21, v21
    v_exp_f32 v22, v22
    v_mfma_f32_32x32x16_bf16 v[64:79], a[60:63], v[84:87], 0
    v_exp_f32 v23, v23
    v_cvt_pk_bf16_f32 v16, v16, v17
    v_cvt_pk_bf16_f32 v17, v18, v19
    v_cvt_pk_bf16_f32 v18, v20, v21
    v_cvt_pk_bf16_f32 v19, v22, v23
    v_exp_f32 v24, v24
    v_exp_f32 v25, v25
    v_exp_f32 v26, v26
    v_exp_f32 v27, v27
    v_mfma_f32_32x32x16_bf16 a[208:223], a[192:195], v[16:19], a[208:223]
    v_exp_f32 v28, v28
    v_exp_f32 v29, v29
    v_exp_f32 v30, v30
    v_mfma_f32_32x32x4_2b_bf16 v[48:79], a[78:79], v[88:89], v[48:79] cbsz:1 abid:1
    ds_read_b128 v[80:83], v241
    ds_read_b128 v[84:87], v241 offset:1024
    v_add_u32 v240, 256, v240
    ds_read_b32 v88, v240
    v_exp_f32 v31, v31
    v_cvt_pk_bf16_f32 v24, v24, v25
    v_cvt_pk_bf16_f32 v25, v26, v27
    v_cvt_pk_bf16_f32 v26, v28, v29
    v_cvt_pk_bf16_f32 v27, v30, v31
    v_exp_f32 v32, v32
    v_exp_f32 v33, v33
    v_exp_f32 v34, v34
    v_exp_f32 v35, v35
    v_mfma_f32_32x32x16_bf16 a[208:223], a[196:199], v[24:27], a[208:223]
    v_exp_f32 v36, v36
    v_exp_f32 v37, v37
    v_exp_f32 v38, v38
    v_exp_f32 v39, v39
    v_cvt_pk_bf16_f32 v32, v32, v33
    v_cvt_pk_bf16_f32 v33, v34, v35
    v_cvt_pk_bf16_f32 v34, v36, v37
    v_cvt_pk_bf16_f32 v35, v38, v39
    v_exp_f32 v40, v40
    v_exp_f32 v41, v41
    v_exp_f32 v42, v42
    v_exp_f32 v43, v43
    v_mfma_f32_32x32x16_bf16 a[224:239], a[192:195], v[32:35], a[224:239]
    v_exp_f32 v44, v44
    v_exp_f32 v45, v45
    v_exp_f32 v46, v46
    v_exp_f32 v47, v47
    v_cvt_pk_bf16_f32 v40, v40, v41
    v_cvt_pk_bf16_f32 v41, v42, v43
    v_cvt_pk_bf16_f32 v42, v44, v45
    v_cvt_pk_bf16_f32 v43, v46, v47
    s_waitcnt lgkmcnt(2)
    v_mfma_f32_32x32x16_bf16 v[16:31], a[0:3], v[80:83], 0
    s_waitcnt vmcnt(2)
    v_exp_f32 v48, v48
    v_exp_f32 v49, v49
    v_exp_f32 v50, v50
    v_exp_f32 v51, v51
    v_mfma_f32_32x32x16_bf16 a[224:239], a[196:199], v[40:43], a[224:239]
    v_exp_f32 v52, v52
    v_exp_f32 v53, v53
    v_exp_f32 v54, v54
    s_waitcnt lgkmcnt(1)
    v_mfma_f32_32x32x16_bf16 v[32:47], a[0:3], v[84:87], 0
    v_exp_f32 v55, v55
    v_cvt_pk_bf16_f32 v48, v48, v49
    v_cvt_pk_bf16_f32 v49, v50, v51
    v_cvt_pk_bf16_f32 v50, v52, v53
    v_cvt_pk_bf16_f32 v51, v54, v55
    v_exp_f32 v56, v56
    v_exp_f32 v57, v57
    v_exp_f32 v58, v58
    v_exp_f32 v59, v59
    v_mfma_f32_32x32x16_bf16 a[208:223], a[200:203], v[48:51], a[208:223]
    v_exp_f32 v60, v60
    v_exp_f32 v61, v61
    v_exp_f32 v62, v62
    s_waitcnt lgkmcnt(0)
    v_mfma_f32_32x32x4_2b_bf16 v[16:47], a[64:65], v[88:89], v[16:47] cbsz:1 abid:0
    v_exp_f32 v63, v63
    v_cvt_pk_bf16_f32 v56, v56, v57
    v_cvt_pk_bf16_f32 v57, v58, v59
    v_cvt_pk_bf16_f32 v58, v60, v61
    v_cvt_pk_bf16_f32 v59, v62, v63
    v_exp_f32 v64, v64
    v_exp_f32 v65, v65
    v_exp_f32 v66, v66
    v_exp_f32 v67, v67
    v_exp_f32 v68, v68
    v_mfma_f32_32x32x16_bf16 a[208:223], a[204:207], v[56:59], a[208:223]
    v_exp_f32 v69, v69
    v_exp_f32 v70, v70
    v_exp_f32 v71, v71
    v_cvt_pk_bf16_f32 v64, v64, v65
    v_cvt_pk_bf16_f32 v65, v66, v67
    v_cvt_pk_bf16_f32 v66, v68, v69
    v_cvt_pk_bf16_f32 v67, v70, v71
    v_exp_f32 v72, v72
    v_exp_f32 v73, v73
    v_exp_f32 v74, v74
    v_exp_f32 v75, v75
    v_mfma_f32_32x32x16_bf16 a[224:239], a[200:203], v[64:67], a[224:239]
    v_exp_f32 v76, v76
    v_exp_f32 v77, v77
    v_exp_f32 v78, v78
    v_exp_f32 v79, v79
    v_cvt_pk_bf16_f32 v72, v72, v73
    v_cvt_pk_bf16_f32 v73, v74, v75
    v_cvt_pk_bf16_f32 v74, v76, v77
    v_cvt_pk_bf16_f32 v75, v78, v79
    s_cmp_eq_u32 s83, 0
    s_cbranch_scc0 L_yfl12
    s_cmp_lg_u32 s4, 0
    s_cbranch_scc1 L_ft13
    s_lshl_b32 s28, s5, 1
    s_add_u32 s28, s28, s6
    s_lshl_b32 s28, s28, 7
    s_add_u32 s28, s28, 0x2808000
    v_mov_b32 v5, s28
    v_mov_b32 v6, s86
    s_mov_b64 exec, 1
    global_store_dword v5, v6, s[8:9] sc1
    s_mov_b64 exec, -1
L_ft13:
L_yfl12:
    s_mov_b32 s82, 1
    .p2align 3
interleave_layers__grouped_kv_mqa__ssm_conv_h3__prompt_kernel_at_ph:
    v_mfma_f32_32x32x16_bf16 v[48:63], a[4:7], v[80:83], 0
    ds_write_b128 v234, a[208:211] offset:0
    ds_write_b128 v234, a[212:215] offset:1024
    ds_write_b128 v234, a[216:219] offset:2048
    v_exp_f32 v16, v16
    ds_read_b128 v[168:171], v4 offset:1024
    ds_read_b128 v[172:175], v4 offset:2048
    ds_read_b128 v[176:179], v4 offset:3072
    v_exp_f32 v17, v17
    v_exp_f32 v18, v18
    v_exp_f32 v19, v19
    v_mfma_f32_32x32x16_bf16 a[224:239], a[204:207], v[72:75], a[224:239]
    v_exp_f32 v20, v20
    v_exp_f32 v21, v21
    v_exp_f32 v22, v22
    v_mfma_f32_32x32x16_bf16 v[64:79], a[4:7], v[84:87], 0
    v_exp_f32 v23, v23
    v_cvt_pk_bf16_f32 v16, v16, v17
    v_cvt_pk_bf16_f32 v17, v18, v19
    v_cvt_pk_bf16_f32 v18, v20, v21
    v_cvt_pk_bf16_f32 v19, v22, v23
    v_exp_f32 v24, v24
    v_exp_f32 v25, v25
    v_exp_f32 v26, v26
    v_exp_f32 v27, v27
    v_mfma_f32_32x32x16_bf16 a[208:223], a[80:83], v[16:19], 0
    ds_write_b128 v234, a[224:227] offset:3072
    ds_write_b128 v234, a[228:231] offset:4096
    v_mfma_f32_32x32x4_2b_bf16 v[48:79], a[64:65], v[88:89], v[48:79] cbsz:1 abid:1
    ds_write_b128 v234, a[232:235] offset:5120
    v_exp_f32 v28, v28
    v_exp_f32 v29, v29
    v_exp_f32 v30, v30
    v_exp_f32 v31, v31
    v_cvt_pk_bf16_f32 v24, v24, v25
    v_cvt_pk_bf16_f32 v25, v26, v27
    v_cvt_pk_bf16_f32 v26, v28, v29
    v_cvt_pk_bf16_f32 v27, v30, v31
    v_exp_f32 v32, v32
    v_exp_f32 v33, v33
    v_exp_f32 v34, v34
    v_exp_f32 v35, v35
    v_mfma_f32_32x32x16_bf16 a[208:223], a[84:87], v[24:27], a[208:223]
    v_exp_f32 v36, v36
    v_exp_f32 v37, v37
    v_exp_f32 v38, v38
    v_exp_f32 v39, v39
    v_cvt_pk_bf16_f32 v32, v32, v33
    v_cvt_pk_bf16_f32 v33, v34, v35
    v_cvt_pk_bf16_f32 v34, v36, v37
    v_cvt_pk_bf16_f32 v35, v38, v39
    v_exp_f32 v40, v40
    v_exp_f32 v41, v41
    v_exp_f32 v42, v42
    v_exp_f32 v43, v43
    v_mfma_f32_32x32x16_bf16 a[224:239], a[80:83], v[32:35], 0
    v_exp_f32 v44, v44
    v_exp_f32 v45, v45
    v_exp_f32 v46, v46
    v_exp_f32 v47, v47
    v_cvt_pk_bf16_f32 v40, v40, v41
    v_cvt_pk_bf16_f32 v41, v42, v43
    v_cvt_pk_bf16_f32 v42, v44, v45
    v_cvt_pk_bf16_f32 v43, v46, v47
    v_mfma_f32_32x32x16_bf16 v[16:31], a[8:11], v[80:83], 0
    s_waitcnt vmcnt(6) lgkmcnt(3)
    v_exp_f32 v48, v48
    v_exp_f32 v49, v49
    v_exp_f32 v50, v50
    v_mfma_f32_16x16x32_bf16 v[180:183], v[132:135], v[168:171], 0
    global_load_dwordx4 v[132:135], v232, s[8:9] offset:-3072 sc1
    ds_read_b128 v[168:171], v4 offset:4096
    v_exp_f32 v51, v51
    v_mfma_f32_32x32x16_bf16 a[224:239], a[84:87], v[40:43], a[224:239]
    v_exp_f32 v52, v52
    v_exp_f32 v53, v53
    v_exp_f32 v54, v54
    v_mfma_f32_32x32x16_bf16 v[32:47], a[8:11], v[84:87], 0
    v_exp_f32 v55, v55
    v_cvt_pk_bf16_f32 v48, v48, v49
    v_cvt_pk_bf16_f32 v49, v50, v51
    v_cvt_pk_bf16_f32 v50, v52, v53
    v_cvt_pk_bf16_f32 v51, v54, v55
    v_exp_f32 v56, v56
    v_exp_f32 v57, v57
    v_exp_f32 v58, v58
    v_mfma_f32_16x16x32_bf16 v[180:183], v[136:139], v[172:175], v[180:183]
    global_load_dwordx4 v[136:139], v232, s[8:9] offset:-2048 sc1
    v_mfma_f32_32x32x4_2b_bf16 v[16:47], a[66:67], v[88:89], v[16:47] cbsz:1 abid:0
    ds_read_b128 v[172:175], v4 offset:5120
    v_exp_f32 v59, v59
    v_exp_f32 v60, v60
    v_exp_f32 v61, v61
    v_exp_f32 v62, v62
    v_exp_f32 v63, v63
    v_cvt_pk_bf16_f32 v56, v56, v57
    v_cvt_pk_bf16_f32 v57, v58, v59
    v_cvt_pk_bf16_f32 v58, v60, v61
    v_mfma_f32_32x32x16_bf16 a[208:223], a[88:91], v[48:51], a[208:223]
    v_cvt_pk_bf16_f32 v59, v62, v63
    v_exp_f32 v64, v64
    v_exp_f32 v65, v65
    v_exp_f32 v66, v66
    v_exp_f32 v67, v67
    v_mfma_f32_32x32x16_bf16 a[208:223], a[92:95], v[56:59], a[208:223]
    v_exp_f32 v68, v68
    v_exp_f32 v69, v69
    v_exp_f32 v70, v70
    v_mfma_f32_16x16x32_bf16 v[180:183], v[140:143], v[176:179], v[180:183]
    global_load_dwordx4 v[140:143], v232, s[8:9] offset:-1024 sc1
    ds_read_b128 v[176:179], v4 offset:6144
    v_exp_f32 v71, v71
    s_waitcnt lgkmcnt(3)
    s_barrier
    ds_read_b128 v[216:219], v236 offset:0
    v_cvt_pk_bf16_f32 v64, v64, v65
    ds_read_b128 v[220:223], v236 offset:6144
    ds_read_b128 v[224:227], v236 offset:12288
    ds_read_b128 v[228:231], v236 offset:18432
    v_cvt_pk_bf16_f32 v65, v66, v67
    ds_read_b128 v[200:203], v235 offset:0
    ds_read_b128 v[204:207], v235 offset:6144
    ds_read_b128 v[208:211], v235 offset:12288
    v_cvt_pk_bf16_f32 v66, v68, v69
    ds_read_b128 v[212:215], v235 offset:18432
    v_cvt_pk_bf16_f32 v67, v70, v71
    v_exp_f32 v72, v72
    s_waitcnt vmcnt(6) lgkmcnt(8)
    v_mfma_f32_16x16x32_bf16 v[180:183], v[144:147], v[168:171], v[180:183]
    global_load_dwordx4 v[144:147], v232, s[8:9] offset:0 sc1
    v_exp_f32 v73, v73
    ds_read_b128 v[168:171], v4 offset:7168
    v_exp_f32 v74, v74
    v_exp_f32 v75, v75
    v_mfma_f32_32x32x16_bf16 a[224:239], a[88:91], v[64:67], a[224:239]
    v_exp_f32 v76, v76
    v_exp_f32 v77, v77
    v_exp_f32 v78, v78
    v_exp_f32 v79, v79
    v_cvt_pk_bf16_f32 v72, v72, v73
    v_cvt_pk_bf16_f32 v73, v74, v75
    v_cvt_pk_bf16_f32 v74, v76, v77
    v_cvt_pk_bf16_f32 v75, v78, v79
    v_mfma_f32_32x32x16_bf16 v[48:63], a[12:15], v[80:83], 0
    v_exp_f32 v16, v16
    v_exp_f32 v17, v17
    v_exp_f32 v18, v18
    v_exp_f32 v19, v19
    v_mfma_f32_32x32x16_bf16 a[224:239], a[92:95], v[72:75], a[224:239]
    v_exp_f32 v20, v20
    v_exp_f32 v21, v21
    v_exp_f32 v22, v22
    v_mfma_f32_32x32x16_bf16 v[64:79], a[12:15], v[84:87], 0
    v_exp_f32 v23, v23
    v_cvt_pk_bf16_f32 v16, v16, v17
    v_cvt_pk_bf16_f32 v17, v18, v19
    v_cvt_pk_bf16_f32 v18, v20, v21
    v_cvt_pk_bf16_f32 v19, v22, v23
    v_mfma_f32_16x16x32_bf16 v[180:183], v[148:151], v[172:175], v[180:183]
    global_load_dwordx4 v[148:151], v232, s[8:9] offset:1024 sc1
    ds_read_b128 v[172:175], v4 offset:8192
    v_exp_f32 v24, v24
    v_exp_f32 v25, v25
    v_mfma_f32_32x32x4_2b_bf16 v[48:79], a[66:67], v[88:89], v[48:79] cbsz:1 abid:1
    v_exp_f32 v26, v26
    v_exp_f32 v27, v27
    v_exp_f32 v28, v28
    v_exp_f32 v29, v29
    v_exp_f32 v30, v30
    v_exp_f32 v31, v31
    v_cvt_pk_bf16_f32 v24, v24, v25
    v_cvt_pk_bf16_f32 v25, v26, v27
    v_cvt_pk_bf16_f32 v26, v28, v29
    v_mfma_f32_32x32x16_bf16 a[208:223], a[96:99], v[16:19], a[208:223]
    v_cvt_pk_bf16_f32 v27, v30, v31
    v_exp_f32 v32, v32
    v_exp_f32 v33, v33
    v_exp_f32 v34, v34
    v_mfma_f32_16x16x32_bf16 v[180:183], v[152:155], v[176:179], v[180:183]
    global_load_dwordx4 v[152:155], v232, s[8:9] offset:2048 sc1
    ds_read_b128 v[176:179], v4 offset:9216
    v_exp_f32 v35, v35
    v_mfma_f32_32x32x16_bf16 a[208:223], a[100:103], v[24:27], a[208:223]
    s_waitcnt lgkmcnt(3)
    v_pk_add_f32 v[216:217], v[216:217], v[220:221]
    v_pk_add_f32 v[224:225], v[224:225], v[228:229]
    v_exp_f32 v36, v36
    v_add_f32 v218, v218, v222
    v_add_f32 v226, v226, v230
    v_pk_add_f32 v[216:217], v[216:217], v[224:225]
    v_exp_f32 v37, v37
    v_add_f32 v218, v218, v226
    v_rcp_f32 v242, v218
    v_subrev_u32 v243, 0x1f800000, v218
    v_exp_f32 v38, v38
    v_cmp_le_u32 vcc, 0x40000000, v243
    v_pk_add_f32 v[200:201], v[200:201], v[204:205]
    v_pk_add_f32 v[208:209], v[208:209], v[212:213]
    v_exp_f32 v39, v39
    v_pk_add_f32 v[202:203], v[202:203], v[206:207]
    v_pk_add_f32 v[210:211], v[210:211], v[214:215]
    s_or_b64 s[84:85], s[84:85], vcc
    v_cvt_pk_bf16_f32 v32, v32, v33
    v_pk_add_f32 v[200:201], v[200:201], v[208:209]
    v_pk_add_f32 v[202:203], v[202:203], v[210:211]
    v_pk_mul_f32 v[216:217], v[216:217], v[242:243] op_sel_hi:[1,0]
    v_cvt_pk_bf16_f32 v33, v34, v35
    v_pk_mul_f32 v[200:201], v[200:201], v[242:243] op_sel_hi:[1,0]
    v_pk_mul_f32 v[202:203], v[202:203], v[242:243] op_sel_hi:[1,0]
    v_cvt_pk_bf16_f32 v220, v216, v217
    v_cvt_pk_bf16_f32 v34, v36, v37
    v_cvt_pk_bf16_f32 v204, v200, v201
    v_cvt_pk_bf16_f32 v205, v202, v203
    ds_write_b32 v238, v220
    v_cvt_pk_bf16_f32 v35, v38, v39
    ds_write_b64 v237, v[204:205]
    v_add_u32 v238, 256, v238
    s_waitcnt vmcnt(6) lgkmcnt(2)
    v_exp_f32 v40, v40
    v_mfma_f32_16x16x32_bf16 v[180:183], v[156:159], v[168:171], v[180:183]
    global_load_dwordx4 v[156:159], v232, s[8:9] offset:3072 sc1
    ds_read_b128 v[168:171], v4 offset:10240
    v_exp_f32 v41, v41
    v_mfma_f32_16x16x32_bf16 v[180:183], v[160:163], v[172:175], v[180:183]
    v_add_u32 v232, 8192, v232
    global_load_dwordx4 v[160:163], v232, s[8:9] offset:-4096 sc1
    v_exp_f32 v42, v42
    ds_read_b128 v[172:175], v4 offset:11264
    v_exp_f32 v43, v43
    v_mfma_f32_32x32x16_bf16 a[224:239], a[96:99], v[32:35], a[224:239]
    v_exp_f32 v44, v44
    v_exp_f32 v45, v45
    v_exp_f32 v46, v46
    v_exp_f32 v47, v47
    v_cvt_pk_bf16_f32 v40, v40, v41
    v_cvt_pk_bf16_f32 v41, v42, v43
    v_cvt_pk_bf16_f32 v42, v44, v45
    v_cvt_pk_bf16_f32 v43, v46, v47
    v_mfma_f32_32x32x16_bf16 v[16:31], a[16:19], v[80:83], 0
    v_exp_f32 v48, v48
    v_exp_f32 v49, v49
    v_exp_f32 v50, v50
    v_exp_f32 v51, v51
    v_mfma_f32_32x32x16_bf16 a[224:239], a[100:103], v[40:43], a[224:239]
    v_exp_f32 v52, v52
    v_exp_f32 v53, v53
    v_exp_f32 v54, v54
    v_mfma_f32_32x32x16_bf16 v[32:47], a[16:19], v[84:87], 0
    v_exp_f32 v55, v55
    v_cvt_pk_bf16_f32 v48, v48, v49
    v_cvt_pk_bf16_f32 v49, v50, v51
    v_cvt_pk_bf16_f32 v50, v52, v53
    v_cvt_pk_bf16_f32 v51, v54, v55
    v_mfma_f32_16x16x32_bf16 v[180:183], v[164:167], v[176:179], v[180:183]
    global_load_dwordx4 v[164:167], v232, s[8:9] offset:-3072 sc1
    v_add_u32 v232, 57344, v232
    v_exp_f32 v56, v56
    ds_read_b128 v[176:179], v4 offset:12288
    v_mfma_f32_32x32x4_2b_bf16 v[16:47], a[68:69], v[88:89], v[16:47] cbsz:1 abid:0
    v_exp_f32 v57, v57
    v_exp_f32 v58, v58
    v_exp_f32 v59, v59
    v_exp_f32 v60, v60
    v_exp_f32 v61, v61
    s_waitcnt vmcnt(6) lgkmcnt(0)
    v_exp_f32 v62, v62
    v_exp_f32 v63, v63
    v_mfma_f32_32x32x16_bf16 a[208:223], a[104:107], v[48:51], a[208:223]
    v_cvt_pk_bf16_f32 v56, v56, v57
    v_cvt_pk_bf16_f32 v57, v58, v59
    v_cvt_pk_bf16_f32 v58, v60, v61
    v_cvt_pk_bf16_f32 v59, v62, v63
    v_exp_f32 v64, v64
    v_mfma_f32_16x16x32_bf16 v[180:183], v[132:135], v[168:171], v[180:183]
    global_load_dwordx4 v[132:135], v233, s[8:9] offset:-4096 sc1
    ds_read_b128 v[168:171], v4 offset:13312
    v_exp_f32 v65, v65
    v_exp_f32 v66, v66
    v_exp_f32 v67, v67
    v_mfma_f32_32x32x16_bf16 a[208:223], a[108:111], v[56:59], a[208:223]
    v_exp_f32 v68, v68
    v_exp_f32 v69, v69
    v_exp_f32 v70, v70
    v_exp_f32 v71, v71
    v_cvt_pk_bf16_f32 v64, v64, v65
    v_cvt_pk_bf16_f32 v65, v66, v67
    v_cvt_pk_bf16_f32 v66, v68, v69
    v_mfma_f32_16x16x32_bf16 v[180:183], v[136:139], v[172:175], v[180:183]
    global_load_dwordx4 v[136:139], v233, s[8:9] offset:-3072 sc1
    ds_read_b128 v[172:175], v4 offset:14336
    v_cvt_pk_bf16_f32 v67, v70, v71
    v_exp_f32 v72, v72
    v_exp_f32 v73, v73
    v_exp_f32 v74, v74
    v_exp_f32 v75, v75
    v_mfma_f32_32x32x16_bf16 a[224:239], a[104:107], v[64:67], a[224:239]
    v_exp_f32 v76, v76
    v_exp_f32 v77, v77
    v_exp_f32 v78, v78
    v_exp_f32 v79, v79
    v_cvt_pk_bf16_f32 v72, v72, v73
    v_cvt_pk_bf16_f32 v73, v74, v75
    v_cvt_pk_bf16_f32 v74, v76, v77
    v_cvt_pk_bf16_f32 v75, v78, v79
    v_mfma_f32_32x32x16_bf16 v[48:63], a[20:23], v[80:83], 0
    v_exp_f32 v16, v16
    v_exp_f32 v17, v17
    v_exp_f32 v18, v18
    v_mfma_f32_16x16x32_bf16 v[180:183], v[140:143], v[176:179], v[180:183]
    global_load_dwordx4 v[140:143], v233, s[8:9] offset:-2048 sc1
    ds_read_b128 v[176:179], v4 offset:15360
    v_exp_f32 v19, v19
    v_mfma_f32_32x32x16_bf16 a[224:239], a[108:111], v[72:75], a[224:239]
    v_exp_f32 v20, v20
    v_exp_f32 v21, v21
    v_exp_f32 v22, v22
    v_mfma_f32_32x32x16_bf16 v[64:79], a[20:23], v[84:87], 0
    v_exp_f32 v23, v23
    v_cvt_pk_bf16_f32 v16, v16, v17
    v_cvt_pk_bf16_f32 v17, v18, v19
    v_cvt_pk_bf16_f32 v18, v20, v21
    v_cvt_pk_bf16_f32 v19, v22, v23
    v_exp_f32 v24, v24
    v_exp_f32 v25, v25
    v_exp_f32 v26, v26
    v_exp_f32 v27, v27
    v_mfma_f32_32x32x16_bf16 a[208:223], a[112:115], v[16:19], a[208:223]
    v_exp_f32 v28, v28
    s_waitcnt vmcnt(6) lgkmcnt(0)
    v_exp_f32 v29, v29
    v_exp_f32 v30, v30
    v_mfma_f32_32x32x4_2b_bf16 v[48:79], a[68:69], v[88:89], v[48:79] cbsz:1 abid:1
    v_exp_f32 v31, v31
    v_cvt_pk_bf16_f32 v24, v24, v25
    v_cvt_pk_bf16_f32 v25, v26, v27
    v_cvt_pk_bf16_f32 v26, v28, v29
    v_cvt_pk_bf16_f32 v27, v30, v31
    v_exp_f32 v32, v32
    v_exp_f32 v33, v33
    v_exp_f32 v34, v34
    v_exp_f32 v35, v35
    v_exp_f32 v36, v36
    v_mfma_f32_32x32x16_bf16 a[208:223], a[116:119], v[24:27], a[208:223]
    v_exp_f32 v37, v37
    v_exp_f32 v38, v38
    v_exp_f32 v39, v39
    v_mfma_f32_16x16x32_bf16 v[180:183], v[144:147], v[168:171], v[180:183]
    global_load_dwordx4 v[144:147], v233, s[8:9] offset:-1024 sc1
    ds_read_b128 v[168:171], v4 offset:16384
    v_cvt_pk_bf16_f32 v32, v32, v33
    v_cvt_pk_bf16_f32 v33, v34, v35
    v_mfma_f32_16x16x32_bf16 v[180:183], v[148:151], v[172:175], v[180:183]
    global_load_dwordx4 v[148:151], v233, s[8:9] offset:0 sc1
    ds_read_b128 v[172:175], v4 offset:17408
    v_cvt_pk_bf16_f32 v34, v36, v37
    v_cvt_pk_bf16_f32 v35, v38, v39
    v_exp_f32 v40, v40
    v_exp_f32 v41, v41
    v_exp_f32 v42, v42
    v_exp_f32 v43, v43
    v_mfma_f32_32x32x16_bf16 a[224:239], a[112:115], v[32:35], a[224:239]
    v_exp_f32 v44, v44
    v_exp_f32 v45, v45
    v_exp_f32 v46, v46
    v_exp_f32 v47, v47
    v_cvt_pk_bf16_f32 v40, v40, v41
    v_cvt_pk_bf16_f32 v41, v42, v43
    v_cvt_pk_bf16_f32 v42, v44, v45
    v_cvt_pk_bf16_f32 v43, v46, v47
    v_mfma_f32_32x32x16_bf16 v[16:31], a[24:27], v[80:83], 0
    v_exp_f32 v48, v48
    v_exp_f32 v49, v49
    v_exp_f32 v50, v50
    v_mfma_f32_16x16x32_bf16 v[180:183], v[152:155], v[176:179], v[180:183]
    global_load_dwordx4 v[152:155], v233, s[8:9] offset:1024 sc1
    ds_read_b128 v[176:179], v4 offset:18432
    v_exp_f32 v51, v51
    v_mfma_f32_32x32x16_bf16 a[224:239], a[116:119], v[40:43], a[224:239]
    v_exp_f32 v52, v52
    v_exp_f32 v53, v53
    v_exp_f32 v54, v54
    v_mfma_f32_32x32x16_bf16 v[32:47], a[24:27], v[84:87], 0
    v_exp_f32 v55, v55
    v_cvt_pk_bf16_f32 v48, v48, v49
    v_cvt_pk_bf16_f32 v49, v50, v51
    v_cvt_pk_bf16_f32 v50, v52, v53
    v_cvt_pk_bf16_f32 v51, v54, v55
    v_exp_f32 v56, v56
    v_exp_f32 v57, v57
    v_exp_f32 v58, v58
    v_exp_f32 v59, v59
    v_mfma_f32_32x32x16_bf16 a[208:223], a[120:123], v[48:51], a[208:223]
    s_waitcnt vmcnt(6) lgkmcnt(0)
    v_exp_f32 v60, v60
    v_exp_f32 v61, v61
    v_exp_f32 v62, v62
    v_mfma_f32_32x32x4_2b_bf16 v[16:47], a[70:71], v[88:89], v[16:47] cbsz:1 abid:0
    v_exp_f32 v63, v63
    v_cvt_pk_bf16_f32 v56, v56, v57
    v_cvt_pk_bf16_f32 v57, v58, v59
    v_cvt_pk_bf16_f32 v58, v60, v61
    v_cvt_pk_bf16_f32 v59, v62, v63
    v_exp_f32 v64, v64
    v_exp_f32 v65, v65
    v_exp_f32 v66, v66
    v_exp_f32 v67, v67
    v_exp_f32 v68, v68
    v_mfma_f32_32x32x16_bf16 a[208:223], a[124:127], v[56:59], a[208:223]
    v_exp_f32 v69, v69
    v_exp_f32 v70, v70
    v_exp_f32 v71, v71
    v_mfma_f32_16x16x32_bf16 v[180:183], v[156:159], v[168:171], v[180:183]
    global_load_dwordx4 v[156:159], v233, s[8:9] offset:2048 sc1
    v_cvt_pk_bf16_f32 v64, v64, v65
    v_cvt_pk_bf16_f32 v65, v66, v67
    v_cvt_pk_bf16_f32 v66, v68, v69
    v_mfma_f32_16x16x32_bf16 v[180:183], v[160:163], v[172:175], v[180:183]
    global_load_dwordx4 v[160:163], v233, s[8:9] offset:3072 sc1
    v_cvt_pk_bf16_f32 v67, v70, v71
    v_exp_f32 v72, v72
    v_exp_f32 v73, v73
    v_exp_f32 v74, v74
    v_exp_f32 v75, v75
    v_mfma_f32_32x32x16_bf16 a[224:239], a[120:123], v[64:67], a[224:239]
    v_exp_f32 v76, v76
    v_exp_f32 v77, v77
    v_exp_f32 v78, v78
    v_exp_f32 v79, v79
    v_cvt_pk_bf16_f32 v72, v72, v73
    v_cvt_pk_bf16_f32 v73, v74, v75
    v_cvt_pk_bf16_f32 v74, v76, v77
    v_cvt_pk_bf16_f32 v75, v78, v79
    v_mfma_f32_32x32x16_bf16 v[48:63], a[28:31], v[80:83], 0
    v_exp_f32 v16, v16
    v_exp_f32 v17, v17
    v_exp_f32 v18, v18
    v_exp_f32 v19, v19
    v_mfma_f32_32x32x16_bf16 a[224:239], a[124:127], v[72:75], a[224:239]
    v_exp_f32 v20, v20
    v_exp_f32 v21, v21
    v_exp_f32 v22, v22
    v_mfma_f32_32x32x16_bf16 v[64:79], a[28:31], v[84:87], 0
    v_exp_f32 v23, v23
    v_cvt_pk_bf16_f32 v16, v16, v17
    v_cvt_pk_bf16_f32 v17, v18, v19
    v_cvt_pk_bf16_f32 v18, v20, v21
    v_cvt_pk_bf16_f32 v19, v22, v23
    v_mfma_f32_16x16x32_bf16 v[180:183], v[164:167], v[176:179], v[180:183]
    v_add_u32 v233, 8192, v233
    global_load_dwordx4 v[164:167], v233, s[8:9] offset:-4096 sc1
    v_exp_f32 v24, v24
    v_exp_f32 v25, v25
    v_mfma_f32_32x32x4_2b_bf16 v[48:79], a[70:71], v[88:89], v[48:79] cbsz:1 abid:1
    v_exp_f32 v26, v26
    v_exp_f32 v27, v27
    v_exp_f32 v28, v28
    v_exp_f32 v29, v29
    v_cvt_pk_bf16_f32 v184, v180, v181
    v_cvt_pk_bf16_f32 v185, v182, v183
    ds_write_b64 v239, v[184:185]
    v_exp_f32 v30, v30
    v_exp_f32 v31, v31
    v_mfma_f32_32x32x16_bf16 a[208:223], a[128:131], v[16:19], a[208:223]
    v_cvt_pk_bf16_f32 v24, v24, v25
    v_cvt_pk_bf16_f32 v25, v26, v27
    v_cvt_pk_bf16_f32 v26, v28, v29
    v_cvt_pk_bf16_f32 v27, v30, v31
    v_exp_f32 v32, v32
    v_exp_f32 v33, v33
    v_exp_f32 v34, v34
    v_exp_f32 v35, v35
    v_mfma_f32_32x32x16_bf16 a[208:223], a[132:135], v[24:27], a[208:223]
    v_exp_f32 v36, v36
    v_exp_f32 v37, v37
    v_exp_f32 v38, v38
    v_exp_f32 v39, v39
    v_cvt_pk_bf16_f32 v32, v32, v33
    v_cvt_pk_bf16_f32 v33, v34, v35
    v_cvt_pk_bf16_f32 v34, v36, v37
    v_cvt_pk_bf16_f32 v35, v38, v39
    v_exp_f32 v40, v40
    v_exp_f32 v41, v41
    s_waitcnt lgkmcnt(0)
    s_barrier
    ds_read_b128 v[188:191], v4 offset:44032
    v_exp_f32 v42, v42
    ds_read_b128 v[192:195], v4 offset:45056
    v_exp_f32 v43, v43
    v_mfma_f32_32x32x16_bf16 a[224:239], a[128:131], v[32:35], a[224:239]
    v_exp_f32 v44, v44
    v_exp_f32 v45, v45
    v_exp_f32 v46, v46
    v_exp_f32 v47, v47
    v_cvt_pk_bf16_f32 v40, v40, v41
    v_cvt_pk_bf16_f32 v41, v42, v43
    v_cvt_pk_bf16_f32 v42, v44, v45
    v_cvt_pk_bf16_f32 v43, v46, v47
    v_mfma_f32_32x32x16_bf16 v[16:31], a[32:35], v[80:83], 0
    v_exp_f32 v48, v48
    v_exp_f32 v49, v49
    v_exp_f32 v50, v50
    v_exp_f32 v51, v51
    v_mfma_f32_32x32x16_bf16 a[224:239], a[132:135], v[40:43], a[224:239]
    v_exp_f32 v52, v52
    v_exp_f32 v53, v53
    v_exp_f32 v54, v54
    v_mfma_f32_32x32x16_bf16 v[32:47], a[32:35], v[84:87], 0
    v_exp_f32 v55, v55
    v_cvt_pk_bf16_f32 v48, v48, v49
    v_cvt_pk_bf16_f32 v49, v50, v51
    v_cvt_pk_bf16_f32 v50, v52, v53
    v_cvt_pk_bf16_f32 v51, v54, v55
    v_exp_f32 v56, v56
    v_exp_f32 v57, v57
    v_exp_f32 v58, v58
    s_waitcnt vmcnt(6) lgkmcnt(0)
    v_exp_f32 v59, v59
    v_mfma_f32_32x32x4_2b_bf16 v[16:47], a[72:73], v[88:89], v[16:47] cbsz:1 abid:0
    v_exp_f32 v60, v60
    v_exp_f32 v61, v61
    v_exp_f32 v62, v62
    v_exp_f32 v63, v63
    v_cvt_pk_bf16_f32 v56, v56, v57
    v_cvt_pk_bf16_f32 v57, v58, v59
    v_cvt_pk_bf16_f32 v58, v60, v61
    v_cvt_pk_bf16_f32 v59, v62, v63
    v_exp_f32 v64, v64
    v_exp_f32 v65, v65
    v_mfma_f32_32x32x16_bf16 a[208:223], a[136:139], v[48:51], a[208:223]
    v_exp_f32 v66, v66
    v_exp_f32 v67, v67
    v_exp_f32 v68, v68
    v_mfma_f32_32x32x16_bf16 a[208:223], a[140:143], v[56:59], a[208:223]
    v_exp_f32 v69, v69
    v_exp_f32 v70, v70
    v_exp_f32 v71, v71
    v_mfma_f32_16x16x32_bf16 v[96:99], v[132:135], v[188:191], v[96:99]
    v_add_u32 v233, 28672, v233
    global_load_dwordx4 v[132:135], v233, s[8:9] offset:-4096 sc1
    v_cvt_pk_bf16_f32 v64, v64, v65
    v_cvt_pk_bf16_f32 v65, v66, v67
    v_cvt_pk_bf16_f32 v66, v68, v69
    v_cvt_pk_bf16_f32 v67, v70, v71
    v_exp_f32 v72, v72
    v_exp_f32 v73, v73
    v_exp_f32 v74, v74
    v_mfma_f32_16x16x32_bf16 v[100:103], v[136:139], v[188:191], v[100:103]
    global_load_dwordx4 v[136:139], v233, s[8:9] offset:-3072 sc1
    v_exp_f32 v75, v75
    v_mfma_f32_32x32x16_bf16 a[224:239], a[136:139], v[64:67], a[224:239]
    v_exp_f32 v76, v76
    v_exp_f32 v77, v77
    v_exp_f32 v78, v78
    v_exp_f32 v79, v79
    v_cvt_pk_bf16_f32 v72, v72, v73
    v_cvt_pk_bf16_f32 v73, v74, v75
    v_cvt_pk_bf16_f32 v74, v76, v77
    v_cvt_pk_bf16_f32 v75, v78, v79
    v_mfma_f32_32x32x16_bf16 v[48:63], a[36:39], v[80:83], 0
    v_exp_f32 v16, v16
    v_exp_f32 v17, v17
    v_exp_f32 v18, v18
    v_exp_f32 v19, v19
    v_mfma_f32_32x32x16_bf16 a[224:239], a[140:143], v[72:75], a[224:239]
    v_exp_f32 v20, v20
    v_exp_f32 v21, v21
    v_exp_f32 v22, v22
    v_mfma_f32_32x32x16_bf16 v[64:79], a[36:39], v[84:87], 0
    v_exp_f32 v23, v23
    v_cvt_pk_bf16_f32 v16, v16, v17
    v_cvt_pk_bf16_f32 v17, v18, v19
    v_cvt_pk_bf16_f32 v18, v20, v21
    v_cvt_pk_bf16_f32 v19, v22, v23
    v_exp_f32 v24, v24
    v_exp_f32 v25, v25
    v_mfma_f32_16x16x32_bf16 v[104:107], v[140:143], v[188:191], v[104:107]
    global_load_dwordx4 v[140:143], v233, s[8:9] offset:-2048 sc1
    v_exp_f32 v26, v26
    v_mfma_f32_32x32x4_2b_bf16 v[48:79], a[72:73], v[88:89], v[48:79] cbsz:1 abid:1
    v_exp_f32 v27, v27
    v_exp_f32 v28, v28
    v_exp_f32 v29, v29
    v_exp_f32 v30, v30
    v_exp_f32 v31, v31
    v_cvt_pk_bf16_f32 v24, v24, v25
    v_cvt_pk_bf16_f32 v25, v26, v27
    v_cvt_pk_bf16_f32 v26, v28, v29
    v_cvt_pk_bf16_f32 v27, v30, v31
    v_exp_f32 v32, v32
    v_mfma_f32_32x32x16_bf16 a[208:223], a[144:147], v[16:19], a[208:223]
    v_exp_f32 v33, v33
    v_exp_f32 v34, v34
    v_exp_f32 v35, v35
    v_mfma_f32_32x32x16_bf16 a[208:223], a[148:151], v[24:27], a[208:223]
    v_exp_f32 v36, v36
    v_exp_f32 v37, v37
    v_exp_f32 v38, v38
    v_exp_f32 v39, v39
    v_cvt_pk_bf16_f32 v32, v32, v33
    v_cvt_pk_bf16_f32 v33, v34, v35
    v_cvt_pk_bf16_f32 v34, v36, v37
    v_cvt_pk_bf16_f32 v35, v38, v39
    v_exp_f32 v40, v40
    s_waitcnt vmcnt(6)
    v_mfma_f32_16x16x32_bf16 v[108:111], v[144:147], v[188:191], v[108:111]
    global_load_dwordx4 v[144:147], v233, s[8:9] offset:-1024 sc1
    v_exp_f32 v41, v41
    v_exp_f32 v42, v42
    v_exp_f32 v43, v43
    v_mfma_f32_32x32x16_bf16 a[224:239], a[144:147], v[32:35], a[224:239]
    v_exp_f32 v44, v44
    v_exp_f32 v45, v45
    v_exp_f32 v46, v46
    v_exp_f32 v47, v47
    v_cvt_pk_bf16_f32 v40, v40, v41
    v_cvt_pk_bf16_f32 v41, v42, v43
    v_cvt_pk_bf16_f32 v42, v44, v45
    v_cvt_pk_bf16_f32 v43, v46, v47
    v_mfma_f32_32x32x16_bf16 v[16:31], a[40:43], v[80:83], 0
    v_exp_f32 v48, v48
    v_exp_f32 v49, v49
    v_exp_f32 v50, v50
    v_exp_f32 v51, v51
    v_mfma_f32_32x32x16_bf16 a[224:239], a[148:151], v[40:43], a[224:239]
    v_exp_f32 v52, v52
    v_exp_f32 v53, v53
    v_exp_f32 v54, v54
    v_mfma_f32_32x32x16_bf16 v[32:47], a[40:43], v[84:87], 0
    v_exp_f32 v55, v55
    v_cvt_pk_bf16_f32 v48, v48, v49
    v_cvt_pk_bf16_f32 v49, v50, v51
    v_cvt_pk_bf16_f32 v50, v52, v53
    v_cvt_pk_bf16_f32 v51, v54, v55
    v_mfma_f32_16x16x32_bf16 v[112:115], v[148:151], v[188:191], v[112:115]
    global_load_dwordx4 v[148:151], v233, s[8:9] offset:0 sc1
    v_exp_f32 v56, v56
    v_exp_f32 v57, v57
    v_exp_f32 v58, v58
    v_mfma_f32_32x32x4_2b_bf16 v[16:47], a[74:75], v[88:89], v[16:47] cbsz:1 abid:0
    v_exp_f32 v59, v59
    v_exp_f32 v60, v60
    v_exp_f32 v61, v61
    v_exp_f32 v62, v62
    v_exp_f32 v63, v63
    v_cvt_pk_bf16_f32 v56, v56, v57
    v_cvt_pk_bf16_f32 v57, v58, v59
    v_cvt_pk_bf16_f32 v58, v60, v61
    v_cvt_pk_bf16_f32 v59, v62, v63
    v_exp_f32 v64, v64
    v_mfma_f32_32x32x16_bf16 a[208:223], a[152:155], v[48:51], a[208:223]
    v_exp_f32 v65, v65
    v_exp_f32 v66, v66
    v_exp_f32 v67, v67
    v_mfma_f32_32x32x16_bf16 a[208:223], a[156:159], v[56:59], a[208:223]
    v_exp_f32 v68, v68
    v_exp_f32 v69, v69
    v_exp_f32 v70, v70
    v_exp_f32 v71, v71
    v_cvt_pk_bf16_f32 v64, v64, v65
    v_cvt_pk_bf16_f32 v65, v66, v67
    v_cvt_pk_bf16_f32 v66, v68, v69
    v_mfma_f32_16x16x32_bf16 v[116:119], v[152:155], v[188:191], v[116:119]
    global_load_dwordx4 v[152:155], v233, s[8:9] offset:1024 sc1
    v_cvt_pk_bf16_f32 v67, v70, v71
    v_exp_f32 v72, v72
    v_exp_f32 v73, v73
    v_exp_f32 v74, v74
    v_exp_f32 v75, v75
    v_mfma_f32_32x32x16_bf16 a[224:239], a[152:155], v[64:67], a[224:239]
    v_exp_f32 v76, v76
    v_exp_f32 v77, v77
    v_exp_f32 v78, v78
    v_exp_f32 v79, v79
    v_cvt_pk_bf16_f32 v72, v72, v73
    v_cvt_pk_bf16_f32 v73, v74, v75
    v_cvt_pk_bf16_f32 v74, v76, v77
    v_cvt_pk_bf16_f32 v75, v78, v79
    v_mfma_f32_32x32x16_bf16 v[48:63], a[44:47], v[80:83], 0
    v_exp_f32 v16, v16
    v_exp_f32 v17, v17
    v_exp_f32 v18, v18
    v_exp_f32 v19, v19
    v_mfma_f32_32x32x16_bf16 a[224:239], a[156:159], v[72:75], a[224:239]
    v_exp_f32 v20, v20
    v_exp_f32 v21, v21
    v_exp_f32 v22, v22
    v_mfma_f32_32x32x16_bf16 v[64:79], a[44:47], v[84:87], 0
    s_waitcnt vmcnt(6)
    v_exp_f32 v23, v23
    v_cvt_pk_bf16_f32 v16, v16, v17
    v_cvt_pk_bf16_f32 v17, v18, v19
    v_cvt_pk_bf16_f32 v18, v20, v21
    v_mfma_f32_16x16x32_bf16 v[120:123], v[156:159], v[188:191], v[120:123]
    global_load_dwordx4 v[156:159], v233, s[8:9] offset:2048 sc1
    v_cvt_pk_bf16_f32 v19, v22, v23
    v_exp_f32 v24, v24
    v_exp_f32 v25, v25
    v_mfma_f32_32x32x4_2b_bf16 v[48:79], a[74:75], v[88:89], v[48:79] cbsz:1 abid:1
    v_exp_f32 v26, v26
    v_exp_f32 v27, v27
    v_exp_f32 v28, v28
    v_exp_f32 v29, v29
    v_exp_f32 v30, v30
    v_exp_f32 v31, v31
    v_cvt_pk_bf16_f32 v24, v24, v25
    v_cvt_pk_bf16_f32 v25, v26, v27
    v_cvt_pk_bf16_f32 v26, v28, v29
    v_mfma_f32_32x32x16_bf16 a[208:223], a[160:163], v[16:19], a[208:223]
    v_cvt_pk_bf16_f32 v27, v30, v31
    v_exp_f32 v32, v32
    v_exp_f32 v33, v33
    v_exp_f32 v34, v34
    v_exp_f32 v35, v35
    v_mfma_f32_32x32x16_bf16 a[208:223], a[164:167], v[24:27], a[208:223]
    v_exp_f32 v36, v36
    v_exp_f32 v37, v37
    v_exp_f32 v38, v38
    v_exp_f32 v39, v39
    v_mfma_f32_16x16x32_bf16 v[124:127], v[160:163], v[188:191], v[124:127]
    global_load_dwordx4 v[160:163], v233, s[8:9] offset:3072 sc1
    v_cvt_pk_bf16_f32 v32, v32, v33
    v_cvt_pk_bf16_f32 v33, v34, v35
    v_cvt_pk_bf16_f32 v34, v36, v37
    v_cvt_pk_bf16_f32 v35, v38, v39
    v_exp_f32 v40, v40
    v_exp_f32 v41, v41
    v_exp_f32 v42, v42
    v_exp_f32 v43, v43
    v_mfma_f32_32x32x16_bf16 a[224:239], a[160:163], v[32:35], a[224:239]
    v_exp_f32 v44, v44
    v_exp_f32 v45, v45
    v_exp_f32 v46, v46
    v_exp_f32 v47, v47
    v_cvt_pk_bf16_f32 v40, v40, v41
    v_cvt_pk_bf16_f32 v41, v42, v43
    v_cvt_pk_bf16_f32 v42, v44, v45
    v_cvt_pk_bf16_f32 v43, v46, v47
    v_mfma_f32_32x32x16_bf16 v[16:31], a[48:51], v[80:83], 0
    v_exp_f32 v48, v48
    v_exp_f32 v49, v49
    v_exp_f32 v50, v50
    v_exp_f32 v51, v51
    v_mfma_f32_32x32x16_bf16 a[224:239], a[164:167], v[40:43], a[224:239]
    v_exp_f32 v52, v52
    v_exp_f32 v53, v53
    v_exp_f32 v54, v54
    v_mfma_f32_32x32x16_bf16 v[32:47], a[48:51], v[84:87], 0
    v_exp_f32 v55, v55
    v_cvt_pk_bf16_f32 v48, v48, v49
    v_cvt_pk_bf16_f32 v49, v50, v51
    v_cvt_pk_bf16_f32 v50, v52, v53
    v_cvt_pk_bf16_f32 v51, v54, v55
    v_mfma_f32_16x16x32_bf16 v[128:131], v[164:167], v[188:191], v[128:131]
    v_add_u32 v233, 8192, v233
    global_load_dwordx4 v[164:167], v233, s[8:9] offset:-4096 sc1
    v_exp_f32 v56, v56
    v_add_u32 v233, 28672, v233
    v_mfma_f32_32x32x4_2b_bf16 v[16:47], a[76:77], v[88:89], v[16:47] cbsz:1 abid:0
    v_exp_f32 v57, v57
    v_exp_f32 v58, v58
    v_exp_f32 v59, v59
    v_exp_f32 v60, v60
    v_exp_f32 v61, v61
    v_exp_f32 v62, v62
    v_exp_f32 v63, v63
    v_cvt_pk_bf16_f32 v56, v56, v57
    v_mfma_f32_32x32x16_bf16 a[208:223], a[168:171], v[48:51], a[208:223]
    v_cvt_pk_bf16_f32 v57, v58, v59
    v_cvt_pk_bf16_f32 v58, v60, v61
    v_cvt_pk_bf16_f32 v59, v62, v63
    v_exp_f32 v64, v64
    v_exp_f32 v65, v65
    v_exp_f32 v66, v66
    v_exp_f32 v67, v67
    v_mfma_f32_32x32x16_bf16 a[208:223], a[172:175], v[56:59], a[208:223]
    s_waitcnt vmcnt(6)
    v_exp_f32 v68, v68
    v_exp_f32 v69, v69
    v_exp_f32 v70, v70
    v_mfma_f32_16x16x32_bf16 v[96:99], v[132:135], v[192:195], v[96:99]
    global_load_dwordx4 v[132:135], v232, s[8:9] offset:-4096 sc1
    v_exp_f32 v71, v71
    v_cvt_pk_bf16_f32 v64, v64, v65
    v_cvt_pk_bf16_f32 v65, v66, v67
    v_cvt_pk_bf16_f32 v66, v68, v69
    v_cvt_pk_bf16_f32 v67, v70, v71
    v_exp_f32 v72, v72
    v_exp_f32 v73, v73
    v_exp_f32 v74, v74
    v_exp_f32 v75, v75
    v_mfma_f32_32x32x16_bf16 a[224:239], a[168:171], v[64:67], a[224:239]
    v_exp_f32 v76, v76
    v_exp_f32 v77, v77
    v_exp_f32 v78, v78
    v_exp_f32 v79, v79
    v_cvt_pk_bf16_f32 v72, v72, v73
    v_cvt_pk_bf16_f32 v73, v74, v75
    v_cvt_pk_bf16_f32 v74, v76, v77
    v_cvt_pk_bf16_f32 v75, v78, v79
    v_mfma_f32_32x32x16_bf16 v[48:63], a[52:55], v[80:83], 0
    v_exp_f32 v16, v16
    v_exp_f32 v17, v17
    v_exp_f32 v18, v18
    v_exp_f32 v19, v19
    v_mfma_f32_32x32x16_bf16 a[224:239], a[172:175], v[72:75], a[224:239]
    v_exp_f32 v20, v20
    v_exp_f32 v21, v21
    v_exp_f32 v22, v22
    v_mfma_f32_32x32x16_bf16 v[64:79], a[52:55], v[84:87], 0
    v_exp_f32 v23, v23
    v_cvt_pk_bf16_f32 v16, v16, v17
    v_cvt_pk_bf16_f32 v17, v18, v19
    v_cvt_pk_bf16_f32 v18, v20, v21
    v_cvt_pk_bf16_f32 v19, v22, v23
    v_mfma_f32_16x16x32_bf16 v[100:103], v[136:139], v[192:195], v[100:103]
    global_load_dwordx4 v[136:139], v232, s[8:9] offset:-3072 sc1
    v_exp_f32 v24, v24
    v_exp_f32 v25, v25
    v_exp_f32 v26, v26
    v_mfma_f32_32x32x4_2b_bf16 v[48:79], a[76:77], v[88:89], v[48:79] cbsz:1 abid:1
    v_exp_f32 v27, v27
    v_exp_f32 v28, v28
    v_exp_f32 v29, v29
    v_exp_f32 v30, v30
    v_exp_f32 v31, v31
    v_cvt_pk_bf16_f32 v24, v24, v25
    v_cvt_pk_bf16_f32 v25, v26, v27
    v_cvt_pk_bf16_f32 v26, v28, v29
    v_cvt_pk_bf16_f32 v27, v30, v31
    v_exp_f32 v32, v32
    v_mfma_f32_32x32x16_bf16 a[208:223], a[176:179], v[16:19], a[208:223]
    v_exp_f32 v33, v33
    v_exp_f32 v34, v34
    v_exp_f32 v35, v35
    v_mfma_f32_32x32x16_bf16 a[208:223], a[180:183], v[24:27], a[208:223]
    v_exp_f32 v36, v36
    v_exp_f32 v37, v37
    v_exp_f32 v38, v38
    v_mfma_f32_16x16x32_bf16 v[104:107], v[140:143], v[192:195], v[104:107]
    global_load_dwordx4 v[140:143], v232, s[8:9] offset:-2048 sc1
    v_exp_f32 v39, v39
    v_cvt_pk_bf16_f32 v32, v32, v33
    v_cvt_pk_bf16_f32 v33, v34, v35
    v_cvt_pk_bf16_f32 v34, v36, v37
    v_cvt_pk_bf16_f32 v35, v38, v39
    v_exp_f32 v40, v40
    v_exp_f32 v41, v41
    v_exp_f32 v42, v42
    v_exp_f32 v43, v43
    v_mfma_f32_32x32x16_bf16 a[224:239], a[176:179], v[32:35], a[224:239]
    v_exp_f32 v44, v44
    v_exp_f32 v45, v45
    v_exp_f32 v46, v46
    v_exp_f32 v47, v47
    v_cvt_pk_bf16_f32 v40, v40, v41
    v_cvt_pk_bf16_f32 v41, v42, v43
    v_cvt_pk_bf16_f32 v42, v44, v45
    v_cvt_pk_bf16_f32 v43, v46, v47
    v_mfma_f32_32x32x16_bf16 v[16:31], a[56:59], v[80:83], 0
    v_exp_f32 v48, v48
    v_exp_f32 v49, v49
    v_exp_f32 v50, v50
    s_waitcnt vmcnt(6)
    v_exp_f32 v51, v51
    v_mfma_f32_32x32x16_bf16 a[224:239], a[180:183], v[40:43], a[224:239]
    v_exp_f32 v52, v52
    v_exp_f32 v53, v53
    v_exp_f32 v54, v54
    v_mfma_f32_32x32x16_bf16 v[32:47], a[56:59], v[84:87], 0
    v_exp_f32 v55, v55
    v_cvt_pk_bf16_f32 v48, v48, v49
    v_cvt_pk_bf16_f32 v49, v50, v51
    v_cvt_pk_bf16_f32 v50, v52, v53
    v_cvt_pk_bf16_f32 v51, v54, v55
    v_mfma_f32_16x16x32_bf16 v[108:111], v[144:147], v[192:195], v[108:111]
    global_load_dwordx4 v[144:147], v232, s[8:9] offset:-1024 sc1
    v_exp_f32 v56, v56
    v_exp_f32 v57, v57
    v_exp_f32 v58, v58
    v_mfma_f32_32x32x4_2b_bf16 v[16:47], a[78:79], v[88:89], v[16:47] cbsz:1 abid:0
    v_exp_f32 v59, v59
    v_exp_f32 v60, v60
    v_exp_f32 v61, v61
    v_exp_f32 v62, v62
    v_exp_f32 v63, v63
    v_cvt_pk_bf16_f32 v56, v56, v57
    v_cvt_pk_bf16_f32 v57, v58, v59
    v_cvt_pk_bf16_f32 v58, v60, v61
    v_cvt_pk_bf16_f32 v59, v62, v63
    v_exp_f32 v64, v64
    v_mfma_f32_32x32x16_bf16 a[208:223], a[184:187], v[48:51], a[208:223]
    v_exp_f32 v65, v65
    v_exp_f32 v66, v66
    v_exp_f32 v67, v67
    v_mfma_f32_32x32x16_bf16 a[208:223], a[188:191], v[56:59], a[208:223]
    v_exp_f32 v68, v68
    v_exp_f32 v69, v69
    v_exp_f32 v70, v70
    v_mfma_f32_16x16x32_bf16 v[112:115], v[148:151], v[192:195], v[112:115]
    global_load_dwordx4 v[148:151], v232, s[8:9] offset:0 sc1
    v_exp_f32 v71, v71
    v_cvt_pk_bf16_f32 v64, v64, v65
    v_cvt_pk_bf16_f32 v65, v66, v67
    v_cvt_pk_bf16_f32 v66, v68, v69
    v_cvt_pk_bf16_f32 v67, v70, v71
    v_exp_f32 v72, v72
    v_exp_f32 v73, v73
    v_exp_f32 v74, v74
    v_exp_f32 v75, v75
    v_mfma_f32_32x32x16_bf16 a[224:239], a[184:187], v[64:67], a[224:239]
    v_exp_f32 v76, v76
    v_exp_f32 v77, v77
    v_exp_f32 v78, v78
    v_exp_f32 v79, v79
    v_cvt_pk_bf16_f32 v72, v72, v73
    v_cvt_pk_bf16_f32 v73, v74, v75
    v_cvt_pk_bf16_f32 v74, v76, v77
    v_cvt_pk_bf16_f32 v75, v78, v79
    v_mfma_f32_32x32x16_bf16 v[48:63], a[60:63], v[80:83], 0
    v_exp_f32 v16, v16
    v_exp_f32 v17, v17
    v_exp_f32 v18, v18
    v_mfma_f32_16x16x32_bf16 v[116:119], v[152:155], v[192:195], v[116:119]
    global_load_dwordx4 v[152:155], v232, s[8:9] offset:1024 sc1
    v_exp_f32 v19, v19
    v_mfma_f32_32x32x16_bf16 a[224:239], a[188:191], v[72:75], a[224:239]
    v_exp_f32 v20, v20
    v_exp_f32 v21, v21
    v_exp_f32 v22, v22
    v_mfma_f32_32x32x16_bf16 v[64:79], a[60:63], v[84:87], 0
    v_exp_f32 v23, v23
    v_cvt_pk_bf16_f32 v16, v16, v17
    v_cvt_pk_bf16_f32 v17, v18, v19
    v_cvt_pk_bf16_f32 v18, v20, v21
    v_cvt_pk_bf16_f32 v19, v22, v23
    v_exp_f32 v24, v24
    v_exp_f32 v25, v25
    v_exp_f32 v26, v26
    v_exp_f32 v27, v27
    v_mfma_f32_32x32x16_bf16 a[208:223], a[192:195], v[16:19], a[208:223]
    v_exp_f32 v28, v28
    v_exp_f32 v29, v29
    v_exp_f32 v30, v30
    v_mfma_f32_32x32x4_2b_bf16 v[48:79], a[78:79], v[88:89], v[48:79] cbsz:1 abid:1
    ds_read_b128 v[80:83], v241
    ds_read_b128 v[84:87], v241 offset:1024
    v_add_u32 v240, 256, v240
    ds_read_b32 v88, v240
    s_waitcnt vmcnt(6)
    v_exp_f32 v31, v31
    v_cvt_pk_bf16_f32 v24, v24, v25
    v_cvt_pk_bf16_f32 v25, v26, v27
    v_cvt_pk_bf16_f32 v26, v28, v29
    v_cvt_pk_bf16_f32 v27, v30, v31
    v_exp_f32 v32, v32
    v_mfma_f32_16x16x32_bf16 v[120:123], v[156:159], v[192:195], v[120:123]
    global_load_dwordx4 v[156:159], v232, s[8:9] offset:2048 sc1
    v_exp_f32 v33, v33
    v_exp_f32 v34, v34
    v_exp_f32 v35, v35
    v_mfma_f32_32x32x16_bf16 a[208:223], a[196:199], v[24:27], a[208:223]
    v_exp_f32 v36, v36
    v_exp_f32 v37, v37
    v_exp_f32 v38, v38
    v_exp_f32 v39, v39
    v_cvt_pk_bf16_f32 v32, v32, v33
    v_cvt_pk_bf16_f32 v33, v34, v35
    v_cvt_pk_bf16_f32 v34, v36, v37
    v_cvt_pk_bf16_f32 v35, v38, v39
    v_exp_f32 v40, v40
    v_exp_f32 v41, v41
    v_exp_f32 v42, v42
    v_exp_f32 v43, v43
    v_mfma_f32_32x32x16_bf16 a[224:239], a[192:195], v[32:35], a[224:239]
    v_exp_f32 v44, v44
    v_exp_f32 v45, v45
    v_exp_f32 v46, v46
    v_mfma_f32_16x16x32_bf16 v[124:127], v[160:163], v[192:195], v[124:127]
    global_load_dwordx4 v[160:163], v232, s[8:9] offset:3072 sc1
    v_exp_f32 v47, v47
    v_cvt_pk_bf16_f32 v40, v40, v41
    v_cvt_pk_bf16_f32 v41, v42, v43
    v_cvt_pk_bf16_f32 v42, v44, v45
    v_cvt_pk_bf16_f32 v43, v46, v47
    s_waitcnt lgkmcnt(2)
    v_mfma_f32_32x32x16_bf16 v[16:31], a[0:3], v[80:83], 0
    v_exp_f32 v48, v48
    v_exp_f32 v49, v49
    v_exp_f32 v50, v50
    v_exp_f32 v51, v51
    v_mfma_f32_32x32x16_bf16 a[224:239], a[196:199], v[40:43], a[224:239]
    v_exp_f32 v52, v52
    v_exp_f32 v53, v53
    v_exp_f32 v54, v54
    s_waitcnt lgkmcnt(1)
    v_mfma_f32_32x32x16_bf16 v[32:47], a[0:3], v[84:87], 0
    v_exp_f32 v55, v55
    v_cvt_pk_bf16_f32 v48, v48, v49
    v_cvt_pk_bf16_f32 v49, v50, v51
    v_cvt_pk_bf16_f32 v50, v52, v53
    v_cvt_pk_bf16_f32 v51, v54, v55
    v_exp_f32 v56, v56
    v_exp_f32 v57, v57
    v_exp_f32 v58, v58
    v_exp_f32 v59, v59
    v_mfma_f32_32x32x16_bf16 a[208:223], a[200:203], v[48:51], a[208:223]
    v_exp_f32 v60, v60
    v_exp_f32 v61, v61
    v_exp_f32 v62, v62
    s_waitcnt lgkmcnt(0)
    v_mfma_f32_32x32x4_2b_bf16 v[16:47], a[64:65], v[88:89], v[16:47] cbsz:1 abid:0
    v_exp_f32 v63, v63
    v_cvt_pk_bf16_f32 v56, v56, v57
    v_cvt_pk_bf16_f32 v57, v58, v59
    v_cvt_pk_bf16_f32 v58, v60, v61
    v_cvt_pk_bf16_f32 v59, v62, v63
    v_exp_f32 v64, v64
    v_exp_f32 v65, v65
    v_exp_f32 v66, v66
    v_exp_f32 v67, v67
    v_exp_f32 v68, v68
    v_mfma_f32_32x32x16_bf16 a[208:223], a[204:207], v[56:59], a[208:223]
    v_exp_f32 v69, v69
    v_exp_f32 v70, v70
    v_exp_f32 v71, v71
    v_mfma_f32_16x16x32_bf16 v[128:131], v[164:167], v[192:195], v[128:131]
    v_add_u32 v232, 8192, v232
    global_load_dwordx4 v[164:167], v232, s[8:9] offset:-4096 sc1
    v_cvt_pk_bf16_f32 v64, v64, v65
    v_cvt_pk_bf16_f32 v65, v66, v67
    v_cvt_pk_bf16_f32 v66, v68, v69
    v_cvt_pk_bf16_f32 v67, v70, v71
    v_exp_f32 v72, v72
    v_exp_f32 v73, v73
    v_exp_f32 v74, v74
    v_exp_f32 v75, v75
    v_mfma_f32_32x32x16_bf16 a[224:239], a[200:203], v[64:67], a[224:239]
    v_exp_f32 v76, v76
    v_exp_f32 v77, v77
    v_exp_f32 v78, v78
    v_exp_f32 v79, v79
    v_cvt_pk_bf16_f32 v72, v72, v73
    v_cvt_pk_bf16_f32 v73, v74, v75
    v_cvt_pk_bf16_f32 v74, v76, v77
    v_cvt_pk_bf16_f32 v75, v78, v79
    s_add_u32 s82, s82, 1
    s_cmp_lt_u32 s82, 3
    s_cbranch_scc1 interleave_layers__grouped_kv_mqa__ssm_conv_h3__prompt_kernel_at_ph
    s_lshl_b32 s28, s4, 13
    s_add_u32 s28, s28, 0x2808000
    v_lshlrev_b32 v248, 7, v1
    v_add_u32 v248, s28, v248
    global_load_dword v247, v248, s[8:9] sc1
    s_mul_i32 s28, s4, 589824
    s_lshl_b32 s29, s5, 5
    s_add_u32 s28, s28, s29
    s_add_u32 s28, s28, 0x200000
    v_lshlrev_b32 v254, 14, v3
    v_lshl_add_u32 v254, v2, 1, v254
    v_add_u32 v254, s28, v254
    .p2align 3
    s_nop 0
    v_mfma_f32_32x32x16_bf16 v[48:63], a[4:7], v[80:83], 0
    ds_write_b128 v234, a[208:211] offset:0
    ds_write_b128 v234, a[212:215] offset:1024
    ds_write_b128 v234, a[216:219] offset:2048
    v_exp_f32 v16, v16
    v_exp_f32 v17, v17
    v_exp_f32 v18, v18
    v_exp_f32 v19, v19
    v_mfma_f32_32x32x16_bf16 a[224:239], a[204:207], v[72:75], a[224:239]
    v_exp_f32 v20, v20
    v_exp_f32 v21, v21
    v_exp_f32 v22, v22
    v_mfma_f32_32x32x16_bf16 v[64:79], a[4:7], v[84:87], 0
    v_exp_f32 v23, v23
    v_cvt_pk_bf16_f32 v16, v16, v17
    v_cvt_pk_bf16_f32 v17, v18, v19
    v_cvt_pk_bf16_f32 v18, v20, v21
    v_cvt_pk_bf16_f32 v19, v22, v23
    v_exp_f32 v24, v24
    v_exp_f32 v25, v25
    v_exp_f32 v26, v26
    v_exp_f32 v27, v27
    v_mfma_f32_32x32x16_bf16 a[208:223], a[80:83], v[16:19], 0
    ds_write_b128 v234, a[224:227] offset:3072
    ds_write_b128 v234, a[228:231] offset:4096
    v_mfma_f32_32x32x4_2b_bf16 v[48:79], a[64:65], v[88:89], v[48:79] cbsz:1 abid:1
    ds_write_b128 v234, a[232:235] offset:5120
    v_exp_f32 v28, v28
    s_waitcnt vmcnt(9)
    global_load_dwordx4 v[132:135], v233, s[8:9] offset:-4096 sc1
    s_waitcnt vmcnt(9)
    global_load_dwordx4 v[136:139], v233, s[8:9] offset:-3072 sc1
    s_waitcnt vmcnt(9)
    global_load_dwordx4 v[140:143], v233, s[8:9] offset:-2048 sc1
    v_exp_f32 v29, v29
    s_waitcnt vmcnt(9)
    global_load_dwordx4 v[144:147], v233, s[8:9] offset:-1024 sc1
    s_waitcnt vmcnt(9)
    global_load_dwordx4 v[148:151], v233, s[8:9] offset:0 sc1
    s_waitcnt vmcnt(9)
    global_load_dwordx4 v[152:155], v233, s[8:9] offset:1024 sc1
    v_exp_f32 v30, v30
    s_waitcnt vmcnt(9)
    global_load_dwordx4 v[156:159], v233, s[8:9] offset:2048 sc1
    s_waitcnt vmcnt(9)
    global_load_dwordx4 v[160:163], v233, s[8:9] offset:3072 sc1
    v_add_u32 v233, 8192, v233
    v_exp_f32 v31, v31
    s_waitcnt vmcnt(9)
    global_load_dwordx4 v[164:167], v233, s[8:9] offset:-4096 sc1
    v_cvt_pk_bf16_f32 v24, v24, v25
    v_cvt_pk_bf16_f32 v25, v26, v27
    v_cvt_pk_bf16_f32 v26, v28, v29
    v_cvt_pk_bf16_f32 v27, v30, v31
    v_exp_f32 v32, v32
    v_exp_f32 v33, v33
    v_exp_f32 v34, v34
    v_exp_f32 v35, v35
    v_mfma_f32_32x32x16_bf16 a[208:223], a[84:87], v[24:27], a[208:223]
    v_exp_f32 v36, v36
    v_exp_f32 v37, v37
    v_exp_f32 v38, v38
    v_exp_f32 v39, v39
    v_cvt_pk_bf16_f32 v32, v32, v33
    v_cvt_pk_bf16_f32 v33, v34, v35
    v_cvt_pk_bf16_f32 v34, v36, v37
    v_cvt_pk_bf16_f32 v35, v38, v39
    v_exp_f32 v40, v40
    v_exp_f32 v41, v41
    v_exp_f32 v42, v42
    v_exp_f32 v43, v43
    v_mfma_f32_32x32x16_bf16 a[224:239], a[80:83], v[32:35], 0
    v_exp_f32 v44, v44
    v_exp_f32 v45, v45
    v_exp_f32 v46, v46
    v_exp_f32 v47, v47
    v_cvt_pk_bf16_f32 v40, v40, v41
    v_cvt_pk_bf16_f32 v41, v42, v43
    v_cvt_pk_bf16_f32 v42, v44, v45
    v_cvt_pk_bf16_f32 v43, v46, v47
    v_mfma_f32_32x32x16_bf16 v[16:31], a[8:11], v[80:83], 0
    v_exp_f32 v48, v48
    v_exp_f32 v49, v49
    v_exp_f32 v50, v50
    v_exp_f32 v51, v51
    v_mfma_f32_32x32x16_bf16 a[224:239], a[84:87], v[40:43], a[224:239]
    v_exp_f32 v52, v52
    v_exp_f32 v53, v53
    v_exp_f32 v54, v54
    v_mfma_f32_32x32x16_bf16 v[32:47], a[8:11], v[84:87], 0
    v_exp_f32 v55, v55
    v_cvt_pk_bf16_f32 v48, v48, v49
    v_cvt_pk_bf16_f32 v49, v50, v51
    v_cvt_pk_bf16_f32 v50, v52, v53
    s_waitcnt lgkmcnt(0)
    s_barrier
    ds_read_b128 v[216:219], v236 offset:0
    v_cvt_pk_bf16_f32 v51, v54, v55
    ds_read_b128 v[220:223], v236 offset:6144
    ds_read_b128 v[224:227], v236 offset:12288
    v_mfma_f32_32x32x4_2b_bf16 v[16:47], a[66:67], v[88:89], v[16:47] cbsz:1 abid:0
    ds_read_b128 v[228:231], v236 offset:18432
    v_exp_f32 v56, v56
    ds_read_b128 v[200:203], v235 offset:0
    ds_read_b128 v[204:207], v235 offset:6144
    ds_read_b128 v[208:211], v235 offset:12288
    v_exp_f32 v57, v57
    ds_read_b128 v[212:215], v235 offset:18432
    v_exp_f32 v58, v58
    v_exp_f32 v59, v59
    v_mfma_f32_32x32x16_bf16 a[208:223], a[88:91], v[48:51], a[208:223]
    v_exp_f32 v60, v60
    v_exp_f32 v61, v61
    v_exp_f32 v62, v62
    v_exp_f32 v63, v63
    v_cvt_pk_bf16_f32 v56, v56, v57
    v_cvt_pk_bf16_f32 v57, v58, v59
    v_cvt_pk_bf16_f32 v58, v60, v61
    v_cvt_pk_bf16_f32 v59, v62, v63
    v_exp_f32 v64, v64
    v_exp_f32 v65, v65
    v_exp_f32 v66, v66
    v_exp_f32 v67, v67
    v_mfma_f32_32x32x16_bf16 a[208:223], a[92:95], v[56:59], a[208:223]
    v_exp_f32 v68, v68
    v_exp_f32 v69, v69
    v_exp_f32 v70, v70
    v_exp_f32 v71, v71
    v_cvt_pk_bf16_f32 v64, v64, v65
    v_cvt_pk_bf16_f32 v65, v66, v67
    v_cvt_pk_bf16_f32 v66, v68, v69
    v_cvt_pk_bf16_f32 v67, v70, v71
    v_exp_f32 v72, v72
    v_exp_f32 v73, v73
    v_exp_f32 v74, v74
    v_exp_f32 v75, v75
    v_mfma_f32_32x32x16_bf16 a[224:239], a[88:91], v[64:67], a[224:239]
    v_exp_f32 v76, v76
    v_exp_f32 v77, v77
    v_exp_f32 v78, v78
    v_exp_f32 v79, v79
    v_cvt_pk_bf16_f32 v72, v72, v73
    v_cvt_pk_bf16_f32 v73, v74, v75
    v_cvt_pk_bf16_f32 v74, v76, v77
    v_cvt_pk_bf16_f32 v75, v78, v79
    v_mfma_f32_32x32x16_bf16 v[48:63], a[12:15], v[80:83], 0
    v_exp_f32 v16, v16
    s_waitcnt lgkmcnt(0)
    v_pk_add_f32 v[216:217], v[216:217], v[220:221]
    v_pk_add_f32 v[224:225], v[224:225], v[228:229]
    v_exp_f32 v17, v17
    v_add_f32 v218, v218, v222
    v_add_f32 v226, v226, v230
    v_pk_add_f32 v[216:217], v[216:217], v[224:225]
    v_exp_f32 v18, v18
    v_add_f32 v218, v218, v226
    v_rcp_f32 v242, v218
    v_subrev_u32 v243, 0x1f800000, v218
    v_exp_f32 v19, v19
    v_mfma_f32_32x32x16_bf16 a[224:239], a[92:95], v[72:75], a[224:239]
    v_cmp_le_u32 vcc, 0x40000000, v243
    v_pk_add_f32 v[200:201], v[200:201], v[204:205]
    v_pk_add_f32 v[208:209], v[208:209], v[212:213]
    v_exp_f32 v20, v20
    v_pk_add_f32 v[202:203], v[202:203], v[206:207]
    v_mfma_f32_32x32x16_bf16 v[64:79], a[12:15], v[84:87], 0
    v_pk_add_f32 v[210:211], v[210:211], v[214:215]
    s_or_b64 s[84:85], s[84:85], vcc
    v_exp_f32 v21, v21
    v_pk_add_f32 v[200:201], v[200:201], v[208:209]
    v_pk_add_f32 v[202:203], v[202:203], v[210:211]
    v_pk_mul_f32 v[216:217], v[216:217], v[242:243] op_sel_hi:[1,0]
    v_exp_f32 v22, v22
    v_pk_mul_f32 v[200:201], v[200:201], v[242:243] op_sel_hi:[1,0]
    v_pk_mul_f32 v[202:203], v[202:203], v[242:243] op_sel_hi:[1,0]
    v_cvt_pk_bf16_f32 v220, v216, v217
    v_mfma_f32_32x32x4_2b_bf16 v[48:79], a[66:67], v[88:89], v[48:79] cbsz:1 abid:1
    v_exp_f32 v23, v23
    v_cvt_pk_bf16_f32 v204, v200, v201
    v_cvt_pk_bf16_f32 v205, v202, v203
    ds_write_b32 v238, v220
    v_cvt_pk_bf16_f32 v16, v16, v17
    ds_write_b64 v237, v[204:205]
    v_add_u32 v238, 256, v238
    s_waitcnt vmcnt(9)
    v_cmp_ne_u32 vcc, s86, v247
    s_nop 0
    s_cbranch_vccz L_yf14
    s_mov_b32 s29, 0
L_pl15:
    global_load_dword v6, v248, s[8:9] sc1
    s_add_u32 s29, s29, 1
    s_waitcnt vmcnt(0)
    v_cmp_ne_u32 vcc, s86, v6
    s_cmp_gt_u32 s29, 400000
    s_cbranch_scc1 L_pl15_x
    s_cbranch_vccz L_pl15_x
    s_sleep 3
    s_branch L_pl15
L_pl15_x:
L_yf14:
    v_cvt_pk_bf16_f32 v17, v18, v19
    v_cvt_pk_bf16_f32 v18, v20, v21
    v_cvt_pk_bf16_f32 v19, v22, v23
    v_exp_f32 v24, v24
    v_exp_f32 v25, v25
    v_exp_f32 v26, v26
    v_exp_f32 v27, v27
    v_mfma_f32_32x32x16_bf16 a[208:223], a[96:99], v[16:19], a[208:223]
    v_exp_f32 v28, v28
    v_exp_f32 v29, v29
    v_exp_f32 v30, v30
    v_exp_f32 v31, v31
    v_cvt_pk_bf16_f32 v24, v24, v25
    v_cvt_pk_bf16_f32 v25, v26, v27
    v_cvt_pk_bf16_f32 v26, v28, v29
    v_cvt_pk_bf16_f32 v27, v30, v31
    v_exp_f32 v32, v32
    v_exp_f32 v33, v33
    v_exp_f32 v34, v34
    v_exp_f32 v35, v35
    v_mfma_f32_32x32x16_bf16 a[208:223], a[100:103], v[24:27], a[208:223]
    v_exp_f32 v36, v36
    s_waitcnt lgkmcnt(0)
    s_barrier
    ds_read_b128 v[188:191], v4 offset:44032
    v_exp_f32 v37, v37
    ds_read_b128 v[192:195], v4 offset:45056
    v_exp_f32 v38, v38
    v_exp_f32 v39, v39
    v_cvt_pk_bf16_f32 v32, v32, v33
    v_cvt_pk_bf16_f32 v33, v34, v35
    v_cvt_pk_bf16_f32 v34, v36, v37
    v_cvt_pk_bf16_f32 v35, v38, v39
    v_exp_f32 v40, v40
    v_exp_f32 v41, v41
    v_exp_f32 v42, v42
    v_exp_f32 v43, v43
    v_mfma_f32_32x32x16_bf16 a[224:239], a[96:99], v[32:35], a[224:239]
    v_exp_f32 v44, v44
    v_exp_f32 v45, v45
    v_exp_f32 v46, v46
    v_exp_f32 v47, v47
    v_cvt_pk_bf16_f32 v40, v40, v41
    v_cvt_pk_bf16_f32 v41, v42, v43
    v_cvt_pk_bf16_f32 v42, v44, v45
    v_cvt_pk_bf16_f32 v43, v46, v47
    v_mfma_f32_32x32x16_bf16 v[16:31], a[16:19], v[80:83], 0
    v_exp_f32 v48, v48
    v_exp_f32 v49, v49
    v_exp_f32 v50, v50
    v_exp_f32 v51, v51
    v_mfma_f32_32x32x16_bf16 a[224:239], a[100:103], v[40:43], a[224:239]
    v_exp_f32 v52, v52
    v_exp_f32 v53, v53
    v_exp_f32 v54, v54
    v_mfma_f32_32x32x16_bf16 v[32:47], a[16:19], v[84:87], 0
    v_exp_f32 v55, v55
    v_cvt_pk_bf16_f32 v48, v48, v49
    v_cvt_pk_bf16_f32 v49, v50, v51
    v_cvt_pk_bf16_f32 v50, v52, v53
    v_cvt_pk_bf16_f32 v51, v54, v55
    v_exp_f32 v56, v56
    v_exp_f32 v57, v57
    v_exp_f32 v58, v58
    v_exp_f32 v59, v59
    v_mfma_f32_32x32x16_bf16 a[208:223], a[104:107], v[48:51], a[208:223]
    v_exp_f32 v60, v60
    v_exp_f32 v61, v61
    v_exp_f32 v62, v62
    v_mfma_f32_32x32x4_2b_bf16 v[16:47], a[68:69], v[88:89], v[16:47] cbsz:1 abid:0
    v_exp_f32 v63, v63
    v_cvt_pk_bf16_f32 v56, v56, v57
    v_cvt_pk_bf16_f32 v57, v58, v59
    v_cvt_pk_bf16_f32 v58, v60, v61
    v_cvt_pk_bf16_f32 v59, v62, v63
    v_exp_f32 v64, v64
    v_exp_f32 v65, v65
    v_exp_f32 v66, v66
    v_exp_f32 v67, v67
    v_exp_f32 v68, v68
    v_mfma_f32_32x32x16_bf16 a[208:223], a[108:111], v[56:59], a[208:223]
    v_exp_f32 v69, v69
    v_exp_f32 v70, v70
    v_exp_f32 v71, v71
    v_cvt_pk_bf16_f32 v64, v64, v65
    v_cvt_pk_bf16_f32 v65, v66, v67
    v_cvt_pk_bf16_f32 v66, v68, v69
    v_cvt_pk_bf16_f32 v67, v70, v71
    v_exp_f32 v72, v72
    v_exp_f32 v73, v73
    v_exp_f32 v74, v74
    v_exp_f32 v75, v75
    v_mfma_f32_32x32x16_bf16 a[224:239], a[104:107], v[64:67], a[224:239]
    v_exp_f32 v76, v76
    v_exp_f32 v77, v77
    v_exp_f32 v78, v78
    v_exp_f32 v79, v79
    v_cvt_pk_bf16_f32 v72, v72, v73
    v_cvt_pk_bf16_f32 v73, v74, v75
    v_cvt_pk_bf16_f32 v74, v76, v77
    v_cvt_pk_bf16_f32 v75, v78, v79
    v_mfma_f32_32x32x16_bf16 v[48:63], a[20:23], v[80:83], 0
    v_exp_f32 v16, v16
    v_exp_f32 v17, v17
    v_exp_f32 v18, v18
    v_exp_f32 v19, v19
    v_mfma_f32_32x32x16_bf16 a[224:239], a[108:111], v[72:75], a[224:239]
    v_exp_f32 v20, v20
    v_exp_f32 v21, v21
    v_exp_f32 v22, v22
    v_mfma_f32_32x32x16_bf16 v[64:79], a[20:23], v[84:87], 0
    v_exp_f32 v23, v23
    v_cvt_pk_bf16_f32 v16, v16, v17
    v_cvt_pk_bf16_f32 v17, v18, v19
    v_cvt_pk_bf16_f32 v18, v20, v21
    v_cvt_pk_bf16_f32 v19, v22, v23
    v_exp_f32 v24, v24
    v_exp_f32 v25, v25
    v_exp_f32 v26, v26
    v_exp_f32 v27, v27
    v_mfma_f32_32x32x16_bf16 a[208:223], a[112:115], v[16:19], a[208:223]
    v_exp_f32 v28, v28
    s_waitcnt vmcnt(6) lgkmcnt(0)
    v_exp_f32 v29, v29
    v_exp_f32 v30, v30
    v_mfma_f32_32x32x4_2b_bf16 v[48:79], a[68:69], v[88:89], v[48:79] cbsz:1 abid:1
    v_exp_f32 v31, v31
    v_cvt_pk_bf16_f32 v24, v24, v25
    v_cvt_pk_bf16_f32 v25, v26, v27
    v_cvt_pk_bf16_f32 v26, v28, v29
    v_cvt_pk_bf16_f32 v27, v30, v31
    v_exp_f32 v32, v32
    v_exp_f32 v33, v33
    v_exp_f32 v34, v34
    v_exp_f32 v35, v35
    v_exp_f32 v36, v36
    v_mfma_f32_32x32x16_bf16 a[208:223], a[116:119], v[24:27], a[208:223]
    v_exp_f32 v37, v37
    v_exp_f32 v38, v38
    v_exp_f32 v39, v39
    v_mfma_f32_16x16x32_bf16 v[96:99], v[132:135], v[188:191], v[96:99]
    v_add_u32 v233, 28672, v233
    global_load_dwordx4 v[132:135], v233, s[8:9] offset:-4096 sc1
    v_cvt_pk_bf16_f32 v32, v32, v33
    v_cvt_pk_bf16_f32 v33, v34, v35
    v_cvt_pk_bf16_f32 v34, v36, v37
    v_cvt_pk_bf16_f32 v35, v38, v39
    v_exp_f32 v40, v40
    v_exp_f32 v41, v41
    v_exp_f32 v42, v42
    v_exp_f32 v43, v43
    v_mfma_f32_32x32x16_bf16 a[224:239], a[112:115], v[32:35], a[224:239]
    v_exp_f32 v44, v44
    v_exp_f32 v45, v45
    v_exp_f32 v46, v46
    v_exp_f32 v47, v47
    v_cvt_pk_bf16_f32 v40, v40, v41
    v_cvt_pk_bf16_f32 v41, v42, v43
    v_cvt_pk_bf16_f32 v42, v44, v45
    v_mfma_f32_16x16x32_bf16 v[100:103], v[136:139], v[188:191], v[100:103]
    global_load_dwordx4 v[136:139], v233, s[8:9] offset:-3072 sc1
    v_cvt_pk_bf16_f32 v43, v46, v47
    v_mfma_f32_32x32x16_bf16 v[16:31], a[24:27], v[80:83], 0
    v_exp_f32 v48, v48
    v_exp_f32 v49, v49
    v_exp_f32 v50, v50
    v_exp_f32 v51, v51
    v_mfma_f32_32x32x16_bf16 a[224:239], a[116:119], v[40:43], a[224:239]
    v_exp_f32 v52, v52
    v_exp_f32 v53, v53
    v_exp_f32 v54, v54
    v_mfma_f32_32x32x16_bf16 v[32:47], a[24:27], v[84:87], 0
    v_exp_f32 v55, v55
    v_cvt_pk_bf16_f32 v48, v48, v49
    v_cvt_pk_bf16_f32 v49, v50, v51
    v_cvt_pk_bf16_f32 v50, v52, v53
    v_cvt_pk_bf16_f32 v51, v54, v55
    v_exp_f32 v56, v56
    v_exp_f32 v57, v57
    v_exp_f32 v58, v58
    v_exp_f32 v59, v59
    v_mfma_f32_32x32x16_bf16 a[208:223], a[120:123], v[48:51], a[208:223]
    v_exp_f32 v60, v60
    v_exp_f32 v61, v61
    v_exp_f32 v62, v62
    v_mfma_f32_32x32x4_2b_bf16 v[16:47], a[70:71], v[88:89], v[16:47] cbsz:1 abid:0
    v_exp_f32 v63, v63
    v_cvt_pk_bf16_f32 v56, v56, v57
    v_cvt_pk_bf16_f32 v57, v58, v59
    v_cvt_pk_bf16_f32 v58, v60, v61
    v_cvt_pk_bf16_f32 v59, v62, v63
    v_exp_f32 v64, v64
    v_exp_f32 v65, v65
    v_exp_f32 v66, v66
    v_exp_f32 v67, v67
    v_exp_f32 v68, v68
    v_mfma_f32_32x32x16_bf16 a[208:223], a[124:127], v[56:59], a[208:223]
    v_exp_f32 v69, v69
    v_exp_f32 v70, v70
    v_exp_f32 v71, v71
    v_mfma_f32_16x16x32_bf16 v[104:107], v[140:143], v[188:191], v[104:107]
    global_load_dwordx4 v[140:143], v233, s[8:9] offset:-2048 sc1
    v_cvt_pk_bf16_f32 v64, v64, v65
    v_cvt_pk_bf16_f32 v65, v66, v67
    v_cvt_pk_bf16_f32 v66, v68, v69
    v_cvt_pk_bf16_f32 v67, v70, v71
    v_exp_f32 v72, v72
    v_exp_f32 v73, v73
    v_exp_f32 v74, v74
    v_exp_f32 v75, v75
    v_mfma_f32_32x32x16_bf16 a[224:239], a[120:123], v[64:67], a[224:239]
    v_exp_f32 v76, v76
    v_exp_f32 v77, v77
    v_exp_f32 v78, v78
    v_exp_f32 v79, v79
    v_cvt_pk_bf16_f32 v72, v72, v73
    v_cvt_pk_bf16_f32 v73, v74, v75
    v_cvt_pk_bf16_f32 v74, v76, v77
    v_cvt_pk_bf16_f32 v75, v78, v79
    v_mfma_f32_32x32x16_bf16 v[48:63], a[28:31], v[80:83], 0
    v_exp_f32 v16, v16
    v_exp_f32 v17, v17
    v_exp_f32 v18, v18
    v_exp_f32 v19, v19
    v_mfma_f32_32x32x16_bf16 a[224:239], a[124:127], v[72:75], a[224:239]
    s_waitcnt vmcnt(6)
    v_exp_f32 v20, v20
    v_exp_f32 v21, v21
    v_exp_f32 v22, v22
    v_mfma_f32_32x32x16_bf16 v[64:79], a[28:31], v[84:87], 0
    v_exp_f32 v23, v23
    v_cvt_pk_bf16_f32 v16, v16, v17
    v_cvt_pk_bf16_f32 v17, v18, v19
    v_cvt_pk_bf16_f32 v18, v20, v21
    v_cvt_pk_bf16_f32 v19, v22, v23
    v_mfma_f32_16x16x32_bf16 v[108:111], v[144:147], v[188:191], v[108:111]
    global_load_dwordx4 v[144:147], v233, s[8:9] offset:-1024 sc1
    v_exp_f32 v24, v24
    v_exp_f32 v25, v25
    v_exp_f32 v26, v26
    v_mfma_f32_32x32x4_2b_bf16 v[48:79], a[70:71], v[88:89], v[48:79] cbsz:1 abid:1
    v_exp_f32 v27, v27
    v_exp_f32 v28, v28
    v_exp_f32 v29, v29
    v_exp_f32 v30, v30
    v_exp_f32 v31, v31
    v_cvt_pk_bf16_f32 v24, v24, v25
    v_cvt_pk_bf16_f32 v25, v26, v27
    v_cvt_pk_bf16_f32 v26, v28, v29
    v_cvt_pk_bf16_f32 v27, v30, v31
    v_exp_f32 v32, v32
    v_mfma_f32_32x32x16_bf16 a[208:223], a[128:131], v[16:19], a[208:223]
    v_exp_f32 v33, v33
    v_exp_f32 v34, v34
    v_exp_f32 v35, v35
    v_mfma_f32_32x32x16_bf16 a[208:223], a[132:135], v[24:27], a[208:223]
    v_exp_f32 v36, v36
    v_exp_f32 v37, v37
    v_exp_f32 v38, v38
    v_mfma_f32_16x16x32_bf16 v[112:115], v[148:151], v[188:191], v[112:115]
    global_load_dwordx4 v[148:151], v233, s[8:9] offset:0 sc1
    v_exp_f32 v39, v39
    v_cvt_pk_bf16_f32 v32, v32, v33
    v_cvt_pk_bf16_f32 v33, v34, v35
    v_cvt_pk_bf16_f32 v34, v36, v37
    v_cvt_pk_bf16_f32 v35, v38, v39
    v_exp_f32 v40, v40
    v_exp_f32 v41, v41
    v_exp_f32 v42, v42
    v_exp_f32 v43, v43
    v_mfma_f32_32x32x16_bf16 a[224:239], a[128:131], v[32:35], a[224:239]
    v_exp_f32 v44, v44
    v_exp_f32 v45, v45
    v_exp_f32 v46, v46
    v_exp_f32 v47, v47
    v_cvt_pk_bf16_f32 v40, v40, v41
    v_cvt_pk_bf16_f32 v41, v42, v43
    v_cvt_pk_bf16_f32 v42, v44, v45
    v_cvt_pk_bf16_f32 v43, v46, v47
    v_mfma_f32_32x32x16_bf16 v[16:31], a[32:35], v[80:83], 0
    v_exp_f32 v48, v48
    v_exp_f32 v49, v49
    v_exp_f32 v50, v50
    v_exp_f32 v51, v51
    v_mfma_f32_32x32x16_bf16 a[224:239], a[132:135], v[40:43], a[224:239]
    v_exp_f32 v52, v52
    v_exp_f32 v53, v53
    v_exp_f32 v54, v54
    v_mfma_f32_32x32x16_bf16 v[32:47], a[32:35], v[84:87], 0
    v_exp_f32 v55, v55
    v_cvt_pk_bf16_f32 v48, v48, v49
    v_cvt_pk_bf16_f32 v49, v50, v51
    v_cvt_pk_bf16_f32 v50, v52, v53
    v_cvt_pk_bf16_f32 v51, v54, v55
    v_mfma_f32_16x16x32_bf16 v[116:119], v[152:155], v[188:191], v[116:119]
    global_load_dwordx4 v[152:155], v233, s[8:9] offset:1024 sc1
    v_exp_f32 v56, v56
    v_exp_f32 v57, v57
    v_exp_f32 v58, v58
    v_mfma_f32_32x32x4_2b_bf16 v[16:47], a[72:73], v[88:89], v[16:47] cbsz:1 abid:0
    v_exp_f32 v59, v59
    v_exp_f32 v60, v60
    v_exp_f32 v61, v61
    v_exp_f32 v62, v62
    v_exp_f32 v63, v63
    v_cvt_pk_bf16_f32 v56, v56, v57
    v_cvt_pk_bf16_f32 v57, v58, v59
    v_cvt_pk_bf16_f32 v58, v60, v61
    v_cvt_pk_bf16_f32 v59, v62, v63
    v_exp_f32 v64, v64
    v_mfma_f32_32x32x16_bf16 a[208:223], a[136:139], v[48:51], a[208:223]
    v_exp_f32 v65, v65
    v_exp_f32 v66, v66
    v_exp_f32 v67, v67
    v_mfma_f32_32x32x16_bf16 a[208:223], a[140:143], v[56:59], a[208:223]
    v_exp_f32 v68, v68
    v_exp_f32 v69, v69
    v_exp_f32 v70, v70
    v_exp_f32 v71, v71
    v_cvt_pk_bf16_f32 v64, v64, v65
    v_cvt_pk_bf16_f32 v65, v66, v67
    v_cvt_pk_bf16_f32 v66, v68, v69
    v_cvt_pk_bf16_f32 v67, v70, v71
    v_exp_f32 v72, v72
    v_exp_f32 v73, v73
    v_exp_f32 v74, v74
    v_exp_f32 v75, v75
    v_mfma_f32_32x32x16_bf16 a[224:239], a[136:139], v[64:67], a[224:239]
    s_waitcnt vmcnt(6)
    v_exp_f32 v76, v76
    v_exp_f32 v77, v77
    v_exp_f32 v78, v78
    v_mfma_f32_16x16x32_bf16 v[120:123], v[156:159], v[188:191], v[120:123]
    global_load_dwordx4 v[156:159], v233, s[8:9] offset:2048 sc1
    v_exp_f32 v79, v79
    v_cvt_pk_bf16_f32 v72, v72, v73
    v_cvt_pk_bf16_f32 v73, v74, v75
    v_cvt_pk_bf16_f32 v74, v76, v77
    v_cvt_pk_bf16_f32 v75, v78, v79
    v_mfma_f32_32x32x16_bf16 v[48:63], a[36:39], v[80:83], 0
    v_exp_f32 v16, v16
    v_exp_f32 v17, v17
    v_exp_f32 v18, v18
    v_exp_f32 v19, v19
    v_mfma_f32_32x32x16_bf16 a[224:239], a[140:143], v[72:75], a[224:239]
    v_exp_f32 v20, v20
    v_exp_f32 v21, v21
    v_exp_f32 v22, v22
    v_mfma_f32_32x32x16_bf16 v[64:79], a[36:39], v[84:87], 0
    v_exp_f32 v23, v23
    v_cvt_pk_bf16_f32 v16, v16, v17
    v_cvt_pk_bf16_f32 v17, v18, v19
    v_cvt_pk_bf16_f32 v18, v20, v21
    v_cvt_pk_bf16_f32 v19, v22, v23
    v_exp_f32 v24, v24
    v_exp_f32 v25, v25
    v_exp_f32 v26, v26
    v_exp_f32 v27, v27
    v_mfma_f32_32x32x16_bf16 a[208:223], a[144:147], v[16:19], a[208:223]
    v_exp_f32 v28, v28
    v_exp_f32 v29, v29
    v_exp_f32 v30, v30
    v_mfma_f32_32x32x4_2b_bf16 v[48:79], a[72:73], v[88:89], v[48:79] cbsz:1 abid:1
    v_exp_f32 v31, v31
    v_cvt_pk_bf16_f32 v24, v24, v25
    v_cvt_pk_bf16_f32 v25, v26, v27
    v_cvt_pk_bf16_f32 v26, v28, v29
    v_cvt_pk_bf16_f32 v27, v30, v31
    v_exp_f32 v32, v32
    v_exp_f32 v33, v33
    v_exp_f32 v34, v34
    v_exp_f32 v35, v35
    v_exp_f32 v36, v36
    v_mfma_f32_32x32x16_bf16 a[208:223], a[148:151], v[24:27], a[208:223]
    v_exp_f32 v37, v37
    v_exp_f32 v38, v38
    v_exp_f32 v39, v39
    v_mfma_f32_16x16x32_bf16 v[124:127], v[160:163], v[188:191], v[124:127]
    global_load_dwordx4 v[160:163], v233, s[8:9] offset:3072 sc1
    v_cvt_pk_bf16_f32 v32, v32, v33
    v_cvt_pk_bf16_f32 v33, v34, v35
    v_cvt_pk_bf16_f32 v34, v36, v37
    v_cvt_pk_bf16_f32 v35, v38, v39
    v_exp_f32 v40, v40
    v_exp_f32 v41, v41
    v_exp_f32 v42, v42
    v_exp_f32 v43, v43
    v_mfma_f32_32x32x16_bf16 a[224:239], a[144:147], v[32:35], a[224:239]
    v_exp_f32 v44, v44
    v_exp_f32 v45, v45
    v_exp_f32 v46, v46
    v_exp_f32 v47, v47
    v_cvt_pk_bf16_f32 v40, v40, v41
    v_cvt_pk_bf16_f32 v41, v42, v43
    v_cvt_pk_bf16_f32 v42, v44, v45
    v_cvt_pk_bf16_f32 v43, v46, v47
    v_mfma_f32_32x32x16_bf16 v[16:31], a[40:43], v[80:83], 0
    v_exp_f32 v48, v48
    v_exp_f32 v49, v49
    v_exp_f32 v50, v50
    v_mfma_f32_16x16x32_bf16 v[128:131], v[164:167], v[188:191], v[128:131]
    v_add_u32 v233, 8192, v233
    global_load_dwordx4 v[164:167], v233, s[8:9] offset:-4096 sc1
    v_exp_f32 v51, v51
    v_mfma_f32_32x32x16_bf16 a[224:239], a[148:151], v[40:43], a[224:239]
    v_add_u32 v233, 28672, v233
    v_exp_f32 v52, v52
    v_exp_f32 v53, v53
    v_exp_f32 v54, v54
    v_mfma_f32_32x32x16_bf16 v[32:47], a[40:43], v[84:87], 0
    v_exp_f32 v55, v55
    v_cvt_pk_bf16_f32 v48, v48, v49
    v_cvt_pk_bf16_f32 v49, v50, v51
    v_cvt_pk_bf16_f32 v50, v52, v53
    v_cvt_pk_bf16_f32 v51, v54, v55
    v_exp_f32 v56, v56
    v_exp_f32 v57, v57
    v_exp_f32 v58, v58
    v_exp_f32 v59, v59
    v_mfma_f32_32x32x16_bf16 a[208:223], a[152:155], v[48:51], a[208:223]
    v_exp_f32 v60, v60
    v_exp_f32 v61, v61
    v_exp_f32 v62, v62
    v_mfma_f32_32x32x4_2b_bf16 v[16:47], a[74:75], v[88:89], v[16:47] cbsz:1 abid:0
    v_exp_f32 v63, v63
    v_cvt_pk_bf16_f32 v56, v56, v57
    v_cvt_pk_bf16_f32 v57, v58, v59
    v_cvt_pk_bf16_f32 v58, v60, v61
    v_cvt_pk_bf16_f32 v59, v62, v63
    s_waitcnt vmcnt(6)
    v_exp_f32 v64, v64
    v_exp_f32 v65, v65
    v_exp_f32 v66, v66
    v_exp_f32 v67, v67
    v_mfma_f32_32x32x16_bf16 a[208:223], a[156:159], v[56:59], a[208:223]
    v_exp_f32 v68, v68
    v_exp_f32 v69, v69
    v_exp_f32 v70, v70
    v_mfma_f32_16x16x32_bf16 v[96:99], v[132:135], v[192:195], v[96:99]
    global_load_dwordx4 v[132:135], v233, s[8:9] offset:-4096 sc1
    v_exp_f32 v71, v71
    v_cvt_pk_bf16_f32 v64, v64, v65
    v_cvt_pk_bf16_f32 v65, v66, v67
    v_cvt_pk_bf16_f32 v66, v68, v69
    v_cvt_pk_bf16_f32 v67, v70, v71
    v_exp_f32 v72, v72
    v_exp_f32 v73, v73
    v_exp_f32 v74, v74
    v_exp_f32 v75, v75
    v_mfma_f32_32x32x16_bf16 a[224:239], a[152:155], v[64:67], a[224:239]
    v_exp_f32 v76, v76
    v_exp_f32 v77, v77
    v_exp_f32 v78, v78
    v_exp_f32 v79, v79
    v_cvt_pk_bf16_f32 v72, v72, v73
    v_cvt_pk_bf16_f32 v73, v74, v75
    v_cvt_pk_bf16_f32 v74, v76, v77
    v_cvt_pk_bf16_f32 v75, v78, v79
    v_mfma_f32_32x32x16_bf16 v[48:63], a[44:47], v[80:83], 0
    v_exp_f32 v16, v16
    v_exp_f32 v17, v17
    v_exp_f32 v18, v18
    v_exp_f32 v19, v19
    v_mfma_f32_32x32x16_bf16 a[224:239], a[156:159], v[72:75], a[224:239]
    v_exp_f32 v20, v20
    v_exp_f32 v21, v21
    v_exp_f32 v22, v22
    v_mfma_f32_32x32x16_bf16 v[64:79], a[44:47], v[84:87], 0
    v_exp_f32 v23, v23
    v_cvt_pk_bf16_f32 v16, v16, v17
    v_cvt_pk_bf16_f32 v17, v18, v19
    v_cvt_pk_bf16_f32 v18, v20, v21
    v_cvt_pk_bf16_f32 v19, v22, v23
    v_mfma_f32_16x16x32_bf16 v[100:103], v[136:139], v[192:195], v[100:103]
    global_load_dwordx4 v[136:139], v233, s[8:9] offset:-3072 sc1
    v_exp_f32 v24, v24
    v_exp_f32 v25, v25
    v_exp_f32 v26, v26
    v_mfma_f32_32x32x4_2b_bf16 v[48:79], a[74:75], v[88:89], v[48:79] cbsz:1 abid:1
    v_exp_f32 v27, v27
    v_exp_f32 v28, v28
    v_exp_f32 v29, v29
    v_exp_f32 v30, v30
    v_exp_f32 v31, v31
    v_cvt_pk_bf16_f32 v24, v24, v25
    v_cvt_pk_bf16_f32 v25, v26, v27
    v_cvt_pk_bf16_f32 v26, v28, v29
    v_cvt_pk_bf16_f32 v27, v30, v31
    v_exp_f32 v32, v32
    v_mfma_f32_32x32x16_bf16 a[208:223], a[160:163], v[16:19], a[208:223]
    v_exp_f32 v33, v33
    v_exp_f32 v34, v34
    v_exp_f32 v35, v35
    v_mfma_f32_32x32x16_bf16 a[208:223], a[164:167], v[24:27], a[208:223]
    v_exp_f32 v36, v36
    v_exp_f32 v37, v37
    v_exp_f32 v38, v38
    v_mfma_f32_16x16x32_bf16 v[104:107], v[140:143], v[192:195], v[104:107]
    global_load_dwordx4 v[140:143], v233, s[8:9] offset:-2048 sc1
    v_exp_f32 v39, v39
    v_cvt_pk_bf16_f32 v32, v32, v33
    v_cvt_pk_bf16_f32 v33, v34, v35
    v_cvt_pk_bf16_f32 v34, v36, v37
    v_cvt_pk_bf16_f32 v35, v38, v39
    v_exp_f32 v40, v40
    v_exp_f32 v41, v41
    v_exp_f32 v42, v42
    v_exp_f32 v43, v43
    v_mfma_f32_32x32x16_bf16 a[224:239], a[160:163], v[32:35], a[224:239]
    v_exp_f32 v44, v44
    v_exp_f32 v45, v45
    v_exp_f32 v46, v46
    v_exp_f32 v47, v47
    v_cvt_pk_bf16_f32 v40, v40, v41
    v_cvt_pk_bf16_f32 v41, v42, v43
    v_cvt_pk_bf16_f32 v42, v44, v45
    v_cvt_pk_bf16_f32 v43, v46, v47
    v_mfma_f32_32x32x16_bf16 v[16:31], a[48:51], v[80:83], 0
    v_exp_f32 v48, v48
    v_exp_f32 v49, v49
    v_exp_f32 v50, v50
    v_exp_f32 v51, v51
    v_mfma_f32_32x32x16_bf16 a[224:239], a[164:167], v[40:43], a[224:239]
    v_exp_f32 v52, v52
    v_exp_f32 v53, v53
    v_exp_f32 v54, v54
    v_mfma_f32_32x32x16_bf16 v[32:47], a[48:51], v[84:87], 0
    v_exp_f32 v55, v55
    v_cvt_pk_bf16_f32 v48, v48, v49
    s_waitcnt vmcnt(6)
    v_cvt_pk_bf16_f32 v49, v50, v51
    v_cvt_pk_bf16_f32 v50, v52, v53
    v_mfma_f32_16x16x32_bf16 v[108:111], v[144:147], v[192:195], v[108:111]
    global_load_dwordx4 v[144:147], v233, s[8:9] offset:-1024 sc1
    v_cvt_pk_bf16_f32 v51, v54, v55
    v_exp_f32 v56, v56
    v_exp_f32 v57, v57
    v_mfma_f32_32x32x4_2b_bf16 v[16:47], a[76:77], v[88:89], v[16:47] cbsz:1 abid:0
    v_exp_f32 v58, v58
    v_exp_f32 v59, v59
    v_exp_f32 v60, v60
    v_exp_f32 v61, v61
    v_exp_f32 v62, v62
    v_exp_f32 v63, v63
    v_cvt_pk_bf16_f32 v56, v56, v57
    v_cvt_pk_bf16_f32 v57, v58, v59
    v_cvt_pk_bf16_f32 v58, v60, v61
    v_mfma_f32_32x32x16_bf16 a[208:223], a[168:171], v[48:51], a[208:223]
    v_cvt_pk_bf16_f32 v59, v62, v63
    v_exp_f32 v64, v64
    v_exp_f32 v65, v65
    v_exp_f32 v66, v66
    v_exp_f32 v67, v67
    v_mfma_f32_32x32x16_bf16 a[208:223], a[172:175], v[56:59], a[208:223]
    v_exp_f32 v68, v68
    v_exp_f32 v69, v69
    v_exp_f32 v70, v70
    v_exp_f32 v71, v71
    v_cvt_pk_bf16_f32 v64, v64, v65
    v_cvt_pk_bf16_f32 v65, v66, v67
    v_cvt_pk_bf16_f32 v66, v68, v69
    v_cvt_pk_bf16_f32 v67, v70, v71
    v_exp_f32 v72, v72
    v_exp_f32 v73, v73
    v_exp_f32 v74, v74
    v_exp_f32 v75, v75
    v_mfma_f32_32x32x16_bf16 a[224:239], a[168:171], v[64:67], a[224:239]
    v_exp_f32 v76, v76
    v_exp_f32 v77, v77
    v_exp_f32 v78, v78
    v_mfma_f32_16x16x32_bf16 v[112:115], v[148:151], v[192:195], v[112:115]
    global_load_dwordx4 v[148:151], v233, s[8:9] offset:0 sc1
    v_exp_f32 v79, v79
    v_cvt_pk_bf16_f32 v72, v72, v73
    v_cvt_pk_bf16_f32 v73, v74, v75
    v_cvt_pk_bf16_f32 v74, v76, v77
    v_cvt_pk_bf16_f32 v75, v78, v79
    v_mfma_f32_32x32x16_bf16 v[48:63], a[52:55], v[80:83], 0
    v_exp_f32 v16, v16
    v_exp_f32 v17, v17
    v_exp_f32 v18, v18
    v_exp_f32 v19, v19
    v_mfma_f32_32x32x16_bf16 a[224:239], a[172:175], v[72:75], a[224:239]
    v_exp_f32 v20, v20
    v_exp_f32 v21, v21
    v_exp_f32 v22, v22
    v_mfma_f32_32x32x16_bf16 v[64:79], a[52:55], v[84:87], 0
    v_exp_f32 v23, v23
    v_cvt_pk_bf16_f32 v16, v16, v17
    v_cvt_pk_bf16_f32 v17, v18, v19
    v_cvt_pk_bf16_f32 v18, v20, v21
    v_cvt_pk_bf16_f32 v19, v22, v23
    v_exp_f32 v24, v24
    v_exp_f32 v25, v25
    v_exp_f32 v26, v26
    v_exp_f32 v27, v27
    v_mfma_f32_32x32x16_bf16 a[208:223], a[176:179], v[16:19], a[208:223]
    v_exp_f32 v28, v28
    v_exp_f32 v29, v29
    v_exp_f32 v30, v30
    v_mfma_f32_32x32x4_2b_bf16 v[48:79], a[76:77], v[88:89], v[48:79] cbsz:1 abid:1
    v_exp_f32 v31, v31
    v_cvt_pk_bf16_f32 v24, v24, v25
    v_cvt_pk_bf16_f32 v25, v26, v27
    v_cvt_pk_bf16_f32 v26, v28, v29
    v_cvt_pk_bf16_f32 v27, v30, v31
    v_exp_f32 v32, v32
    v_exp_f32 v33, v33
    v_exp_f32 v34, v34
    v_exp_f32 v35, v35
    v_exp_f32 v36, v36
    v_mfma_f32_32x32x16_bf16 a[208:223], a[180:183], v[24:27], a[208:223]
    v_exp_f32 v37, v37
    v_exp_f32 v38, v38
    v_exp_f32 v39, v39
    v_mfma_f32_16x16x32_bf16 v[116:119], v[152:155], v[192:195], v[116:119]
    global_load_dwordx4 v[152:155], v233, s[8:9] offset:1024 sc1
    v_cvt_pk_bf16_f32 v32, v32, v33
    v_cvt_pk_bf16_f32 v33, v34, v35
    v_cvt_pk_bf16_f32 v34, v36, v37
    v_cvt_pk_bf16_f32 v35, v38, v39
    v_exp_f32 v40, v40
    v_exp_f32 v41, v41
    v_exp_f32 v42, v42
    v_exp_f32 v43, v43
    v_mfma_f32_32x32x16_bf16 a[224:239], a[176:179], v[32:35], a[224:239]
    v_exp_f32 v44, v44
    v_exp_f32 v45, v45
    v_exp_f32 v46, v46
    v_exp_f32 v47, v47
    v_cvt_pk_bf16_f32 v40, v40, v41
    s_waitcnt vmcnt(6)
    v_cvt_pk_bf16_f32 v41, v42, v43
    v_mfma_f32_16x16x32_bf16 v[120:123], v[156:159], v[192:195], v[120:123]
    global_load_dwordx4 v[156:159], v233, s[8:9] offset:2048 sc1
    v_cvt_pk_bf16_f32 v42, v44, v45
    v_cvt_pk_bf16_f32 v43, v46, v47
    v_mfma_f32_32x32x16_bf16 v[16:31], a[56:59], v[80:83], 0
    v_exp_f32 v48, v48
    v_exp_f32 v49, v49
    v_exp_f32 v50, v50
    v_exp_f32 v51, v51
    v_mfma_f32_32x32x16_bf16 a[224:239], a[180:183], v[40:43], a[224:239]
    v_exp_f32 v52, v52
    v_exp_f32 v53, v53
    v_exp_f32 v54, v54
    v_mfma_f32_32x32x16_bf16 v[32:47], a[56:59], v[84:87], 0
    v_exp_f32 v55, v55
    v_cvt_pk_bf16_f32 v48, v48, v49
    v_cvt_pk_bf16_f32 v49, v50, v51
    v_cvt_pk_bf16_f32 v50, v52, v53
    v_cvt_pk_bf16_f32 v51, v54, v55
    v_exp_f32 v56, v56
    v_exp_f32 v57, v57
    v_exp_f32 v58, v58
    v_exp_f32 v59, v59
    v_mfma_f32_32x32x16_bf16 a[208:223], a[184:187], v[48:51], a[208:223]
    v_exp_f32 v60, v60
    v_exp_f32 v61, v61
    v_exp_f32 v62, v62
    v_mfma_f32_32x32x4_2b_bf16 v[16:47], a[78:79], v[88:89], v[16:47] cbsz:1 abid:0
    v_exp_f32 v63, v63
    v_cvt_pk_bf16_f32 v56, v56, v57
    v_cvt_pk_bf16_f32 v57, v58, v59
    v_cvt_pk_bf16_f32 v58, v60, v61
    v_cvt_pk_bf16_f32 v59, v62, v63
    v_exp_f32 v64, v64
    v_exp_f32 v65, v65
    v_exp_f32 v66, v66
    v_exp_f32 v67, v67
    v_exp_f32 v68, v68
    v_mfma_f32_32x32x16_bf16 a[208:223], a[188:191], v[56:59], a[208:223]
    v_exp_f32 v69, v69
    v_exp_f32 v70, v70
    v_exp_f32 v71, v71
    v_mfma_f32_16x16x32_bf16 v[124:127], v[160:163], v[192:195], v[124:127]
    global_load_dwordx4 v[160:163], v233, s[8:9] offset:3072 sc1
    v_cvt_pk_bf16_f32 v64, v64, v65
    v_cvt_pk_bf16_f32 v65, v66, v67
    v_cvt_pk_bf16_f32 v66, v68, v69
    v_cvt_pk_bf16_f32 v67, v70, v71
    v_exp_f32 v72, v72
    v_exp_f32 v73, v73
    v_exp_f32 v74, v74
    v_exp_f32 v75, v75
    v_mfma_f32_32x32x16_bf16 a[224:239], a[184:187], v[64:67], a[224:239]
    v_exp_f32 v76, v76
    v_exp_f32 v77, v77
    v_exp_f32 v78, v78
    v_exp_f32 v79, v79
    v_cvt_pk_bf16_f32 v72, v72, v73
    v_cvt_pk_bf16_f32 v73, v74, v75
    v_cvt_pk_bf16_f32 v74, v76, v77
    v_cvt_pk_bf16_f32 v75, v78, v79
    v_mfma_f32_32x32x16_bf16 v[48:63], a[60:63], v[80:83], 0
    v_exp_f32 v16, v16
    v_exp_f32 v17, v17
    v_exp_f32 v18, v18
    v_exp_f32 v19, v19
    v_mfma_f32_32x32x16_bf16 a[224:239], a[188:191], v[72:75], a[224:239]
    v_exp_f32 v20, v20
    v_exp_f32 v21, v21
    v_exp_f32 v22, v22
    v_mfma_f32_32x32x16_bf16 v[64:79], a[60:63], v[84:87], 0
    v_exp_f32 v23, v23
    v_cvt_pk_bf16_f32 v16, v16, v17
    v_cvt_pk_bf16_f32 v17, v18, v19
    v_cvt_pk_bf16_f32 v18, v20, v21
    v_cvt_pk_bf16_f32 v19, v22, v23
    v_mfma_f32_16x16x32_bf16 v[128:131], v[164:167], v[192:195], v[128:131]
    v_add_u32 v233, 8192, v233
    global_load_dwordx4 v[164:167], v233, s[8:9] offset:-4096 sc1
    v_exp_f32 v24, v24
    v_exp_f32 v25, v25
    v_mfma_f32_32x32x4_2b_bf16 v[48:79], a[78:79], v[88:89], v[48:79] cbsz:1 abid:1
    v_exp_f32 v26, v26
    v_exp_f32 v27, v27
    v_exp_f32 v28, v28
    v_exp_f32 v29, v29
    v_exp_f32 v30, v30
    v_exp_f32 v31, v31
    v_cvt_pk_bf16_f32 v24, v24, v25
    v_cvt_pk_bf16_f32 v25, v26, v27
    v_cvt_pk_bf16_f32 v26, v28, v29
    v_mfma_f32_32x32x16_bf16 a[208:223], a[192:195], v[16:19], a[208:223]
    v_cvt_pk_bf16_f32 v27, v30, v31
    v_exp_f32 v32, v32
    v_exp_f32 v33, v33
    v_exp_f32 v34, v34
    v_exp_f32 v35, v35
    v_mfma_f32_32x32x16_bf16 a[208:223], a[196:199], v[24:27], a[208:223]
    v_exp_f32 v36, v36
    v_exp_f32 v37, v37
    v_exp_f32 v38, v38
    v_exp_f32 v39, v39
    v_cvt_pk_bf16_f32 v32, v32, v33
    v_cvt_pk_bf16_f32 v33, v34, v35
    v_cvt_pk_bf16_f32 v34, v36, v37
    v_cvt_pk_bf16_f32 v35, v38, v39
    v_exp_f32 v40, v40
    v_exp_f32 v41, v41
    v_exp_f32 v42, v42
    v_exp_f32 v43, v43
    v_mfma_f32_32x32x16_bf16 a[224:239], a[192:195], v[32:35], a[224:239]
    v_exp_f32 v44, v44
    v_exp_f32 v45, v45
    v_exp_f32 v46, v46
    v_exp_f32 v47, v47
    v_cvt_pk_bf16_f32 v40, v40, v41
    v_cvt_pk_bf16_f32 v41, v42, v43
    v_cvt_pk_bf16_f32 v42, v44, v45
    v_cvt_pk_bf16_f32 v43, v46, v47
    v_exp_f32 v48, v48
    v_exp_f32 v49, v49
    v_exp_f32 v50, v50
    v_exp_f32 v51, v51
    v_mfma_f32_32x32x16_bf16 a[224:239], a[196:199], v[40:43], a[224:239]
    v_exp_f32 v52, v52
    v_exp_f32 v53, v53
    v_exp_f32 v54, v54
    v_exp_f32 v55, v55
    v_cvt_pk_bf16_f32 v48, v48, v49
    v_cvt_pk_bf16_f32 v49, v50, v51
    v_cvt_pk_bf16_f32 v50, v52, v53
    v_cvt_pk_bf16_f32 v51, v54, v55
    v_exp_f32 v56, v56
    v_exp_f32 v57, v57
    v_exp_f32 v58, v58
    v_exp_f32 v59, v59
    v_mfma_f32_32x32x16_bf16 a[208:223], a[200:203], v[48:51], a[208:223]
    v_exp_f32 v60, v60
    v_exp_f32 v61, v61
    v_exp_f32 v62, v62
    v_exp_f32 v63, v63
    v_cvt_pk_bf16_f32 v56, v56, v57
    v_cvt_pk_bf16_f32 v57, v58, v59
    v_cvt_pk_bf16_f32 v58, v60, v61
    v_cvt_pk_bf16_f32 v59, v62, v63
    v_exp_f32 v64, v64
    v_exp_f32 v65, v65
    v_exp_f32 v66, v66
    v_exp_f32 v67, v67
    v_mfma_f32_32x32x16_bf16 a[208:223], a[204:207], v[56:59], a[208:223]
    v_exp_f32 v68, v68
    v_exp_f32 v69, v69
    v_exp_f32 v70, v70
    v_exp_f32 v71, v71
    v_cvt_pk_bf16_f32 v64, v64, v65
    v_cvt_pk_bf16_f32 v65, v66, v67
    v_cvt_pk_bf16_f32 v66, v68, v69
    v_cvt_pk_bf16_f32 v67, v70, v71
    v_exp_f32 v72, v72
    v_exp_f32 v73, v73
    v_exp_f32 v74, v74
    v_exp_f32 v75, v75
    v_mfma_f32_32x32x16_bf16 a[224:239], a[200:203], v[64:67], a[224:239]
    v_exp_f32 v76, v76
    v_exp_f32 v77, v77
    v_exp_f32 v78, v78
    v_exp_f32 v79, v79
    v_cvt_pk_bf16_f32 v72, v72, v73
    v_cvt_pk_bf16_f32 v73, v74, v75
    v_cvt_pk_bf16_f32 v74, v76, v77
    v_cvt_pk_bf16_f32 v75, v78, v79
    s_nop 1
    v_mfma_f32_32x32x16_bf16 a[224:239], a[204:207], v[72:75], a[224:239]
    ds_write_b128 v234, a[208:211] offset:0
    ds_write_b128 v234, a[212:215] offset:1024
    ds_write_b128 v234, a[216:219] offset:2048
    v_add_u32 v5, 28672, v233
    global_load_dwordx4 v[16:19], v5, s[8:9] offset:-4096 sc1
    v_add_u32 v5, 29696, v233
    global_load_dwordx4 v[20:23], v5, s[8:9] offset:-4096 sc1
    v_add_u32 v5, 30720, v233
    global_load_dwordx4 v[24:27], v5, s[8:9] offset:-4096 sc1
    v_add_u32 v5, 31744, v233
    global_load_dwordx4 v[28:31], v5, s[8:9] offset:-4096 sc1
    s_nop 0
    ds_write_b128 v234, a[224:227] offset:3072
    ds_write_b128 v234, a[228:231] offset:4096
    ds_write_b128 v234, a[232:235] offset:5120
    v_add_u32 v5, 32768, v233
    global_load_dwordx4 v[32:35], v5, s[8:9] offset:-4096 sc1
    v_add_u32 v5, 33792, v233
    global_load_dwordx4 v[36:39], v5, s[8:9] offset:-4096 sc1
    v_add_u32 v5, 34816, v233
    global_load_dwordx4 v[40:43], v5, s[8:9] offset:-4096 sc1
    v_add_u32 v5, 35840, v233
    global_load_dwordx4 v[44:47], v5, s[8:9] offset:-4096 sc1
    v_add_u32 v5, 36864, v233
    global_load_dwordx4 v[48:51], v5, s[8:9] offset:-4096 sc1
    s_waitcnt lgkmcnt(0)
    s_barrier
    ds_read_b128 v[216:219], v236 offset:0
    ds_read_b128 v[220:223], v236 offset:6144
    ds_read_b128 v[224:227], v236 offset:12288
    ds_read_b128 v[228:231], v236 offset:18432
    ds_read_b128 v[200:203], v235 offset:0
    ds_read_b128 v[204:207], v235 offset:6144
    ds_read_b128 v[208:211], v235 offset:12288
    ds_read_b128 v[212:215], v235 offset:18432
    v_add_u32 v5, 65536, v233
    global_load_dwordx4 v[52:55], v5, s[8:9] offset:-4096 sc1
    v_add_u32 v5, 66560, v233
    global_load_dwordx4 v[56:59], v5, s[8:9] offset:-4096 sc1
    v_add_u32 v5, 67584, v233
    global_load_dwordx4 v[60:63], v5, s[8:9] offset:-4096 sc1
    v_add_u32 v5, 68608, v233
    global_load_dwordx4 v[64:67], v5, s[8:9] offset:-4096 sc1
    v_add_u32 v5, 69632, v233
    global_load_dwordx4 v[68:71], v5, s[8:9] offset:-4096 sc1
    v_add_u32 v5, 70656, v233
    global_load_dwordx4 v[72:75], v5, s[8:9] offset:-4096 sc1
    v_add_u32 v5, 71680, v233
    global_load_dwordx4 v[76:79], v5, s[8:9] offset:-4096 sc1
    v_add_u32 v5, 72704, v233
    global_load_dwordx4 v[80:83], v5, s[8:9] offset:-4096 sc1
    v_add_u32 v5, 73728, v233
    global_load_dwordx4 v[84:87], v5, s[8:9] offset:-4096 sc1
    s_waitcnt lgkmcnt(6)
    v_pk_add_f32 v[216:217], v[216:217], v[220:221]
    s_waitcnt lgkmcnt(4)
    v_pk_add_f32 v[224:225], v[224:225], v[228:229]
    v_add_f32 v218, v218, v222
    v_add_f32 v226, v226, v230
    v_pk_add_f32 v[216:217], v[216:217], v[224:225]
    v_add_f32 v218, v218, v226
    v_rcp_f32 v242, v218
    v_subrev_u32 v243, 0x1f800000, v218
    v_cmp_le_u32 vcc, 0x40000000, v243
    s_waitcnt lgkmcnt(2)
    v_pk_add_f32 v[200:201], v[200:201], v[204:205]
    s_waitcnt lgkmcnt(0)
    v_pk_add_f32 v[208:209], v[208:209], v[212:213]
    v_pk_add_f32 v[202:203], v[202:203], v[206:207]
    v_pk_add_f32 v[210:211], v[210:211], v[214:215]
    s_or_b64 s[84:85], s[84:85], vcc
    v_pk_add_f32 v[200:201], v[200:201], v[208:209]
    v_pk_add_f32 v[202:203], v[202:203], v[210:211]
    v_pk_mul_f32 v[216:217], v[216:217], v[242:243] op_sel_hi:[1,0]
    v_pk_mul_f32 v[200:201], v[200:201], v[242:243] op_sel_hi:[1,0]
    v_pk_mul_f32 v[202:203], v[202:203], v[242:243] op_sel_hi:[1,0]
    v_cvt_pk_bf16_f32 v220, v216, v217
    v_cvt_pk_bf16_f32 v204, v200, v201
    v_cvt_pk_bf16_f32 v205, v202, v203
    ds_write_b32 v238, v220
    ds_write_b64 v237, v[204:205]
    s_cmp_lg_u64 s[84:85], 0
    s_cselect_b32 s28, 1, 0
    s_lshl_b32 s29, s4, 2
    s_add_u32 s29, s29, 47104
    v_mov_b32 v6, s28
    v_mov_b32 v7, s29
    ds_write_b32 v7, v6
    s_waitcnt lgkmcnt(0)
    s_barrier
    ds_read_b128 v[188:191], v4 offset:44032
    ds_read_b128 v[192:195], v4 offset:45056
    ds_read_b128 v[196:199], v4 offset:46080
    v_mov_b32 v7, 47104
    ds_read_b128 v[200:203], v7
    s_waitcnt vmcnt(18)
    s_waitcnt lgkmcnt(3)
    v_mfma_f32_16x16x32_bf16 v[96:99], v[132:135], v[188:191], v[96:99]
    v_mfma_f32_16x16x32_bf16 v[100:103], v[136:139], v[188:191], v[100:103]
    v_mfma_f32_16x16x32_bf16 v[104:107], v[140:143], v[188:191], v[104:107]
    v_mfma_f32_16x16x32_bf16 v[108:111], v[144:147], v[188:191], v[108:111]
    v_mfma_f32_16x16x32_bf16 v[112:115], v[148:151], v[188:191], v[112:115]
    v_mfma_f32_16x16x32_bf16 v[116:119], v[152:155], v[188:191], v[116:119]
    v_mfma_f32_16x16x32_bf16 v[120:123], v[156:159], v[188:191], v[120:123]
    v_mfma_f32_16x16x32_bf16 v[124:127], v[160:163], v[188:191], v[124:127]
    v_mfma_f32_16x16x32_bf16 v[128:131], v[164:167], v[188:191], v[128:131]
    s_waitcnt vmcnt(9)
    s_waitcnt lgkmcnt(2)
    v_mfma_f32_16x16x32_bf16 v[96:99], v[16:19], v[192:195], v[96:99]
    v_mfma_f32_16x16x32_bf16 v[100:103], v[20:23], v[192:195], v[100:103]
    v_mfma_f32_16x16x32_bf16 v[104:107], v[24:27], v[192:195], v[104:107]
    v_mfma_f32_16x16x32_bf16 v[108:111], v[28:31], v[192:195], v[108:111]
    v_mfma_f32_16x16x32_bf16 v[112:115], v[32:35], v[192:195], v[112:115]
    v_mfma_f32_16x16x32_bf16 v[116:119], v[36:39], v[192:195], v[116:119]
    v_mfma_f32_16x16x32_bf16 v[120:123], v[40:43], v[192:195], v[120:123]
    v_mfma_f32_16x16x32_bf16 v[124:127], v[44:47], v[192:195], v[124:127]
    v_mfma_f32_16x16x32_bf16 v[128:131], v[48:51], v[192:195], v[128:131]
    s_waitcnt vmcnt(0)
    s_waitcnt lgkmcnt(1)
    v_mfma_f32_16x16x32_bf16 v[96:99], v[52:55], v[196:199], v[96:99]
    v_mfma_f32_16x16x32_bf16 v[100:103], v[56:59], v[196:199], v[100:103]
    v_mfma_f32_16x16x32_bf16 v[104:107], v[60:63], v[196:199], v[104:107]
    v_mfma_f32_16x16x32_bf16 v[108:111], v[64:67], v[196:199], v[108:111]
    v_mfma_f32_16x16x32_bf16 v[112:115], v[68:71], v[196:199], v[112:115]
    v_mfma_f32_16x16x32_bf16 v[116:119], v[72:75], v[196:199], v[116:119]
    v_mfma_f32_16x16x32_bf16 v[120:123], v[76:79], v[196:199], v[120:123]
    v_mfma_f32_16x16x32_bf16 v[124:127], v[80:83], v[196:199], v[124:127]
    v_mfma_f32_16x16x32_bf16 v[128:131], v[84:87], v[196:199], v[128:131]
    s_waitcnt lgkmcnt(0)
    v_or3_b32 v200, v200, v201, v202
    v_or_b32 v200, v200, v203
    s_nop 0
    v_readfirstlane_b32 s28, v200
    s_nop 3
    s_cmp_lg_u32 s28, 0
    s_cbranch_scc1 interleave_layers__grouped_kv_mqa__ssm_conv_h3__prompt_kernel_at_slow
interleave_layers__grouped_kv_mqa__ssm_conv_h3__prompt_kernel_at_slow_back:
    s_lshl_b32 s3, s83, 3
    s_lshl_b32 s28, s5, 1
    s_add_u32 s28, s28, s6
    s_mul_i32 s30, s28, 24576
    s_xor_b32 s28, s28, 1
    s_mul_i32 s31, s28, 24576
    s_mul_i32 s29, s4, 6144
    s_mul_i32 s32, s83, 0x900000
    s_add_u32 s29, s29, s32
    s_add_u32 s30, s30, s29
    s_add_u32 s31, s31, s29
    s_add_u32 s44, s30, 0x480000
    s_add_u32 s44, s8, s44
    s_addc_u32 s45, s9, 0
    s_add_u32 s46, s31, 0x480000
    s_add_u32 s46, s8, s46
    s_addc_u32 s47, s9, 0
    v_cvt_pk_bf16_f32 v168, v96, v97
    v_cvt_pk_bf16_f32 v169, v98, v99
    v_cvt_pk_bf16_f32 v170, v100, v101
    v_cvt_pk_bf16_f32 v172, v102, v103
    v_cvt_pk_bf16_f32 v173, v104, v105
    v_cvt_pk_bf16_f32 v174, v106, v107
    v_cvt_pk_bf16_f32 v176, v108, v109
    v_cvt_pk_bf16_f32 v177, v110, v111
    v_cvt_pk_bf16_f32 v178, v112, v113
    v_cvt_pk_bf16_f32 v180, v114, v115
    v_cvt_pk_bf16_f32 v181, v116, v117
    v_cvt_pk_bf16_f32 v182, v118, v119
    v_cvt_pk_bf16_f32 v184, v120, v121
    v_cvt_pk_bf16_f32 v185, v122, v123
    v_cvt_pk_bf16_f32 v186, v124, v125
    v_cvt_pk_bf16_f32 v188, v126, v127
    v_cvt_pk_bf16_f32 v189, v128, v129
    v_cvt_pk_bf16_f32 v190, v130, v131
    v_add_u32 v59, 4096, v4
    v_mov_b32 v171, s86
    v_mov_b32 v175, s86
    v_mov_b32 v179, s86
    v_mov_b32 v183, s86
    v_mov_b32 v187, s86
    v_mov_b32 v191, s86
    global_store_dwordx4 v59, v[168:171], s[44:45] offset:-4096 sc1
    global_store_dwordx4 v59, v[172:175], s[44:45] offset:-3072 sc1
    global_store_dwordx4 v59, v[176:179], s[44:45] offset:-2048 sc1
    global_store_dwordx4 v59, v[180:183], s[44:45] offset:-1024 sc1
    global_store_dwordx4 v59, v[184:187], s[44:45] offset:0 sc1
    global_store_dwordx4 v59, v[188:191], s[44:45] offset:1024 sc1
    v_lshlrev_b32 v35, 5, v2
    s_lshl_b32 s28, s4, 3
    v_add_u32 v34, s28, v35
    s_mul_i32 s28, s4, 4608
    s_add_u32 s28, s28, 1024
    s_and_b32 s29, s4, 1
    s_mul_i32 s29, s29, 504
    s_sub_u32 s30, s28, s29
    s_sub_u32 s28, s28, 504
    s_add_u32 s28, s28, s29
    v_add_u32 v36, s30, v4
    v_add_u32 v37, s28, v4
    v_mul_u32_u24 v38, 1152, v2
    s_mul_i32 s28, s4, 288
    v_lshl_add_u32 v38, v3, 3, v38
    v_add_u32 v38, s28, v38
    s_load_dwordx2 s[34:35], s[0:1], 16
    s_load_dwordx2 s[36:37], s[0:1], 24
    v_accvgpr_read_b32 v40, a240
    v_accvgpr_read_b32 v41, a241
    v_accvgpr_read_b32 v42, a242
    v_accvgpr_read_b32 v43, a243
    v_accvgpr_read_b32 v44, a244
    v_accvgpr_read_b32 v45, a245
    v_accvgpr_read_b32 v46, a246
    v_accvgpr_read_b32 v47, a247
    v_accvgpr_read_b32 v48, a248
    v_accvgpr_read_b32 v49, a249
    v_accvgpr_read_b32 v50, a250
    v_accvgpr_read_b32 v51, a251
    v_accvgpr_read_b32 v52, a252
    v_accvgpr_read_b32 v53, a253
    v_accvgpr_read_b32 v54, a254
    v_accvgpr_read_b32 v55, a255
    v_mov_b32 v56, v252
    v_mov_b32 v57, v253
    v_lshlrev_b32 v60, 16, v40
    v_and_b32 v61, 0xffff0000, v40
    v_lshlrev_b32 v62, 16, v41
    v_and_b32 v63, 0xffff0000, v41
    v_lshlrev_b32 v64, 16, v42
    v_and_b32 v65, 0xffff0000, v42
    v_lshlrev_b32 v66, 16, v43
    v_and_b32 v67, 0xffff0000, v43
    v_lshlrev_b32 v68, 16, v44
    v_and_b32 v69, 0xffff0000, v44
    v_lshlrev_b32 v70, 16, v45
    v_and_b32 v71, 0xffff0000, v45
    v_lshlrev_b32 v72, 16, v46
    v_and_b32 v73, 0xffff0000, v46
    v_lshlrev_b32 v74, 16, v47
    v_and_b32 v75, 0xffff0000, v47
    v_lshlrev_b32 v76, 16, v48
    v_and_b32 v77, 0xffff0000, v48
    v_lshlrev_b32 v78, 16, v49
    v_and_b32 v79, 0xffff0000, v49
    v_lshlrev_b32 v80, 16, v50
    v_and_b32 v81, 0xffff0000, v50
    v_lshlrev_b32 v82, 16, v51
    v_and_b32 v83, 0xffff0000, v51
    v_lshlrev_b32 v84, 16, v52
    v_and_b32 v85, 0xffff0000, v52
    v_lshlrev_b32 v86, 16, v53
    v_and_b32 v87, 0xffff0000, v53
    v_lshlrev_b32 v88, 16, v54
    v_and_b32 v89, 0xffff0000, v54
    v_lshlrev_b32 v90, 16, v55
    v_and_b32 v91, 0xffff0000, v55
    v_lshlrev_b32 v92, 16, v56
    v_and_b32 v93, 0xffff0000, v56
    v_lshlrev_b32 v94, 16, v57
    v_and_b32 v95, 0xffff0000, v57
    v_pk_add_f32 v[60:61], v[60:61], v[96:97]
    v_pk_add_f32 v[62:63], v[62:63], v[98:99]
    v_pk_add_f32 v[64:65], v[64:65], v[100:101]
    v_pk_add_f32 v[66:67], v[66:67], v[102:103]
    v_pk_add_f32 v[68:69], v[68:69], v[104:105]
    v_pk_add_f32 v[70:71], v[70:71], v[106:107]
    v_pk_add_f32 v[72:73], v[72:73], v[108:109]
    v_pk_add_f32 v[74:75], v[74:75], v[110:111]
    v_pk_add_f32 v[76:77], v[76:77], v[112:113]
    v_pk_add_f32 v[78:79], v[78:79], v[114:115]
    v_pk_add_f32 v[80:81], v[80:81], v[116:117]
    v_pk_add_f32 v[82:83], v[82:83], v[118:119]
    v_pk_add_f32 v[84:85], v[84:85], v[120:121]
    v_pk_add_f32 v[86:87], v[86:87], v[122:123]
    v_pk_add_f32 v[88:89], v[88:89], v[124:125]
    v_pk_add_f32 v[90:91], v[90:91], v[126:127]
    v_pk_add_f32 v[92:93], v[92:93], v[128:129]
    v_pk_add_f32 v[94:95], v[94:95], v[130:131]
    s_lshl_b32 s3, s83, 3
    global_load_short_d16_hi v132, v254, s[8:9] sc1
    v_add_u32 v254, 4096, v254
    global_load_short_d16_hi v133, v254, s[8:9] sc1
    v_add_u32 v254, 4096, v254
    global_load_short_d16_hi v134, v254, s[8:9] sc1
    v_add_u32 v254, 4096, v254
    global_load_short_d16_hi v135, v254, s[8:9] sc1
    v_add_u32 v254, 53248, v254
    global_load_short_d16_hi v136, v254, s[8:9] sc1
    v_add_u32 v254, 4096, v254
    global_load_short_d16_hi v137, v254, s[8:9] sc1
    v_add_u32 v254, 4096, v254
    global_load_short_d16_hi v138, v254, s[8:9] sc1
    v_add_u32 v254, 4096, v254
    global_load_short_d16_hi v139, v254, s[8:9] sc1
    v_add_u32 v254, 53248, v254
    global_load_short_d16_hi v140, v254, s[8:9] sc1
    v_add_u32 v254, 4096, v254
    global_load_short_d16_hi v141, v254, s[8:9] sc1
    v_add_u32 v254, 4096, v254
    global_load_short_d16_hi v142, v254, s[8:9] sc1
    v_add_u32 v254, 4096, v254
    global_load_short_d16_hi v143, v254, s[8:9] sc1
    v_add_u32 v254, 53248, v254
    global_load_short_d16_hi v144, v254, s[8:9] sc1
    v_add_u32 v254, 4096, v254
    global_load_short_d16_hi v145, v254, s[8:9] sc1
    v_add_u32 v254, 4096, v254
    global_load_short_d16_hi v146, v254, s[8:9] sc1
    v_add_u32 v254, 4096, v254
    global_load_short_d16_hi v147, v254, s[8:9] sc1
    v_add_u32 v254, 53248, v254
    global_load_short_d16_hi v148, v254, s[8:9] sc1
    v_add_u32 v254, 4096, v254
    global_load_short_d16_hi v149, v254, s[8:9] sc1
    v_add_u32 v254, 4096, v254
    global_load_short_d16_hi v150, v254, s[8:9] sc1
    v_add_u32 v254, 4096, v254
    global_load_short_d16_hi v151, v254, s[8:9] sc1
    v_add_u32 v254, 53248, v254
    global_load_short_d16_hi v152, v254, s[8:9] sc1
    v_add_u32 v254, 4096, v254
    global_load_short_d16_hi v153, v254, s[8:9] sc1
    v_add_u32 v254, 4096, v254
    global_load_short_d16_hi v154, v254, s[8:9] sc1
    v_add_u32 v254, 4096, v254
    global_load_short_d16_hi v155, v254, s[8:9] sc1
    v_add_u32 v254, 53248, v254
    global_load_short_d16_hi v156, v254, s[8:9] sc1
    v_add_u32 v254, 4096, v254
    global_load_short_d16_hi v157, v254, s[8:9] sc1
    v_add_u32 v254, 4096, v254
    global_load_short_d16_hi v158, v254, s[8:9] sc1
    v_add_u32 v254, 4096, v254
    global_load_short_d16_hi v159, v254, s[8:9] sc1
    v_add_u32 v254, 53248, v254
    global_load_short_d16_hi v160, v254, s[8:9] sc1
    v_add_u32 v254, 4096, v254
    global_load_short_d16_hi v161, v254, s[8:9] sc1
    v_add_u32 v254, 4096, v254
    global_load_short_d16_hi v162, v254, s[8:9] sc1
    v_add_u32 v254, 4096, v254
    global_load_short_d16_hi v163, v254, s[8:9] sc1
    v_add_u32 v254, 53248, v254
    global_load_short_d16_hi v164, v254, s[8:9] sc1
    v_add_u32 v254, 4096, v254
    global_load_short_d16_hi v165, v254, s[8:9] sc1
    v_add_u32 v254, 4096, v254
    global_load_short_d16_hi v166, v254, s[8:9] sc1
    v_add_u32 v254, 4096, v254
    global_load_short_d16_hi v167, v254, s[8:9] sc1
    s_waitcnt lgkmcnt(0)
    s_cmp_eq_u32 s6, 0
    s_cselect_b32 s34, s34, s36
    s_cselect_b32 s35, s35, s37
    s_mov_b32 s16, s34
    s_and_b32 s17, s35, 0xffff
    s_mov_b32 s18, 0x5100
    s_mov_b32 s19, 0x00020000
    s_lshl_b32 s28, s4, 6
    s_add_u32 s28, s28, 0
    v_add_u32 v8, s28, v1
    v_mul_u32_u24 v9, 21846, v8
    v_lshrrev_b32 v9, 16, v9
    v_mul_u32_u24 v5, 3, v9
    v_sub_u32 v8, v8, v5
    v_mul_u32_u24 v5, 36, v9
    v_lshl_add_u32 v5, v8, 4, v5
    s_lshl_b32 s28, s4, 6
    s_add_u32 s28, s28, 1
    v_add_u32 v8, s28, v1
    v_mul_u32_u24 v9, 21846, v8
    v_lshrrev_b32 v9, 16, v9
    v_mul_u32_u24 v6, 3, v9
    v_sub_u32 v8, v8, v6
    v_mul_u32_u24 v6, 36, v9
    v_lshl_add_u32 v6, v8, 4, v6
    s_lshl_b32 s28, s4, 6
    s_add_u32 s28, s28, 2
    v_add_u32 v8, s28, v1
    v_mul_u32_u24 v9, 21846, v8
    v_lshrrev_b32 v9, 16, v9
    v_mul_u32_u24 v7, 3, v9
    v_sub_u32 v8, v8, v7
    v_mul_u32_u24 v7, 36, v9
    v_lshl_add_u32 v7, v8, 4, v7
    s_lshl_b32 s28, s4, 10
    s_add_u32 s28, s28, 57344
    s_add_u32 m0, s28, 0
    s_mov_b32 s29, 0
    buffer_load_dwordx4 v5, s[16:19], s29 offen lds
    s_add_u32 m0, s28, 4096
    s_mov_b32 s29, 3060
    buffer_load_dwordx4 v6, s[16:19], s29 offen lds
    s_add_u32 m0, s28, 8192
    s_mov_b32 s29, 6120
    buffer_load_dwordx4 v7, s[16:19], s29 offen lds
    s_add_u32 m0, s28, 12288
    s_mov_b32 s29, 9216
    buffer_load_dwordx4 v5, s[16:19], s29 offen lds
    s_add_u32 m0, s28, 16384
    s_mov_b32 s29, 12276
    buffer_load_dwordx4 v6, s[16:19], s29 offen lds
    s_add_u32 m0, s28, 20480
    s_mov_b32 s29, 15336
    buffer_load_dwordx4 v7, s[16:19], s29 offen lds
    s_cmp_eq_u32 s4, 3
    s_cbranch_scc1 L_wkdma_end48_1
    s_add_u32 m0, s28, 24576
    s_mov_b32 s29, 18432
    buffer_load_dwordx4 v5, s[16:19], s29 offen lds
L_wkdma_end48_1:
    s_mul_i32 s28, s4, 6144
    s_add_u32 s28, s28, 19456
    v_add_u32 v234, s28, v4
    s_lshr_b32 s29, s4, 1
    s_and_b32 s30, s4, 1
    s_mul_i32 s31, s29, 3072
    s_add_u32 s31, s31, 19456
    s_lshl_b32 s32, s30, 10
    s_add_u32 s32, s32, s31
    v_add_u32 v235, s32, v4
    v_and_b32 v5, 31, v1
    v_lshlrev_b32 v6, 4, v5
    s_add_u32 s31, s31, 2048
    v_add_u32 v236, s31, v6
    s_lshl_b32 s31, s29, 10
    s_lshl_b32 s32, s30, 3
    s_add_u32 s31, s31, s32
    s_add_u32 s32, s31, 44032
    v_add_u32 v237, s32, v4
    s_add_u32 s32, s31, 147200
    v_add_u32 v239, s32, v4
    v_lshlrev_b32 v238, 4, v2
    v_lshrrev_b32 v5, 4, v5
    v_lshl_add_u32 v238, v5, 2, v238
    s_lshl_b32 s31, s29, 3
    s_add_u32 s31, s31, 46080
    v_add_u32 v238, s31, v238
    v_add_u32 v241, 147200, v4
    v_lshlrev_b32 v240, 2, v1
    v_add_u32 v240, 149248, v240
    s_lshl_b32 s28, s4, 14
    s_add_u32 s28, s28, 4096
    v_add_u32 v244, s28, v4
    s_lshl_b32 s28, s4, 12
    s_add_u32 s28, s28, 0x10000
    v_lshlrev_b32 v245, 3, v1
    v_add_u32 v245, s28, v245
    v_and_b32 v5, 31, v1
    v_min_u32 v5, 19, v5
    v_and_b32 v6, 32, v1
    v_add_lshl_u32 v246, v5, v6, 4
    s_lshl_b32 s28, s4, 15
    s_add_u32 s28, s28, 0x19000
    v_add_u32 v246, s28, v246
    s_mul_i32 s28, s6, 331776
    s_mul_i32 s29, s4, 18432
    s_add_u32 s28, s28, s29
    s_add_u32 s28, s28, 0x1000
    v_add_u32 v232, s28, v4
    s_mul_i32 s28, s6, 331776
    s_mul_i32 s29, s4, 9216
    s_add_u32 s28, s28, s29
    s_add_u32 s28, s28, 0xa3000
    v_add_u32 v233, s28, v4
    s_mul_i32 s28, s6, 331776
    s_and_b32 s29, s4, 1
    s_mul_i32 s30, s29, 18432
    s_add_u32 s28, s28, s30
    s_add_u32 s28, s28, 0x49000
    v_add_u32 v249, s28, v4
    s_mov_b32 s29, 0
L_px16:
    global_load_dwordx4 v[192:195], v59, s[46:47] offset:-4096 sc1
    global_load_dwordx4 v[196:199], v59, s[46:47] offset:-3072 sc1
    global_load_dwordx4 v[200:203], v59, s[46:47] offset:-2048 sc1
    global_load_dwordx4 v[204:207], v59, s[46:47] offset:-1024 sc1
    global_load_dwordx4 v[208:211], v59, s[46:47] offset:0 sc1
    global_load_dwordx4 v[212:215], v59, s[46:47] offset:1024 sc1
    s_waitcnt vmcnt(0)
    v_xor_b32 v16, s86, v195
    v_xor_b32 v17, s86, v199
    v_xor_b32 v18, s86, v203
    v_xor_b32 v19, s86, v207
    v_xor_b32 v20, s86, v211
    v_xor_b32 v21, s86, v215
    v_or3_b32 v16, v16, v17, v18
    v_or3_b32 v19, v19, v20, v21
    v_or_b32 v16, v16, v19
    v_cmp_ne_u32 vcc, 0, v16
    s_add_u32 s29, s29, 1
    s_cmp_gt_u32 s29, 400000
    s_cbranch_scc1 L_px16_ok
    s_cbranch_vccz L_px16_ok
    s_sleep 3
    s_branch L_px16
L_px16_ok:
    v_lshlrev_b32 v96, 16, v192
    v_and_b32 v97, 0xffff0000, v192
    v_lshlrev_b32 v98, 16, v193
    v_and_b32 v99, 0xffff0000, v193
    v_lshlrev_b32 v100, 16, v194
    v_and_b32 v101, 0xffff0000, v194
    v_lshlrev_b32 v102, 16, v196
    v_and_b32 v103, 0xffff0000, v196
    v_lshlrev_b32 v104, 16, v197
    v_and_b32 v105, 0xffff0000, v197
    v_lshlrev_b32 v106, 16, v198
    v_and_b32 v107, 0xffff0000, v198
    v_lshlrev_b32 v108, 16, v200
    v_and_b32 v109, 0xffff0000, v200
    v_lshlrev_b32 v110, 16, v201
    v_and_b32 v111, 0xffff0000, v201
    v_lshlrev_b32 v112, 16, v202
    v_and_b32 v113, 0xffff0000, v202
    v_lshlrev_b32 v114, 16, v204
    v_and_b32 v115, 0xffff0000, v204
    v_lshlrev_b32 v116, 16, v205
    v_and_b32 v117, 0xffff0000, v205
    v_lshlrev_b32 v118, 16, v206
    v_and_b32 v119, 0xffff0000, v206
    v_lshlrev_b32 v120, 16, v208
    v_and_b32 v121, 0xffff0000, v208
    v_lshlrev_b32 v122, 16, v209
    v_and_b32 v123, 0xffff0000, v209
    v_lshlrev_b32 v124, 16, v210
    v_and_b32 v125, 0xffff0000, v210
    v_lshlrev_b32 v126, 16, v212
    v_and_b32 v127, 0xffff0000, v212
    v_lshlrev_b32 v128, 16, v213
    v_and_b32 v129, 0xffff0000, v213
    v_lshlrev_b32 v130, 16, v214
    v_and_b32 v131, 0xffff0000, v214
    v_pk_add_f32 v[60:61], v[60:61], v[96:97]
    v_pk_add_f32 v[62:63], v[62:63], v[98:99]
    v_pk_add_f32 v[64:65], v[64:65], v[100:101]
    v_pk_add_f32 v[66:67], v[66:67], v[102:103]
    v_pk_add_f32 v[68:69], v[68:69], v[104:105]
    v_pk_add_f32 v[70:71], v[70:71], v[106:107]
    v_pk_add_f32 v[72:73], v[72:73], v[108:109]
    v_pk_add_f32 v[74:75], v[74:75], v[110:111]
    v_pk_add_f32 v[76:77], v[76:77], v[112:113]
    v_pk_add_f32 v[78:79], v[78:79], v[114:115]
    v_pk_add_f32 v[80:81], v[80:81], v[116:117]
    v_pk_add_f32 v[82:83], v[82:83], v[118:119]
    v_pk_add_f32 v[84:85], v[84:85], v[120:121]
    v_pk_add_f32 v[86:87], v[86:87], v[122:123]
    v_pk_add_f32 v[88:89], v[88:89], v[124:125]
    v_pk_add_f32 v[90:91], v[90:91], v[126:127]
    v_pk_add_f32 v[92:93], v[92:93], v[128:129]
    v_pk_add_f32 v[94:95], v[94:95], v[130:131]
    s_lshl_b32 s3, s83, 3
    v_pk_add_f32 v[16:17], v[60:61], v[62:63]
    v_pk_mul_f32 v[18:19], v[60:61], v[60:61]
    v_pk_fma_f32 v[18:19], v[62:63], v[62:63], v[18:19]
    v_pk_add_f32 v[16:17], v[16:17], v[64:65]
    v_pk_fma_f32 v[18:19], v[64:65], v[64:65], v[18:19]
    v_pk_add_f32 v[16:17], v[16:17], v[66:67]
    v_pk_fma_f32 v[18:19], v[66:67], v[66:67], v[18:19]
    v_pk_add_f32 v[16:17], v[16:17], v[68:69]
    v_pk_fma_f32 v[18:19], v[68:69], v[68:69], v[18:19]
    v_pk_add_f32 v[16:17], v[16:17], v[70:71]
    v_pk_fma_f32 v[18:19], v[70:71], v[70:71], v[18:19]
    v_pk_add_f32 v[16:17], v[16:17], v[72:73]
    v_pk_fma_f32 v[18:19], v[72:73], v[72:73], v[18:19]
    v_pk_add_f32 v[16:17], v[16:17], v[74:75]
    v_pk_fma_f32 v[18:19], v[74:75], v[74:75], v[18:19]
    v_pk_add_f32 v[16:17], v[16:17], v[76:77]
    v_pk_fma_f32 v[18:19], v[76:77], v[76:77], v[18:19]
    v_pk_add_f32 v[16:17], v[16:17], v[78:79]
    v_pk_fma_f32 v[18:19], v[78:79], v[78:79], v[18:19]
    v_pk_add_f32 v[16:17], v[16:17], v[80:81]
    v_pk_fma_f32 v[18:19], v[80:81], v[80:81], v[18:19]
    v_pk_add_f32 v[16:17], v[16:17], v[82:83]
    v_pk_fma_f32 v[18:19], v[82:83], v[82:83], v[18:19]
    v_pk_add_f32 v[16:17], v[16:17], v[84:85]
    v_pk_fma_f32 v[18:19], v[84:85], v[84:85], v[18:19]
    v_pk_add_f32 v[16:17], v[16:17], v[86:87]
    v_pk_fma_f32 v[18:19], v[86:87], v[86:87], v[18:19]
    v_pk_add_f32 v[16:17], v[16:17], v[88:89]
    v_pk_fma_f32 v[18:19], v[88:89], v[88:89], v[18:19]
    v_pk_add_f32 v[16:17], v[16:17], v[90:91]
    v_pk_fma_f32 v[18:19], v[90:91], v[90:91], v[18:19]
    v_pk_add_f32 v[16:17], v[16:17], v[92:93]
    v_pk_fma_f32 v[18:19], v[92:93], v[92:93], v[18:19]
    v_pk_add_f32 v[16:17], v[16:17], v[94:95]
    v_pk_fma_f32 v[18:19], v[94:95], v[94:95], v[18:19]
    v_add_f32 v20, v16, v17
    v_add_f32 v21, v18, v19
    v_mov_b32 v22, v20
    v_mov_b32 v23, v21
    s_nop 0
    v_permlane32_swap_b32 v20, v22
    v_permlane32_swap_b32 v21, v23
    v_add_f32 v20, v20, v22
    v_add_f32 v21, v21, v23
    v_mov_b32 v22, v20
    v_mov_b32 v23, v21
    s_nop 0
    v_permlane16_swap_b32 v20, v22
    v_permlane16_swap_b32 v21, v23
    v_add_f32 v20, v20, v22
    v_add_f32 v21, v21, v23
    ds_write_b64 v34, v[20:21] offset:0
    s_waitcnt lgkmcnt(0)
    s_barrier
    ds_read_b128 v[16:19], v35 offset:0
    ds_read_b128 v[20:23], v35 offset:16
    s_waitcnt lgkmcnt(1)
    v_pk_add_f32 v[16:17], v[16:17], v[18:19]
    s_waitcnt lgkmcnt(0)
    v_pk_add_f32 v[20:21], v[20:21], v[22:23]
    v_pk_add_f32 v[16:17], v[16:17], v[20:21]
    v_mul_f32 v32, 0x3ae38e39, v16
    v_mul_f32 v17, 0x3ae38e39, v17
    v_fma_f32 v17, -v32, v32, v17
    v_max_f32 v17, 0, v17
    v_add_f32 v17, 0x3727c5ac, v17
    v_rsq_f32 v33, v17
    s_nop 0
    v_mov_b32 v16, v33
    v_mul_f32 v18, v32, v33
    v_sub_f32 v18, 0, v18
    v_pk_fma_f32 v[20:21], v[60:61], v[16:17], v[18:19] op_sel_hi:[1,0,0]
    v_pk_fma_f32 v[60:61], v[20:21], v[132:133], v[60:61]
    v_pk_fma_f32 v[22:23], v[62:63], v[16:17], v[18:19] op_sel_hi:[1,0,0]
    v_pk_fma_f32 v[62:63], v[22:23], v[134:135], v[62:63]
    v_pk_fma_f32 v[20:21], v[64:65], v[16:17], v[18:19] op_sel_hi:[1,0,0]
    v_pk_fma_f32 v[64:65], v[20:21], v[136:137], v[64:65]
    v_pk_fma_f32 v[22:23], v[66:67], v[16:17], v[18:19] op_sel_hi:[1,0,0]
    v_pk_fma_f32 v[66:67], v[22:23], v[138:139], v[66:67]
    v_pk_fma_f32 v[20:21], v[68:69], v[16:17], v[18:19] op_sel_hi:[1,0,0]
    v_pk_fma_f32 v[68:69], v[20:21], v[140:141], v[68:69]
    v_pk_fma_f32 v[22:23], v[70:71], v[16:17], v[18:19] op_sel_hi:[1,0,0]
    v_pk_fma_f32 v[70:71], v[22:23], v[142:143], v[70:71]
    v_pk_fma_f32 v[20:21], v[72:73], v[16:17], v[18:19] op_sel_hi:[1,0,0]
    v_pk_fma_f32 v[72:73], v[20:21], v[144:145], v[72:73]
    v_pk_fma_f32 v[22:23], v[74:75], v[16:17], v[18:19] op_sel_hi:[1,0,0]
    v_pk_fma_f32 v[74:75], v[22:23], v[146:147], v[74:75]
    v_pk_fma_f32 v[20:21], v[76:77], v[16:17], v[18:19] op_sel_hi:[1,0,0]
    v_pk_fma_f32 v[76:77], v[20:21], v[148:149], v[76:77]
    v_pk_fma_f32 v[22:23], v[78:79], v[16:17], v[18:19] op_sel_hi:[1,0,0]
    v_pk_fma_f32 v[78:79], v[22:23], v[150:151], v[78:79]
    v_pk_fma_f32 v[20:21], v[80:81], v[16:17], v[18:19] op_sel_hi:[1,0,0]
    v_pk_fma_f32 v[80:81], v[20:21], v[152:153], v[80:81]
    v_pk_fma_f32 v[22:23], v[82:83], v[16:17], v[18:19] op_sel_hi:[1,0,0]
    v_pk_fma_f32 v[82:83], v[22:23], v[154:155], v[82:83]
    v_pk_fma_f32 v[20:21], v[84:85], v[16:17], v[18:19] op_sel_hi:[1,0,0]
    v_pk_fma_f32 v[84:85], v[20:21], v[156:157], v[84:85]
    v_pk_fma_f32 v[22:23], v[86:87], v[16:17], v[18:19] op_sel_hi:[1,0,0]
    v_pk_fma_f32 v[86:87], v[22:23], v[158:159], v[86:87]
    v_pk_fma_f32 v[20:21], v[88:89], v[16:17], v[18:19] op_sel_hi:[1,0,0]
    v_pk_fma_f32 v[88:89], v[20:21], v[160:161], v[88:89]
    v_pk_fma_f32 v[22:23], v[90:91], v[16:17], v[18:19] op_sel_hi:[1,0,0]
    v_pk_fma_f32 v[90:91], v[22:23], v[162:163], v[90:91]
    v_pk_fma_f32 v[20:21], v[92:93], v[16:17], v[18:19] op_sel_hi:[1,0,0]
    v_pk_fma_f32 v[92:93], v[20:21], v[164:165], v[92:93]
    v_pk_fma_f32 v[22:23], v[94:95], v[16:17], v[18:19] op_sel_hi:[1,0,0]
    v_pk_fma_f32 v[94:95], v[22:23], v[166:167], v[94:95]
    s_cmp_eq_u32 s83, 1
    s_cbranch_scc1 interleave_layers__grouped_kv_mqa__ssm_conv_h3__prompt_kernel_final
    s_cmp_lt_u32 s4, 2
    s_cbranch_scc1 interleave_layers__grouped_kv_mqa__ssm_conv_h3__prompt_kernel_b01
    v_pk_add_f32 v[16:17], v[60:61], v[62:63]
    v_pk_mul_f32 v[18:19], v[60:61], v[60:61]
    v_pk_fma_f32 v[18:19], v[62:63], v[62:63], v[18:19]
    v_pk_add_f32 v[16:17], v[16:17], v[64:65]
    v_pk_fma_f32 v[18:19], v[64:65], v[64:65], v[18:19]
    v_pk_add_f32 v[16:17], v[16:17], v[66:67]
    v_pk_fma_f32 v[18:19], v[66:67], v[66:67], v[18:19]
    v_pk_add_f32 v[16:17], v[16:17], v[68:69]
    v_pk_fma_f32 v[18:19], v[68:69], v[68:69], v[18:19]
    v_pk_add_f32 v[16:17], v[16:17], v[70:71]
    v_pk_fma_f32 v[18:19], v[70:71], v[70:71], v[18:19]
    v_pk_add_f32 v[16:17], v[16:17], v[72:73]
    v_pk_fma_f32 v[18:19], v[72:73], v[72:73], v[18:19]
    v_pk_add_f32 v[16:17], v[16:17], v[74:75]
    v_pk_fma_f32 v[18:19], v[74:75], v[74:75], v[18:19]
    v_pk_add_f32 v[16:17], v[16:17], v[76:77]
    v_pk_fma_f32 v[18:19], v[76:77], v[76:77], v[18:19]
    v_pk_add_f32 v[16:17], v[16:17], v[78:79]
    v_pk_fma_f32 v[18:19], v[78:79], v[78:79], v[18:19]
    v_pk_add_f32 v[16:17], v[16:17], v[80:81]
    v_pk_fma_f32 v[18:19], v[80:81], v[80:81], v[18:19]
    v_pk_add_f32 v[16:17], v[16:17], v[82:83]
    v_pk_fma_f32 v[18:19], v[82:83], v[82:83], v[18:19]
    v_pk_add_f32 v[16:17], v[16:17], v[84:85]
    v_pk_fma_f32 v[18:19], v[84:85], v[84:85], v[18:19]
    v_pk_add_f32 v[16:17], v[16:17], v[86:87]
    v_pk_fma_f32 v[18:19], v[86:87], v[86:87], v[18:19]
    v_pk_add_f32 v[16:17], v[16:17], v[88:89]
    v_pk_fma_f32 v[18:19], v[88:89], v[88:89], v[18:19]
    v_pk_add_f32 v[16:17], v[16:17], v[90:91]
    v_pk_fma_f32 v[18:19], v[90:91], v[90:91], v[18:19]
    v_pk_add_f32 v[16:17], v[16:17], v[92:93]
    v_pk_fma_f32 v[18:19], v[92:93], v[92:93], v[18:19]
    v_pk_add_f32 v[16:17], v[16:17], v[94:95]
    v_pk_fma_f32 v[18:19], v[94:95], v[94:95], v[18:19]
    v_add_f32 v20, v16, v17
    v_add_f32 v21, v18, v19
    v_mov_b32 v22, v20
    v_mov_b32 v23, v21
    s_nop 0
    v_permlane32_swap_b32 v20, v22
    v_permlane32_swap_b32 v21, v23
    v_add_f32 v20, v20, v22
    v_add_f32 v21, v21, v23
    v_mov_b32 v22, v20
    v_mov_b32 v23, v21
    s_nop 0
    v_permlane16_swap_b32 v20, v22
    v_permlane16_swap_b32 v21, v23
    v_add_f32 v20, v20, v22
    v_add_f32 v21, v21, v23
    ds_write_b64 v34, v[20:21] offset:512
    s_waitcnt lgkmcnt(0)
    s_barrier
    ds_read_b128 v[16:19], v35 offset:512
    ds_read_b128 v[20:23], v35 offset:528
    s_waitcnt lgkmcnt(1)
    v_pk_add_f32 v[16:17], v[16:17], v[18:19]
    s_waitcnt lgkmcnt(0)
    v_pk_add_f32 v[20:21], v[20:21], v[22:23]
    v_pk_add_f32 v[16:17], v[16:17], v[20:21]
    v_mul_f32 v32, 0x3ae38e39, v16
    v_mul_f32 v17, 0x3ae38e39, v17
    v_fma_f32 v17, -v32, v32, v17
    v_max_f32 v17, 0, v17
    v_add_f32 v17, 0x3727c5ac, v17
    v_rsq_f32 v33, v17
    s_nop 0
    v_mov_b32 v16, v33
    v_mul_f32 v18, v32, v33
    v_sub_f32 v18, 0, v18
    v_pk_fma_f32 v[20:21], v[60:61], v[16:17], v[18:19] op_sel_hi:[1,0,0]
    v_pk_fma_f32 v[22:23], v[62:63], v[16:17], v[18:19] op_sel_hi:[1,0,0]
    v_cvt_pk_bf16_f32 v24, v20, v21
    v_cvt_pk_bf16_f32 v25, v22, v23
    ds_write_b64 v36, v[24:25] offset:0
    v_pk_fma_f32 v[20:21], v[64:65], v[16:17], v[18:19] op_sel_hi:[1,0,0]
    v_pk_fma_f32 v[22:23], v[66:67], v[16:17], v[18:19] op_sel_hi:[1,0,0]
    v_cvt_pk_bf16_f32 v26, v20, v21
    v_cvt_pk_bf16_f32 v27, v22, v23
    ds_write_b64 v37, v[26:27] offset:512
    v_pk_fma_f32 v[20:21], v[68:69], v[16:17], v[18:19] op_sel_hi:[1,0,0]
    v_pk_fma_f32 v[22:23], v[70:71], v[16:17], v[18:19] op_sel_hi:[1,0,0]
    v_cvt_pk_bf16_f32 v24, v20, v21
    v_cvt_pk_bf16_f32 v25, v22, v23
    ds_write_b64 v36, v[24:25] offset:1024
    v_pk_fma_f32 v[20:21], v[72:73], v[16:17], v[18:19] op_sel_hi:[1,0,0]
    v_pk_fma_f32 v[22:23], v[74:75], v[16:17], v[18:19] op_sel_hi:[1,0,0]
    v_cvt_pk_bf16_f32 v26, v20, v21
    v_cvt_pk_bf16_f32 v27, v22, v23
    ds_write_b64 v37, v[26:27] offset:1536
    v_pk_fma_f32 v[20:21], v[76:77], v[16:17], v[18:19] op_sel_hi:[1,0,0]
    v_pk_fma_f32 v[22:23], v[78:79], v[16:17], v[18:19] op_sel_hi:[1,0,0]
    v_cvt_pk_bf16_f32 v24, v20, v21
    v_cvt_pk_bf16_f32 v25, v22, v23
    ds_write_b64 v36, v[24:25] offset:2048
    v_pk_fma_f32 v[20:21], v[80:81], v[16:17], v[18:19] op_sel_hi:[1,0,0]
    v_pk_fma_f32 v[22:23], v[82:83], v[16:17], v[18:19] op_sel_hi:[1,0,0]
    v_cvt_pk_bf16_f32 v26, v20, v21
    v_cvt_pk_bf16_f32 v27, v22, v23
    ds_write_b64 v37, v[26:27] offset:2560
    v_pk_fma_f32 v[20:21], v[84:85], v[16:17], v[18:19] op_sel_hi:[1,0,0]
    v_pk_fma_f32 v[22:23], v[86:87], v[16:17], v[18:19] op_sel_hi:[1,0,0]
    v_cvt_pk_bf16_f32 v24, v20, v21
    v_cvt_pk_bf16_f32 v25, v22, v23
    ds_write_b64 v36, v[24:25] offset:3072
    v_pk_fma_f32 v[20:21], v[88:89], v[16:17], v[18:19] op_sel_hi:[1,0,0]
    v_pk_fma_f32 v[22:23], v[90:91], v[16:17], v[18:19] op_sel_hi:[1,0,0]
    v_cvt_pk_bf16_f32 v26, v20, v21
    v_cvt_pk_bf16_f32 v27, v22, v23
    ds_write_b64 v37, v[26:27] offset:3584
    v_pk_fma_f32 v[20:21], v[92:93], v[16:17], v[18:19] op_sel_hi:[1,0,0]
    v_pk_fma_f32 v[22:23], v[94:95], v[16:17], v[18:19] op_sel_hi:[1,0,0]
    v_cvt_pk_bf16_f32 v24, v20, v21
    v_cvt_pk_bf16_f32 v25, v22, v23
    ds_write_b64 v36, v[24:25] offset:4096
    s_waitcnt lgkmcnt(0)
    s_barrier
    v_cvt_pk_bf16_f32 v40, v60, v61
    v_cvt_pk_bf16_f32 v41, v62, v63
    global_load_dwordx4 a[112:115], v232, s[8:9] offset:-4096 sc1
    v_cvt_pk_bf16_f32 v42, v64, v65
    v_cvt_pk_bf16_f32 v43, v66, v67
    v_cvt_pk_bf16_f32 v44, v68, v69
    global_load_dwordx4 a[116:119], v232, s[8:9] offset:-3072 sc1
    v_cvt_pk_bf16_f32 v45, v70, v71
    v_cvt_pk_bf16_f32 v46, v72, v73
    v_cvt_pk_bf16_f32 v47, v74, v75
    global_load_dwordx4 a[120:123], v232, s[8:9] offset:-2048 sc1
    v_cvt_pk_bf16_f32 v48, v76, v77
    v_cvt_pk_bf16_f32 v49, v78, v79
    v_cvt_pk_bf16_f32 v50, v80, v81
    global_load_dwordx4 a[124:127], v232, s[8:9] offset:-1024 sc1
    v_cvt_pk_bf16_f32 v51, v82, v83
    v_cvt_pk_bf16_f32 v52, v84, v85
    v_cvt_pk_bf16_f32 v53, v86, v87
    global_load_dwordx4 a[128:131], v232, s[8:9] offset:0 sc1
    v_cvt_pk_bf16_f32 v54, v88, v89
    v_cvt_pk_bf16_f32 v55, v90, v91
    v_cvt_pk_bf16_f32 v56, v92, v93
    global_load_dwordx4 a[132:135], v232, s[8:9] offset:1024 sc1
    v_cvt_pk_bf16_f32 v57, v94, v95
    v_accvgpr_write_b32 a240, v40
    v_accvgpr_write_b32 a241, v41
    global_load_dwordx4 a[136:139], v232, s[8:9] offset:2048 sc1
    v_accvgpr_write_b32 a242, v42
    v_accvgpr_write_b32 a243, v43
    v_accvgpr_write_b32 a244, v44
    global_load_dwordx4 a[140:143], v232, s[8:9] offset:3072 sc1
    v_accvgpr_write_b32 a245, v45
    v_accvgpr_write_b32 a246, v46
    v_accvgpr_write_b32 a247, v47
    v_add_u32 v232, 8192, v232
    v_accvgpr_write_b32 a248, v48
    v_accvgpr_write_b32 a249, v49
    v_accvgpr_write_b32 a250, v50
    global_load_dwordx4 a[144:147], v232, s[8:9] offset:-4096 sc1
    v_accvgpr_write_b32 a251, v51
    v_accvgpr_write_b32 a252, v52
    v_accvgpr_write_b32 a253, v53
    v_accvgpr_write_b32 a254, v54
    v_accvgpr_write_b32 a255, v55
    v_mov_b32 v252, v56
    v_mov_b32 v253, v57
    global_load_dwordx4 a[148:151], v232, s[8:9] offset:-3072 sc1
    global_load_dwordx4 a[152:155], v232, s[8:9] offset:-2048 sc1
    global_load_dwordx4 a[156:159], v232, s[8:9] offset:-1024 sc1
    global_load_dwordx4 a[160:163], v232, s[8:9] offset:0 sc1
    global_load_dwordx4 a[164:167], v232, s[8:9] offset:1024 sc1
    global_load_dwordx4 a[168:171], v232, s[8:9] offset:2048 sc1
    global_load_dwordx4 a[172:175], v232, s[8:9] offset:3072 sc1
    v_add_u32 v232, 8192, v232
    global_load_dwordx4 a[176:179], v232, s[8:9] offset:-4096 sc1
    global_load_dwordx4 a[180:183], v232, s[8:9] offset:-3072 sc1
    v_add_u32 v232, 57344, v232
    global_load_dwordx4 a[16:19], v249, s[8:9] offset:-4096 sc1
    global_load_dwordx4 a[20:23], v249, s[8:9] offset:-3072 sc1
    global_load_dwordx4 a[24:27], v249, s[8:9] offset:-2048 sc1
    global_load_dwordx4 a[28:31], v249, s[8:9] offset:-1024 sc1
    global_load_dwordx4 a[32:35], v249, s[8:9] offset:0 sc1
    global_load_dwordx4 a[36:39], v249, s[8:9] offset:1024 sc1
    global_load_dwordx4 a[40:43], v249, s[8:9] offset:2048 sc1
    global_load_dwordx4 a[44:47], v249, s[8:9] offset:3072 sc1
    v_add_u32 v249, 8192, v249
    global_load_dwordx4 a[48:51], v249, s[8:9] offset:-4096 sc1
    global_load_dwordx4 a[52:55], v249, s[8:9] offset:-3072 sc1
    global_load_dwordx4 a[56:59], v249, s[8:9] offset:-2048 sc1
    global_load_dwordx4 a[60:63], v249, s[8:9] offset:-1024 sc1
    global_load_dwordx4 a[184:187], v249, s[8:9] offset:0 sc1
    global_load_dwordx4 a[188:191], v249, s[8:9] offset:1024 sc1
    global_load_dwordx4 a[192:195], v249, s[8:9] offset:2048 sc1
    global_load_dwordx4 a[196:199], v249, s[8:9] offset:3072 sc1
    v_add_u32 v249, 8192, v249
    global_load_dwordx4 a[200:203], v249, s[8:9] offset:-4096 sc1
    global_load_dwordx4 a[204:207], v249, s[8:9] offset:-3072 sc1
    ds_read_b128 v[220:223], v4 offset:1024
    ds_read_b128 v[224:227], v4 offset:2048
    ds_read_b128 v[228:231], v4 offset:3072
    s_waitcnt vmcnt(17) lgkmcnt(2)
    v_mfma_f32_16x16x32_bf16 v[88:91], a[16:19], v[220:223], 0
    ds_read_b128 v[220:223], v4 offset:4096
    s_waitcnt vmcnt(16) lgkmcnt(2)
    v_mfma_f32_16x16x32_bf16 v[88:91], a[20:23], v[224:227], v[88:91]
    ds_read_b128 v[224:227], v4 offset:5120
    s_waitcnt vmcnt(15) lgkmcnt(2)
    v_mfma_f32_16x16x32_bf16 v[88:91], a[24:27], v[228:231], v[88:91]
    ds_read_b128 v[228:231], v4 offset:6144
    s_waitcnt vmcnt(14) lgkmcnt(2)
    v_mfma_f32_16x16x32_bf16 v[88:91], a[28:31], v[220:223], v[88:91]
    ds_read_b128 v[220:223], v4 offset:7168
    s_waitcnt vmcnt(13) lgkmcnt(2)
    v_mfma_f32_16x16x32_bf16 v[88:91], a[32:35], v[224:227], v[88:91]
    ds_read_b128 v[224:227], v4 offset:8192
    s_waitcnt vmcnt(12) lgkmcnt(2)
    v_mfma_f32_16x16x32_bf16 v[88:91], a[36:39], v[228:231], v[88:91]
    ds_read_b128 v[228:231], v4 offset:9216
    s_waitcnt vmcnt(11) lgkmcnt(2)
    v_mfma_f32_16x16x32_bf16 v[88:91], a[40:43], v[220:223], v[88:91]
    ds_read_b128 v[220:223], v4 offset:10240
    s_waitcnt vmcnt(10) lgkmcnt(2)
    v_mfma_f32_16x16x32_bf16 v[88:91], a[44:47], v[224:227], v[88:91]
    ds_read_b128 v[224:227], v4 offset:11264
    s_waitcnt vmcnt(9) lgkmcnt(2)
    v_mfma_f32_16x16x32_bf16 v[88:91], a[48:51], v[228:231], v[88:91]
    ds_read_b128 v[228:231], v4 offset:12288
    s_waitcnt vmcnt(8) lgkmcnt(2)
    v_mfma_f32_16x16x32_bf16 v[88:91], a[52:55], v[220:223], v[88:91]
    ds_read_b128 v[220:223], v4 offset:13312
    s_waitcnt vmcnt(7) lgkmcnt(2)
    v_mfma_f32_16x16x32_bf16 v[88:91], a[56:59], v[224:227], v[88:91]
    ds_read_b128 v[224:227], v4 offset:14336
    s_waitcnt vmcnt(6) lgkmcnt(2)
    v_mfma_f32_16x16x32_bf16 v[88:91], a[60:63], v[228:231], v[88:91]
    ds_read_b128 v[228:231], v4 offset:15360
    s_waitcnt vmcnt(5) lgkmcnt(2)
    v_mfma_f32_16x16x32_bf16 v[88:91], a[184:187], v[220:223], v[88:91]
    ds_read_b128 v[220:223], v4 offset:16384
    s_waitcnt vmcnt(4) lgkmcnt(2)
    v_mfma_f32_16x16x32_bf16 v[88:91], a[188:191], v[224:227], v[88:91]
    ds_read_b128 v[224:227], v4 offset:17408
    s_waitcnt vmcnt(3) lgkmcnt(2)
    v_mfma_f32_16x16x32_bf16 v[88:91], a[192:195], v[228:231], v[88:91]
    ds_read_b128 v[228:231], v4 offset:18432
    s_waitcnt vmcnt(2) lgkmcnt(2)
    v_mfma_f32_16x16x32_bf16 v[88:91], a[196:199], v[220:223], v[88:91]
    s_waitcnt vmcnt(1) lgkmcnt(1)
    v_mfma_f32_16x16x32_bf16 v[88:91], a[200:203], v[224:227], v[88:91]
    s_waitcnt vmcnt(0) lgkmcnt(0)
    v_mfma_f32_16x16x32_bf16 v[88:91], a[204:207], v[228:231], v[88:91]
    s_nop 7
    v_cvt_pk_bf16_f32 v92, v88, v89
    v_cvt_pk_bf16_f32 v93, v90, v91
    s_sub_u32 s29, s4, 2
    s_lshl_b32 s29, s29, 9
    s_add_u32 s29, s29, 149248
    v_lshlrev_b32 v5, 2, v1
    v_add_u32 v5, s29, v5
    ds_write_b32 v5, v92
    ds_write_b32 v5, v93 offset:256
    s_branch interleave_layers__grouped_kv_mqa__ssm_conv_h3__prompt_kernel_bj
interleave_layers__grouped_kv_mqa__ssm_conv_h3__prompt_kernel_b01:
    s_cmp_ge_u32 s4, 2
    s_cbranch_scc1 interleave_layers__grouped_kv_mqa__ssm_conv_h3__prompt_kernel_wf2_end
    v_lshrrev_b32 v8, 2, v1
    v_mul_u32_u24 v8, 48, v8
    v_and_b32 v9, 3, v1
    v_lshl_add_u32 v8, v9, 3, v8
    s_lshl_b32 s28, s4, 5
    s_add_u32 s28, s28, 57344
    v_add_u32 v8, s28, v8
    ds_read_b64_tr_b16 v[96:97], v8 offset:0
    ds_read_b64_tr_b16 v[98:99], v8 offset:768
    ds_read_b64_tr_b16 v[100:101], v8 offset:1536
    ds_read_b64_tr_b16 v[102:103], v8 offset:2304
    ds_read_b64_tr_b16 v[104:105], v8 offset:3072
    ds_read_b64_tr_b16 v[106:107], v8 offset:3840
    ds_read_b64_tr_b16 v[108:109], v8 offset:4608
    ds_read_b64_tr_b16 v[110:111], v8 offset:5376
    ds_read_b64_tr_b16 v[112:113], v8 offset:6144
    ds_read_b64_tr_b16 v[114:115], v8 offset:6912
    ds_read_b64_tr_b16 v[116:117], v8 offset:7680
    ds_read_b64_tr_b16 v[118:119], v8 offset:8448
    ds_read_b64_tr_b16 v[120:121], v8 offset:9216
    ds_read_b64_tr_b16 v[122:123], v8 offset:9984
    ds_read_b64_tr_b16 v[124:125], v8 offset:10752
    ds_read_b64_tr_b16 v[126:127], v8 offset:11520
    ds_read_b64_tr_b16 v[128:129], v8 offset:12288
    ds_read_b64_tr_b16 v[130:131], v8 offset:13056
    ds_read_b64_tr_b16 v[132:133], v8 offset:13824
    ds_read_b64_tr_b16 v[134:135], v8 offset:14592
    ds_read_b64_tr_b16 v[136:137], v8 offset:15360
    ds_read_b64_tr_b16 v[138:139], v8 offset:16128
    ds_read_b64_tr_b16 v[140:141], v8 offset:16896
    ds_read_b64_tr_b16 v[142:143], v8 offset:17664
    ds_read_b64_tr_b16 v[144:145], v8 offset:18432
    ds_read_b64_tr_b16 v[146:147], v8 offset:19200
    ds_read_b64_tr_b16 v[148:149], v8 offset:19968
    ds_read_b64_tr_b16 v[150:151], v8 offset:20736
    ds_read_b64_tr_b16 v[152:153], v8 offset:21504
    ds_read_b64_tr_b16 v[154:155], v8 offset:22272
    ds_read_b64_tr_b16 v[156:157], v8 offset:23040
    ds_read_b64_tr_b16 v[158:159], v8 offset:23808
    ds_read_b64_tr_b16 v[160:161], v8 offset:24576
    ds_read_b64_tr_b16 v[162:163], v8 offset:25344
    ds_read_b64_tr_b16 v[164:165], v8 offset:26112
    ds_read_b64_tr_b16 v[166:167], v8 offset:26880
interleave_layers__grouped_kv_mqa__ssm_conv_h3__prompt_kernel_wf2_end:
    v_pk_add_f32 v[16:17], v[60:61], v[62:63]
    v_pk_mul_f32 v[18:19], v[60:61], v[60:61]
    v_pk_fma_f32 v[18:19], v[62:63], v[62:63], v[18:19]
    v_pk_add_f32 v[16:17], v[16:17], v[64:65]
    v_pk_fma_f32 v[18:19], v[64:65], v[64:65], v[18:19]
    v_pk_add_f32 v[16:17], v[16:17], v[66:67]
    v_pk_fma_f32 v[18:19], v[66:67], v[66:67], v[18:19]
    v_pk_add_f32 v[16:17], v[16:17], v[68:69]
    v_pk_fma_f32 v[18:19], v[68:69], v[68:69], v[18:19]
    v_pk_add_f32 v[16:17], v[16:17], v[70:71]
    v_pk_fma_f32 v[18:19], v[70:71], v[70:71], v[18:19]
    v_pk_add_f32 v[16:17], v[16:17], v[72:73]
    v_pk_fma_f32 v[18:19], v[72:73], v[72:73], v[18:19]
    v_pk_add_f32 v[16:17], v[16:17], v[74:75]
    v_pk_fma_f32 v[18:19], v[74:75], v[74:75], v[18:19]
    v_pk_add_f32 v[16:17], v[16:17], v[76:77]
    v_pk_fma_f32 v[18:19], v[76:77], v[76:77], v[18:19]
    v_pk_add_f32 v[16:17], v[16:17], v[78:79]
    v_pk_fma_f32 v[18:19], v[78:79], v[78:79], v[18:19]
    v_pk_add_f32 v[16:17], v[16:17], v[80:81]
    v_pk_fma_f32 v[18:19], v[80:81], v[80:81], v[18:19]
    v_pk_add_f32 v[16:17], v[16:17], v[82:83]
    v_pk_fma_f32 v[18:19], v[82:83], v[82:83], v[18:19]
    v_pk_add_f32 v[16:17], v[16:17], v[84:85]
    v_pk_fma_f32 v[18:19], v[84:85], v[84:85], v[18:19]
    v_pk_add_f32 v[16:17], v[16:17], v[86:87]
    v_pk_fma_f32 v[18:19], v[86:87], v[86:87], v[18:19]
    v_pk_add_f32 v[16:17], v[16:17], v[88:89]
    v_pk_fma_f32 v[18:19], v[88:89], v[88:89], v[18:19]
    v_pk_add_f32 v[16:17], v[16:17], v[90:91]
    v_pk_fma_f32 v[18:19], v[90:91], v[90:91], v[18:19]
    v_pk_add_f32 v[16:17], v[16:17], v[92:93]
    v_pk_fma_f32 v[18:19], v[92:93], v[92:93], v[18:19]
    v_pk_add_f32 v[16:17], v[16:17], v[94:95]
    v_pk_fma_f32 v[18:19], v[94:95], v[94:95], v[18:19]
    v_add_f32 v20, v16, v17
    v_add_f32 v21, v18, v19
    v_mov_b32 v22, v20
    v_mov_b32 v23, v21
    s_nop 0
    v_permlane32_swap_b32 v20, v22
    v_permlane32_swap_b32 v21, v23
    v_add_f32 v20, v20, v22
    v_add_f32 v21, v21, v23
    v_mov_b32 v22, v20
    v_mov_b32 v23, v21
    s_nop 0
    v_permlane16_swap_b32 v20, v22
    v_permlane16_swap_b32 v21, v23
    v_add_f32 v20, v20, v22
    v_add_f32 v21, v21, v23
    ds_write_b64 v34, v[20:21] offset:512
    s_waitcnt lgkmcnt(0)
    s_barrier
    ds_read_b128 v[16:19], v35 offset:512
    ds_read_b128 v[20:23], v35 offset:528
    s_waitcnt lgkmcnt(1)
    v_pk_add_f32 v[16:17], v[16:17], v[18:19]
    s_waitcnt lgkmcnt(0)
    v_pk_add_f32 v[20:21], v[20:21], v[22:23]
    v_pk_add_f32 v[16:17], v[16:17], v[20:21]
    v_mul_f32 v32, 0x3ae38e39, v16
    v_mul_f32 v17, 0x3ae38e39, v17
    v_fma_f32 v17, -v32, v32, v17
    v_max_f32 v17, 0, v17
    v_add_f32 v17, 0x3727c5ac, v17
    v_rsq_f32 v33, v17
    s_nop 0
    v_mov_b32 v16, v33
    v_mul_f32 v18, v32, v33
    v_sub_f32 v18, 0, v18
    v_pk_fma_f32 v[20:21], v[60:61], v[16:17], v[18:19] op_sel_hi:[1,0,0]
    v_pk_fma_f32 v[22:23], v[62:63], v[16:17], v[18:19] op_sel_hi:[1,0,0]
    v_cvt_pk_bf16_f32 v24, v20, v21
    v_cvt_pk_bf16_f32 v25, v22, v23
    ds_write_b64 v36, v[24:25] offset:0
    v_pk_fma_f32 v[20:21], v[64:65], v[16:17], v[18:19] op_sel_hi:[1,0,0]
    v_pk_fma_f32 v[22:23], v[66:67], v[16:17], v[18:19] op_sel_hi:[1,0,0]
    v_cvt_pk_bf16_f32 v26, v20, v21
    v_cvt_pk_bf16_f32 v27, v22, v23
    ds_write_b64 v37, v[26:27] offset:512
    v_pk_fma_f32 v[20:21], v[68:69], v[16:17], v[18:19] op_sel_hi:[1,0,0]
    v_pk_fma_f32 v[22:23], v[70:71], v[16:17], v[18:19] op_sel_hi:[1,0,0]
    v_cvt_pk_bf16_f32 v24, v20, v21
    v_cvt_pk_bf16_f32 v25, v22, v23
    ds_write_b64 v36, v[24:25] offset:1024
    v_pk_fma_f32 v[20:21], v[72:73], v[16:17], v[18:19] op_sel_hi:[1,0,0]
    v_pk_fma_f32 v[22:23], v[74:75], v[16:17], v[18:19] op_sel_hi:[1,0,0]
    v_cvt_pk_bf16_f32 v26, v20, v21
    v_cvt_pk_bf16_f32 v27, v22, v23
    ds_write_b64 v37, v[26:27] offset:1536
    v_pk_fma_f32 v[20:21], v[76:77], v[16:17], v[18:19] op_sel_hi:[1,0,0]
    v_pk_fma_f32 v[22:23], v[78:79], v[16:17], v[18:19] op_sel_hi:[1,0,0]
    v_cvt_pk_bf16_f32 v24, v20, v21
    v_cvt_pk_bf16_f32 v25, v22, v23
    ds_write_b64 v36, v[24:25] offset:2048
    v_pk_fma_f32 v[20:21], v[80:81], v[16:17], v[18:19] op_sel_hi:[1,0,0]
    v_pk_fma_f32 v[22:23], v[82:83], v[16:17], v[18:19] op_sel_hi:[1,0,0]
    v_cvt_pk_bf16_f32 v26, v20, v21
    v_cvt_pk_bf16_f32 v27, v22, v23
    ds_write_b64 v37, v[26:27] offset:2560
    v_pk_fma_f32 v[20:21], v[84:85], v[16:17], v[18:19] op_sel_hi:[1,0,0]
    v_pk_fma_f32 v[22:23], v[86:87], v[16:17], v[18:19] op_sel_hi:[1,0,0]
    v_cvt_pk_bf16_f32 v24, v20, v21
    v_cvt_pk_bf16_f32 v25, v22, v23
    ds_write_b64 v36, v[24:25] offset:3072
    v_pk_fma_f32 v[20:21], v[88:89], v[16:17], v[18:19] op_sel_hi:[1,0,0]
    v_pk_fma_f32 v[22:23], v[90:91], v[16:17], v[18:19] op_sel_hi:[1,0,0]
    v_cvt_pk_bf16_f32 v26, v20, v21
    v_cvt_pk_bf16_f32 v27, v22, v23
    ds_write_b64 v37, v[26:27] offset:3584
    v_pk_fma_f32 v[20:21], v[92:93], v[16:17], v[18:19] op_sel_hi:[1,0,0]
    v_pk_fma_f32 v[22:23], v[94:95], v[16:17], v[18:19] op_sel_hi:[1,0,0]
    v_cvt_pk_bf16_f32 v24, v20, v21
    v_cvt_pk_bf16_f32 v25, v22, v23
    ds_write_b64 v36, v[24:25] offset:4096
    s_waitcnt lgkmcnt(0)
    s_barrier
    s_add_u32 s40, s8, 0x1a0000
    s_addc_u32 s41, s9, 0
    s_cmp_ge_u32 s4, 2
    s_cbranch_scc1 interleave_layers__grouped_kv_mqa__ssm_conv_h3__prompt_kernel_kv2_end
    s_cmp_eq_u32 s6, 0
    s_cbranch_scc0 interleave_layers__grouped_kv_mqa__ssm_conv_h3__prompt_kernel_kv2_v
    ds_read_b128 v[168:171], v4 offset:1024
    ds_read_b128 v[172:175], v4 offset:2048
    ds_read_b128 v[176:179], v4 offset:3072
    ds_read_b128 v[180:183], v4 offset:4096
    s_waitcnt lgkmcnt(3)
    v_mfma_f32_16x16x32_bf16 v[16:19], v[96:99], v[168:171], 0
    ds_read_b128 v[168:171], v4 offset:5120
    s_waitcnt lgkmcnt(3)
    v_mfma_f32_16x16x32_bf16 v[16:19], v[100:103], v[172:175], v[16:19]
    ds_read_b128 v[172:175], v4 offset:6144
    s_waitcnt lgkmcnt(3)
    v_mfma_f32_16x16x32_bf16 v[16:19], v[104:107], v[176:179], v[16:19]
    ds_read_b128 v[176:179], v4 offset:7168
    s_waitcnt lgkmcnt(3)
    v_mfma_f32_16x16x32_bf16 v[16:19], v[108:111], v[180:183], v[16:19]
    ds_read_b128 v[180:183], v4 offset:8192
    s_waitcnt lgkmcnt(3)
    v_mfma_f32_16x16x32_bf16 v[16:19], v[112:115], v[168:171], v[16:19]
    ds_read_b128 v[168:171], v4 offset:9216
    s_waitcnt lgkmcnt(3)
    v_mfma_f32_16x16x32_bf16 v[16:19], v[116:119], v[172:175], v[16:19]
    ds_read_b128 v[172:175], v4 offset:10240
    s_waitcnt lgkmcnt(3)
    v_mfma_f32_16x16x32_bf16 v[16:19], v[120:123], v[176:179], v[16:19]
    ds_read_b128 v[176:179], v4 offset:11264
    s_waitcnt lgkmcnt(3)
    v_mfma_f32_16x16x32_bf16 v[16:19], v[124:127], v[180:183], v[16:19]
    ds_read_b128 v[180:183], v4 offset:12288
    s_waitcnt lgkmcnt(3)
    v_mfma_f32_16x16x32_bf16 v[16:19], v[128:131], v[168:171], v[16:19]
    ds_read_b128 v[168:171], v4 offset:13312
    s_waitcnt lgkmcnt(3)
    v_mfma_f32_16x16x32_bf16 v[16:19], v[132:135], v[172:175], v[16:19]
    ds_read_b128 v[172:175], v4 offset:14336
    s_waitcnt lgkmcnt(3)
    v_mfma_f32_16x16x32_bf16 v[16:19], v[136:139], v[176:179], v[16:19]
    ds_read_b128 v[176:179], v4 offset:15360
    s_waitcnt lgkmcnt(3)
    v_mfma_f32_16x16x32_bf16 v[16:19], v[140:143], v[180:183], v[16:19]
    ds_read_b128 v[180:183], v4 offset:16384
    s_waitcnt lgkmcnt(3)
    v_mfma_f32_16x16x32_bf16 v[16:19], v[144:147], v[168:171], v[16:19]
    ds_read_b128 v[168:171], v4 offset:17408
    s_waitcnt lgkmcnt(3)
    v_mfma_f32_16x16x32_bf16 v[16:19], v[148:151], v[172:175], v[16:19]
    ds_read_b128 v[172:175], v4 offset:18432
    s_waitcnt lgkmcnt(3)
    v_mfma_f32_16x16x32_bf16 v[16:19], v[152:155], v[176:179], v[16:19]
    s_waitcnt lgkmcnt(2)
    v_mfma_f32_16x16x32_bf16 v[16:19], v[156:159], v[180:183], v[16:19]
    s_waitcnt lgkmcnt(1)
    v_mfma_f32_16x16x32_bf16 v[16:19], v[160:163], v[168:171], v[16:19]
    s_waitcnt lgkmcnt(0)
    v_mfma_f32_16x16x32_bf16 v[16:19], v[164:167], v[172:175], v[16:19]
    s_lshr_b32 s28, s5, 1
    s_and_b32 s29, s5, 1
    s_lshl_b32 s29, s29, 4
    v_add_u32 v5, s29, v2
    s_mov_b32 s30, 0x3eae1a93
    s_nop 2
    v_mul_f32 v16, s30, v16
    v_mul_f32 v17, s30, v17
    v_mul_f32 v18, s30, v18
    v_mul_f32 v19, s30, v19
    v_cvt_pk_bf16_f32 v20, v16, v17
    v_cvt_pk_bf16_f32 v21, v18, v19
    s_cmp_eq_u32 s4, 0
    s_cbranch_scc0 interleave_layers__grouped_kv_mqa__ssm_conv_h3__prompt_kernel_kv2_kl
    v_lshrrev_b32 v6, 1, v3
    v_lshl_add_u32 v6, v6, 5, v5
    v_lshlrev_b32 v6, 4, v6
    v_and_b32 v7, 1, v3
    v_lshl_add_u32 v6, v7, 3, v6
    s_lshl_b32 s28, s28, 10
    v_add_u32 v6, s28, v6
    global_store_dwordx2 v6, v[20:21], s[40:41] offset:0 sc1
    s_branch interleave_layers__grouped_kv_mqa__ssm_conv_h3__prompt_kernel_kv2_end
interleave_layers__grouped_kv_mqa__ssm_conv_h3__prompt_kernel_kv2_kl:
    v_mov_b32 v21, 0x3f803f80
    s_lshl_b32 s28, s28, 5
    v_add_u32 v6, s28, v5
    v_lshlrev_b32 v6, 3, v6
    v_add_u32 v6, 0x10000, v6
    s_mov_b64 exec, 0xffff
    global_store_dwordx2 v6, v[20:21], s[40:41] sc1
    s_mov_b64 exec, -1
    s_branch interleave_layers__grouped_kv_mqa__ssm_conv_h3__prompt_kernel_kv2_end
interleave_layers__grouped_kv_mqa__ssm_conv_h3__prompt_kernel_kv2_v:
    ds_read_b128 v[168:171], v4 offset:1024
    ds_read_b128 v[172:175], v4 offset:2048
    ds_read_b128 v[176:179], v4 offset:3072
    ds_read_b128 v[180:183], v4 offset:4096
    s_waitcnt lgkmcnt(3)
    v_mfma_f32_16x16x32_bf16 v[16:19], v[168:171], v[96:99], 0
    ds_read_b128 v[168:171], v4 offset:5120
    s_waitcnt lgkmcnt(3)
    v_mfma_f32_16x16x32_bf16 v[16:19], v[172:175], v[100:103], v[16:19]
    ds_read_b128 v[172:175], v4 offset:6144
    s_waitcnt lgkmcnt(3)
    v_mfma_f32_16x16x32_bf16 v[16:19], v[176:179], v[104:107], v[16:19]
    ds_read_b128 v[176:179], v4 offset:7168
    s_waitcnt lgkmcnt(3)
    v_mfma_f32_16x16x32_bf16 v[16:19], v[180:183], v[108:111], v[16:19]
    ds_read_b128 v[180:183], v4 offset:8192
    s_waitcnt lgkmcnt(3)
    v_mfma_f32_16x16x32_bf16 v[16:19], v[168:171], v[112:115], v[16:19]
    ds_read_b128 v[168:171], v4 offset:9216
    s_waitcnt lgkmcnt(3)
    v_mfma_f32_16x16x32_bf16 v[16:19], v[172:175], v[116:119], v[16:19]
    ds_read_b128 v[172:175], v4 offset:10240
    s_waitcnt lgkmcnt(3)
    v_mfma_f32_16x16x32_bf16 v[16:19], v[176:179], v[120:123], v[16:19]
    ds_read_b128 v[176:179], v4 offset:11264
    s_waitcnt lgkmcnt(3)
    v_mfma_f32_16x16x32_bf16 v[16:19], v[180:183], v[124:127], v[16:19]
    ds_read_b128 v[180:183], v4 offset:12288
    s_waitcnt lgkmcnt(3)
    v_mfma_f32_16x16x32_bf16 v[16:19], v[168:171], v[128:131], v[16:19]
    ds_read_b128 v[168:171], v4 offset:13312
    s_waitcnt lgkmcnt(3)
    v_mfma_f32_16x16x32_bf16 v[16:19], v[172:175], v[132:135], v[16:19]
    ds_read_b128 v[172:175], v4 offset:14336
    s_waitcnt lgkmcnt(3)
    v_mfma_f32_16x16x32_bf16 v[16:19], v[176:179], v[136:139], v[16:19]
    ds_read_b128 v[176:179], v4 offset:15360
    s_waitcnt lgkmcnt(3)
    v_mfma_f32_16x16x32_bf16 v[16:19], v[180:183], v[140:143], v[16:19]
    ds_read_b128 v[180:183], v4 offset:16384
    s_waitcnt lgkmcnt(3)
    v_mfma_f32_16x16x32_bf16 v[16:19], v[168:171], v[144:147], v[16:19]
    ds_read_b128 v[168:171], v4 offset:17408
    s_waitcnt lgkmcnt(3)
    v_mfma_f32_16x16x32_bf16 v[16:19], v[172:175], v[148:151], v[16:19]
    ds_read_b128 v[172:175], v4 offset:18432
    s_waitcnt lgkmcnt(3)
    v_mfma_f32_16x16x32_bf16 v[16:19], v[176:179], v[152:155], v[16:19]
    s_waitcnt lgkmcnt(2)
    v_mfma_f32_16x16x32_bf16 v[16:19], v[180:183], v[156:159], v[16:19]
    s_waitcnt lgkmcnt(1)
    v_mfma_f32_16x16x32_bf16 v[16:19], v[168:171], v[160:163], v[16:19]
    s_waitcnt lgkmcnt(0)
    v_mfma_f32_16x16x32_bf16 v[16:19], v[172:175], v[164:167], v[16:19]
    s_lshl_b32 s29, s4, 4
    v_add_u32 v5, s29, v2
    v_cmp_eq_u32 vcc, 18, v5
    s_nop 1
    v_cndmask_b32 v7, 0, 1.0, vcc
    v_cmp_gt_u32 vcc, 18, v5
    s_nop 1
    v_cndmask_b32 v16, v7, v16, vcc
    v_cndmask_b32 v17, v7, v17, vcc
    v_cndmask_b32 v18, v7, v18, vcc
    v_cndmask_b32 v19, v7, v19, vcc
    v_cvt_pk_bf16_f32 v20, v16, v17
    v_cvt_pk_bf16_f32 v21, v18, v19
    v_and_b32 v6, 1, v3
    v_lshl_add_u32 v6, v6, 5, v5
    v_lshlrev_b32 v6, 4, v6
    v_lshrrev_b32 v7, 1, v3
    v_lshl_add_u32 v6, v7, 3, v6
    s_lshl_b32 s28, s5, 10
    s_add_u32 s28, s28, 0x18000
    v_add_u32 v6, s28, v6
    global_store_dwordx2 v6, v[20:21], s[40:41] sc1
interleave_layers__grouped_kv_mqa__ssm_conv_h3__prompt_kernel_kv2_end:
    v_mov_b32 v8, 151616
    v_mov_b32 v9, s86
    s_waitcnt vmcnt(0)
    s_cmp_eq_u32 s4, 0
    s_cbranch_scc1 L_k217_w0
    ds_write_b32 v8, v9
    s_branch L_k217_d
L_k217_w0:
L_k217_sp:
    ds_read_b32 v10, v8
    s_waitcnt lgkmcnt(0)
    v_cmp_ne_u32 vcc, s86, v10
    s_nop 0
    s_cbranch_vccnz L_k217_sp
    s_cmp_lg_u32 s4, 0
    s_cbranch_scc1 L_ft18
    s_lshl_b32 s28, s5, 1
    s_add_u32 s28, s28, s6
    s_lshl_b32 s28, s28, 7
    s_add_u32 s28, s28, 0x2818000
    v_mov_b32 v5, s28
    v_mov_b32 v6, s86
    s_mov_b64 exec, 1
    global_store_dword v5, v6, s[8:9] sc1
    s_mov_b64 exec, -1
L_ft18:
L_k217_d:
    global_load_dwordx4 a[112:115], v232, s[8:9] offset:-4096 sc1
    global_load_dwordx4 a[116:119], v232, s[8:9] offset:-3072 sc1
    global_load_dwordx4 a[120:123], v232, s[8:9] offset:-2048 sc1
    global_load_dwordx4 a[124:127], v232, s[8:9] offset:-1024 sc1
    global_load_dwordx4 a[128:131], v232, s[8:9] offset:0 sc1
    global_load_dwordx4 a[132:135], v232, s[8:9] offset:1024 sc1
    global_load_dwordx4 a[136:139], v232, s[8:9] offset:2048 sc1
    global_load_dwordx4 a[140:143], v232, s[8:9] offset:3072 sc1
    v_add_u32 v232, 8192, v232
    global_load_dwordx4 a[144:147], v232, s[8:9] offset:-4096 sc1
    global_load_dwordx4 a[148:151], v232, s[8:9] offset:-3072 sc1
    global_load_dwordx4 a[152:155], v232, s[8:9] offset:-2048 sc1
    global_load_dwordx4 a[156:159], v232, s[8:9] offset:-1024 sc1
    global_load_dwordx4 a[160:163], v232, s[8:9] offset:0 sc1
    global_load_dwordx4 a[164:167], v232, s[8:9] offset:1024 sc1
    global_load_dwordx4 a[168:171], v232, s[8:9] offset:2048 sc1
    global_load_dwordx4 a[172:175], v232, s[8:9] offset:3072 sc1
    v_add_u32 v232, 8192, v232
    global_load_dwordx4 a[176:179], v232, s[8:9] offset:-4096 sc1
    global_load_dwordx4 a[180:183], v232, s[8:9] offset:-3072 sc1
    v_add_u32 v232, 57344, v232
    v_cvt_pk_bf16_f32 v40, v60, v61
    v_cvt_pk_bf16_f32 v41, v62, v63
    v_cvt_pk_bf16_f32 v42, v64, v65
    v_cvt_pk_bf16_f32 v43, v66, v67
    v_cvt_pk_bf16_f32 v44, v68, v69
    v_cvt_pk_bf16_f32 v45, v70, v71
    v_cvt_pk_bf16_f32 v46, v72, v73
    v_cvt_pk_bf16_f32 v47, v74, v75
    v_cvt_pk_bf16_f32 v48, v76, v77
    v_cvt_pk_bf16_f32 v49, v78, v79
    v_cvt_pk_bf16_f32 v50, v80, v81
    v_cvt_pk_bf16_f32 v51, v82, v83
    v_cvt_pk_bf16_f32 v52, v84, v85
    v_cvt_pk_bf16_f32 v53, v86, v87
    v_cvt_pk_bf16_f32 v54, v88, v89
    v_cvt_pk_bf16_f32 v55, v90, v91
    v_cvt_pk_bf16_f32 v56, v92, v93
    v_cvt_pk_bf16_f32 v57, v94, v95
    v_accvgpr_write_b32 a240, v40
    v_accvgpr_write_b32 a241, v41
    v_accvgpr_write_b32 a242, v42
    v_accvgpr_write_b32 a243, v43
    v_accvgpr_write_b32 a244, v44
    v_accvgpr_write_b32 a245, v45
    v_accvgpr_write_b32 a246, v46
    v_accvgpr_write_b32 a247, v47
    v_accvgpr_write_b32 a248, v48
    v_accvgpr_write_b32 a249, v49
    v_accvgpr_write_b32 a250, v50
    v_accvgpr_write_b32 a251, v51
    v_accvgpr_write_b32 a252, v52
    v_accvgpr_write_b32 a253, v53
    v_accvgpr_write_b32 a254, v54
    v_accvgpr_write_b32 a255, v55
    v_mov_b32 v252, v56
    v_mov_b32 v253, v57
interleave_layers__grouped_kv_mqa__ssm_conv_h3__prompt_kernel_bj:
    ds_read_b128 v[220:223], v4 offset:1024
    ds_read_b128 v[224:227], v4 offset:2048
    ds_read_b128 v[228:231], v4 offset:3072
    s_waitcnt vmcnt(17) lgkmcnt(2)
    v_mfma_f32_16x16x32_bf16 v[88:91], a[112:115], v[220:223], 0
    ds_read_b128 v[220:223], v4 offset:4096
    s_waitcnt vmcnt(16) lgkmcnt(2)
    v_mfma_f32_16x16x32_bf16 v[88:91], a[116:119], v[224:227], v[88:91]
    ds_read_b128 v[224:227], v4 offset:5120
    s_waitcnt vmcnt(15) lgkmcnt(2)
    v_mfma_f32_16x16x32_bf16 v[88:91], a[120:123], v[228:231], v[88:91]
    ds_read_b128 v[228:231], v4 offset:6144
    s_waitcnt vmcnt(14) lgkmcnt(2)
    v_mfma_f32_16x16x32_bf16 v[88:91], a[124:127], v[220:223], v[88:91]
    ds_read_b128 v[220:223], v4 offset:7168
    s_waitcnt vmcnt(13) lgkmcnt(2)
    v_mfma_f32_16x16x32_bf16 v[88:91], a[128:131], v[224:227], v[88:91]
    ds_read_b128 v[224:227], v4 offset:8192
    s_waitcnt vmcnt(12) lgkmcnt(2)
    v_mfma_f32_16x16x32_bf16 v[88:91], a[132:135], v[228:231], v[88:91]
    ds_read_b128 v[228:231], v4 offset:9216
    s_waitcnt vmcnt(11) lgkmcnt(2)
    v_mfma_f32_16x16x32_bf16 v[88:91], a[136:139], v[220:223], v[88:91]
    ds_read_b128 v[220:223], v4 offset:10240
    s_waitcnt vmcnt(10) lgkmcnt(2)
    v_mfma_f32_16x16x32_bf16 v[88:91], a[140:143], v[224:227], v[88:91]
    ds_read_b128 v[224:227], v4 offset:11264
    s_waitcnt vmcnt(9) lgkmcnt(2)
    v_mfma_f32_16x16x32_bf16 v[88:91], a[144:147], v[228:231], v[88:91]
    ds_read_b128 v[228:231], v4 offset:12288
    s_waitcnt vmcnt(8) lgkmcnt(2)
    v_mfma_f32_16x16x32_bf16 v[88:91], a[148:151], v[220:223], v[88:91]
    ds_read_b128 v[220:223], v4 offset:13312
    s_waitcnt vmcnt(7) lgkmcnt(2)
    v_mfma_f32_16x16x32_bf16 v[88:91], a[152:155], v[224:227], v[88:91]
    ds_read_b128 v[224:227], v4 offset:14336
    s_waitcnt vmcnt(6) lgkmcnt(2)
    v_mfma_f32_16x16x32_bf16 v[88:91], a[156:159], v[228:231], v[88:91]
    ds_read_b128 v[228:231], v4 offset:15360
    s_waitcnt vmcnt(5) lgkmcnt(2)
    v_mfma_f32_16x16x32_bf16 v[88:91], a[160:163], v[220:223], v[88:91]
    ds_read_b128 v[220:223], v4 offset:16384
    s_waitcnt vmcnt(4) lgkmcnt(2)
    v_mfma_f32_16x16x32_bf16 v[88:91], a[164:167], v[224:227], v[88:91]
    ds_read_b128 v[224:227], v4 offset:17408
    s_waitcnt vmcnt(3) lgkmcnt(2)
    v_mfma_f32_16x16x32_bf16 v[88:91], a[168:171], v[228:231], v[88:91]
    ds_read_b128 v[228:231], v4 offset:18432
    s_waitcnt vmcnt(2) lgkmcnt(2)
    v_mfma_f32_16x16x32_bf16 v[88:91], a[172:175], v[220:223], v[88:91]
    s_waitcnt vmcnt(1) lgkmcnt(1)
    v_mfma_f32_16x16x32_bf16 v[88:91], a[176:179], v[224:227], v[88:91]
    s_waitcnt vmcnt(0) lgkmcnt(0)
    v_mfma_f32_16x16x32_bf16 v[88:91], a[180:183], v[228:231], v[88:91]
    s_nop 7
    v_cvt_pk_bf16_f32 v92, v88, v89
    v_cvt_pk_bf16_f32 v93, v90, v91
    ds_write_b64 v239, v[92:93]
    global_load_dwordx4 v[132:135], v232, s[8:9] offset:-4096 sc1
    global_load_dwordx4 v[136:139], v232, s[8:9] offset:-3072 sc1
    global_load_dwordx4 v[140:143], v232, s[8:9] offset:-2048 sc1
    global_load_dwordx4 v[144:147], v232, s[8:9] offset:-1024 sc1
    global_load_dwordx4 v[148:151], v232, s[8:9] offset:0 sc1
    global_load_dwordx4 v[152:155], v232, s[8:9] offset:1024 sc1
    global_load_dwordx4 v[156:159], v232, s[8:9] offset:2048 sc1
    global_load_dwordx4 v[160:163], v232, s[8:9] offset:3072 sc1
    v_add_u32 v232, 8192, v232
    global_load_dwordx4 v[164:167], v232, s[8:9] offset:-4096 sc1
    s_waitcnt lgkmcnt(0)
    s_barrier
    ds_read_b128 v[80:83], v241
    ds_read_b128 v[84:87], v241 offset:1024
    ds_read_b32 v88, v240
    v_mov_b32 v89, 0
    v_mov_b32 v96, 0
    v_mov_b32 v97, 0
    v_mov_b32 v98, 0
    v_mov_b32 v99, 0
    v_mov_b32 v100, 0
    v_mov_b32 v101, 0
    v_mov_b32 v102, 0
    v_mov_b32 v103, 0
    v_mov_b32 v104, 0
    v_mov_b32 v105, 0
    v_mov_b32 v106, 0
    v_mov_b32 v107, 0
    v_mov_b32 v108, 0
    v_mov_b32 v109, 0
    v_mov_b32 v110, 0
    v_mov_b32 v111, 0
    v_mov_b32 v112, 0
    v_mov_b32 v113, 0
    v_mov_b32 v114, 0
    v_mov_b32 v115, 0
    v_mov_b32 v116, 0
    v_mov_b32 v117, 0
    v_mov_b32 v118, 0
    v_mov_b32 v119, 0
    v_mov_b32 v120, 0
    v_mov_b32 v121, 0
    v_mov_b32 v122, 0
    v_mov_b32 v123, 0
    v_mov_b32 v124, 0
    v_mov_b32 v125, 0
    v_mov_b32 v126, 0
    v_mov_b32 v127, 0
    v_mov_b32 v128, 0
    v_mov_b32 v129, 0
    v_mov_b32 v130, 0
    v_mov_b32 v131, 0
    s_lshl_b32 s28, s4, 13
    s_add_u32 s28, s28, 0x2818000
    v_lshlrev_b32 v5, 7, v1
    v_add_u32 v5, s28, v5
    s_mov_b32 s29, 0
L_pl19:
    global_load_dword v6, v5, s[8:9] sc1
    s_add_u32 s29, s29, 1
    s_waitcnt vmcnt(0)
    v_cmp_ne_u32 vcc, s86, v6
    s_cmp_gt_u32 s29, 400000
    s_cbranch_scc1 L_pl19_x
    s_cbranch_vccz L_pl19_x
    s_sleep 3
    s_branch L_pl19
L_pl19_x:
    s_add_u32 s40, s8, 0x1a0000
    s_addc_u32 s41, s9, 0
    global_load_dwordx4 a[0:3], v244, s[40:41] offset:-4096 sc1
    global_load_dwordx2 a[64:65], v245, s[40:41] offset:0 sc1
    global_load_dwordx4 a[80:83], v246, s[40:41] offset:-4096 sc1
    global_load_dwordx4 a[84:87], v246, s[40:41] offset:-3072 sc1
    global_load_dwordx4 a[4:7], v244, s[40:41] offset:-3072 sc1
    global_load_dwordx4 a[88:91], v246, s[40:41] offset:-2048 sc1
    global_load_dwordx4 a[92:95], v246, s[40:41] offset:-1024 sc1
    global_load_dwordx4 a[8:11], v244, s[40:41] offset:-2048 sc1
    global_load_dwordx2 a[66:67], v245, s[40:41] offset:512 sc1
    global_load_dwordx4 a[96:99], v246, s[40:41] offset:0 sc1
    global_load_dwordx4 a[100:103], v246, s[40:41] offset:1024 sc1
    global_load_dwordx4 a[12:15], v244, s[40:41] offset:-1024 sc1
    global_load_dwordx4 a[104:107], v246, s[40:41] offset:2048 sc1
    global_load_dwordx4 a[108:111], v246, s[40:41] offset:3072 sc1
    s_mov_b32 s83, 1
    s_branch interleave_layers__grouped_kv_mqa__ssm_conv_h3__prompt_kernel_layer
interleave_layers__grouped_kv_mqa__ssm_conv_h3__prompt_kernel_final:
    s_nop 7
    s_load_dwordx2 s[32:33], s[0:1], 88
    s_waitcnt lgkmcnt(0)
    s_mov_b32 s12, s32
    s_and_b32 s13, s33, 0xffff
    s_mov_b32 s14, 0x240000
    s_mov_b32 s15, 0x00020000
    s_lshr_b32 s28, s4, 1
    s_cmp_eq_u32 s28, s6
    s_cbranch_scc0 interleave_layers__grouped_kv_mqa__ssm_conv_h3__prompt_kernel_done
    v_cvt_pk_bf16_f32 v16, v60, v61
    v_cvt_pk_bf16_f32 v17, v62, v63
    buffer_store_dwordx2 v[16:17], v38, s[12:15], s7 offen offset:0
    v_cvt_pk_bf16_f32 v18, v64, v65
    v_cvt_pk_bf16_f32 v19, v66, v67
    buffer_store_dwordx2 v[18:19], v38, s[12:15], s7 offen offset:32
    v_cvt_pk_bf16_f32 v20, v68, v69
    v_cvt_pk_bf16_f32 v21, v70, v71
    buffer_store_dwordx2 v[20:21], v38, s[12:15], s7 offen offset:64
    v_cvt_pk_bf16_f32 v22, v72, v73
    v_cvt_pk_bf16_f32 v23, v74, v75
    buffer_store_dwordx2 v[22:23], v38, s[12:15], s7 offen offset:96
    v_cvt_pk_bf16_f32 v16, v76, v77
    v_cvt_pk_bf16_f32 v17, v78, v79
    buffer_store_dwordx2 v[16:17], v38, s[12:15], s7 offen offset:128
    v_cvt_pk_bf16_f32 v18, v80, v81
    v_cvt_pk_bf16_f32 v19, v82, v83
    buffer_store_dwordx2 v[18:19], v38, s[12:15], s7 offen offset:160
    v_cvt_pk_bf16_f32 v20, v84, v85
    v_cvt_pk_bf16_f32 v21, v86, v87
    buffer_store_dwordx2 v[20:21], v38, s[12:15], s7 offen offset:192
    v_cvt_pk_bf16_f32 v22, v88, v89
    v_cvt_pk_bf16_f32 v23, v90, v91
    buffer_store_dwordx2 v[22:23], v38, s[12:15], s7 offen offset:224
    v_cvt_pk_bf16_f32 v16, v92, v93
    v_cvt_pk_bf16_f32 v17, v94, v95
    buffer_store_dwordx2 v[16:17], v38, s[12:15], s7 offen offset:256
    s_branch interleave_layers__grouped_kv_mqa__ssm_conv_h3__prompt_kernel_exit
interleave_layers__grouped_kv_mqa__ssm_conv_h3__prompt_kernel_at_slow:
    s_waitcnt vmcnt(0) lgkmcnt(0)
    s_barrier
    s_mul_i32 s28, s4, 6144
    s_add_u32 s28, s28, 19456
    v_add_u32 v234, s28, v4
    s_lshr_b32 s29, s4, 1
    s_and_b32 s30, s4, 1
    s_mul_i32 s31, s29, 3072
    s_add_u32 s31, s31, 19456
    s_lshl_b32 s32, s30, 10
    s_add_u32 s32, s32, s31
    v_add_u32 v235, s32, v4
    v_and_b32 v5, 31, v1
    v_lshlrev_b32 v6, 4, v5
    s_add_u32 s31, s31, 2048
    v_add_u32 v236, s31, v6
    s_lshl_b32 s31, s29, 10
    s_lshl_b32 s32, s30, 3
    s_add_u32 s31, s31, s32
    s_add_u32 s32, s31, 44032
    v_add_u32 v237, s32, v4
    s_add_u32 s32, s31, 147200
    v_add_u32 v239, s32, v4
    v_lshlrev_b32 v238, 4, v2
    v_lshrrev_b32 v5, 4, v5
    v_lshl_add_u32 v238, v5, 2, v238
    s_lshl_b32 s31, s29, 3
    s_add_u32 s31, s31, 46080
    v_add_u32 v238, s31, v238
    v_add_u32 v241, 147200, v4
    v_lshlrev_b32 v240, 2, v1
    v_add_u32 v240, 149248, v240
    s_lshl_b32 s28, s4, 14
    s_add_u32 s28, s28, 4096
    v_add_u32 v244, s28, v4
    s_lshl_b32 s28, s4, 12
    s_add_u32 s28, s28, 0x10000
    v_lshlrev_b32 v245, 3, v1
    v_add_u32 v245, s28, v245
    v_and_b32 v5, 31, v1
    v_min_u32 v5, 19, v5
    v_and_b32 v6, 32, v1
    v_add_lshl_u32 v246, v5, v6, 4
    s_lshl_b32 s28, s4, 15
    s_add_u32 s28, s28, 0x19000
    v_add_u32 v246, s28, v246
    s_mul_i32 s28, s6, 331776
    s_mul_i32 s29, s4, 18432
    s_add_u32 s28, s28, s29
    s_add_u32 s28, s28, 0x1000
    v_add_u32 v232, s28, v4
    s_mul_i32 s28, s6, 331776
    s_mul_i32 s29, s4, 9216
    s_add_u32 s28, s28, s29
    s_add_u32 s28, s28, 0xa3000
    v_add_u32 v233, s28, v4
    v_mov_b32 v96, 0
    v_mov_b32 v97, 0
    v_mov_b32 v98, 0
    v_mov_b32 v99, 0
    v_mov_b32 v100, 0
    v_mov_b32 v101, 0
    v_mov_b32 v102, 0
    v_mov_b32 v103, 0
    v_mov_b32 v104, 0
    v_mov_b32 v105, 0
    v_mov_b32 v106, 0
    v_mov_b32 v107, 0
    v_mov_b32 v108, 0
    v_mov_b32 v109, 0
    v_mov_b32 v110, 0
    v_mov_b32 v111, 0
    v_mov_b32 v112, 0
    v_mov_b32 v113, 0
    v_mov_b32 v114, 0
    v_mov_b32 v115, 0
    v_mov_b32 v116, 0
    v_mov_b32 v117, 0
    v_mov_b32 v118, 0
    v_mov_b32 v119, 0
    v_mov_b32 v120, 0
    v_mov_b32 v121, 0
    v_mov_b32 v122, 0
    v_mov_b32 v123, 0
    v_mov_b32 v124, 0
    v_mov_b32 v125, 0
    v_mov_b32 v126, 0
    v_mov_b32 v127, 0
    v_mov_b32 v128, 0
    v_mov_b32 v129, 0
    v_mov_b32 v130, 0
    v_mov_b32 v131, 0
    s_mov_b32 s82, 0
interleave_layers__grouped_kv_mqa__ssm_conv_h3__prompt_kernel_sp_ph:
    global_load_dwordx4 v[148:151], v232, s[8:9] offset:-4096 sc1
    global_load_dwordx4 v[152:155], v232, s[8:9] offset:-3072 sc1
    global_load_dwordx4 v[156:159], v232, s[8:9] offset:-2048 sc1
    global_load_dwordx4 v[160:163], v232, s[8:9] offset:-1024 sc1
    global_load_dwordx4 v[164:167], v232, s[8:9] offset:0 sc1
    global_load_dwordx4 v[168:171], v232, s[8:9] offset:1024 sc1
    global_load_dwordx4 v[172:175], v232, s[8:9] offset:2048 sc1
    global_load_dwordx4 v[176:179], v232, s[8:9] offset:3072 sc1
    v_add_u32 v232, 8192, v232
    global_load_dwordx4 v[180:183], v232, s[8:9] offset:-4096 sc1
    global_load_dwordx4 v[184:187], v232, s[8:9] offset:-3072 sc1
    global_load_dwordx4 v[188:191], v232, s[8:9] offset:-2048 sc1
    global_load_dwordx4 v[192:195], v232, s[8:9] offset:-1024 sc1
    global_load_dwordx4 v[196:199], v232, s[8:9] offset:0 sc1
    global_load_dwordx4 v[200:203], v232, s[8:9] offset:1024 sc1
    global_load_dwordx4 v[204:207], v232, s[8:9] offset:2048 sc1
    global_load_dwordx4 v[208:211], v232, s[8:9] offset:3072 sc1
    v_add_u32 v232, 8192, v232
    global_load_dwordx4 v[212:215], v232, s[8:9] offset:-4096 sc1
    global_load_dwordx4 v[216:219], v232, s[8:9] offset:-3072 sc1
    v_add_u32 v232, 57344, v232
    ds_read_b128 v[220:223], v4 offset:1024
    ds_read_b128 v[224:227], v4 offset:2048
    ds_read_b128 v[228:231], v4 offset:3072
    s_waitcnt vmcnt(17) lgkmcnt(2)
    v_mfma_f32_16x16x32_bf16 v[88:91], v[148:151], v[220:223], 0
    ds_read_b128 v[220:223], v4 offset:4096
    s_waitcnt vmcnt(16) lgkmcnt(2)
    v_mfma_f32_16x16x32_bf16 v[88:91], v[152:155], v[224:227], v[88:91]
    ds_read_b128 v[224:227], v4 offset:5120
    s_waitcnt vmcnt(15) lgkmcnt(2)
    v_mfma_f32_16x16x32_bf16 v[88:91], v[156:159], v[228:231], v[88:91]
    ds_read_b128 v[228:231], v4 offset:6144
    s_waitcnt vmcnt(14) lgkmcnt(2)
    v_mfma_f32_16x16x32_bf16 v[88:91], v[160:163], v[220:223], v[88:91]
    ds_read_b128 v[220:223], v4 offset:7168
    s_waitcnt vmcnt(13) lgkmcnt(2)
    v_mfma_f32_16x16x32_bf16 v[88:91], v[164:167], v[224:227], v[88:91]
    ds_read_b128 v[224:227], v4 offset:8192
    s_waitcnt vmcnt(12) lgkmcnt(2)
    v_mfma_f32_16x16x32_bf16 v[88:91], v[168:171], v[228:231], v[88:91]
    ds_read_b128 v[228:231], v4 offset:9216
    s_waitcnt vmcnt(11) lgkmcnt(2)
    v_mfma_f32_16x16x32_bf16 v[88:91], v[172:175], v[220:223], v[88:91]
    ds_read_b128 v[220:223], v4 offset:10240
    s_waitcnt vmcnt(10) lgkmcnt(2)
    v_mfma_f32_16x16x32_bf16 v[88:91], v[176:179], v[224:227], v[88:91]
    ds_read_b128 v[224:227], v4 offset:11264
    s_waitcnt vmcnt(9) lgkmcnt(2)
    v_mfma_f32_16x16x32_bf16 v[88:91], v[180:183], v[228:231], v[88:91]
    ds_read_b128 v[228:231], v4 offset:12288
    s_waitcnt vmcnt(8) lgkmcnt(2)
    v_mfma_f32_16x16x32_bf16 v[88:91], v[184:187], v[220:223], v[88:91]
    ds_read_b128 v[220:223], v4 offset:13312
    s_waitcnt vmcnt(7) lgkmcnt(2)
    v_mfma_f32_16x16x32_bf16 v[88:91], v[188:191], v[224:227], v[88:91]
    ds_read_b128 v[224:227], v4 offset:14336
    s_waitcnt vmcnt(6) lgkmcnt(2)
    v_mfma_f32_16x16x32_bf16 v[88:91], v[192:195], v[228:231], v[88:91]
    ds_read_b128 v[228:231], v4 offset:15360
    s_waitcnt vmcnt(5) lgkmcnt(2)
    v_mfma_f32_16x16x32_bf16 v[88:91], v[196:199], v[220:223], v[88:91]
    ds_read_b128 v[220:223], v4 offset:16384
    s_waitcnt vmcnt(4) lgkmcnt(2)
    v_mfma_f32_16x16x32_bf16 v[88:91], v[200:203], v[224:227], v[88:91]
    ds_read_b128 v[224:227], v4 offset:17408
    s_waitcnt vmcnt(3) lgkmcnt(2)
    v_mfma_f32_16x16x32_bf16 v[88:91], v[204:207], v[228:231], v[88:91]
    ds_read_b128 v[228:231], v4 offset:18432
    s_waitcnt vmcnt(2) lgkmcnt(2)
    v_mfma_f32_16x16x32_bf16 v[88:91], v[208:211], v[220:223], v[88:91]
    s_waitcnt vmcnt(1) lgkmcnt(1)
    v_mfma_f32_16x16x32_bf16 v[88:91], v[212:215], v[224:227], v[88:91]
    s_waitcnt vmcnt(0) lgkmcnt(0)
    v_mfma_f32_16x16x32_bf16 v[88:91], v[216:219], v[228:231], v[88:91]
    s_nop 7
    v_cvt_pk_bf16_f32 v92, v88, v89
    v_cvt_pk_bf16_f32 v93, v90, v91
    ds_write_b64 v239, v[92:93]
    s_waitcnt lgkmcnt(0)
    s_barrier
    ds_read_b128 v[80:83], v241
    ds_read_b128 v[84:87], v241 offset:1024
    ds_read_b32 v88, v240
    v_mov_b32 v89, 0
    v_subrev_u32 v8, 4096, v244
    v_and_b32 v9, 31, v1
    v_lshlrev_b32 v9, 3, v9
    s_lshl_b32 s28, s4, 12
    s_add_u32 s28, s28, 0x10000
    v_add_u32 v9, s28, v9
    v_subrev_u32 v10, 4096, v246
    v_mov_b32 v11, 0xff800000
    v_mov_b32 v12, 0xff800000
    s_mov_b32 s33, 16
    s_waitcnt vmcnt(0) lgkmcnt(0)
interleave_layers__grouped_kv_mqa__ssm_conv_h3__prompt_kernel_sp_mx:
    global_load_dwordx4 v[148:151], v8, s[40:41] sc1
    global_load_dwordx2 v[152:153], v9, s[40:41] sc1
    v_add_u32 v8, 1024, v8
    v_add_u32 v9, 256, v9
    s_waitcnt vmcnt(1)
    v_mfma_f32_32x32x16_bf16 v[16:31], v[148:151], v[80:83], 0
    v_mfma_f32_32x32x16_bf16 v[32:47], v[148:151], v[84:87], 0
    s_waitcnt vmcnt(0)
    s_nop 8
    v_mfma_f32_32x32x4_2b_bf16 v[16:47], v[152:153], v[88:89], v[16:47] cbsz:1 abid:0
    s_nop 15
    s_nop 3
    v_max3_f32 v11, v11, v16, v17
    v_max3_f32 v12, v12, v32, v33
    v_max3_f32 v11, v11, v18, v19
    v_max3_f32 v12, v12, v34, v35
    v_max3_f32 v11, v11, v20, v21
    v_max3_f32 v12, v12, v36, v37
    v_max3_f32 v11, v11, v22, v23
    v_max3_f32 v12, v12, v38, v39
    v_max3_f32 v11, v11, v24, v25
    v_max3_f32 v12, v12, v40, v41
    v_max3_f32 v11, v11, v26, v27
    v_max3_f32 v12, v12, v42, v43
    v_max3_f32 v11, v11, v28, v29
    v_max3_f32 v12, v12, v44, v45
    v_max3_f32 v11, v11, v30, v31
    v_max3_f32 v12, v12, v46, v47
    s_sub_u32 s33, s33, 1
    s_cmp_lg_u32 s33, 0
    s_cbranch_scc1 interleave_layers__grouped_kv_mqa__ssm_conv_h3__prompt_kernel_sp_mx
    v_mov_b32 v13, v11
    s_nop 1
    v_permlane32_swap_b32 v11, v13
    v_max_f32 v11, v11, v13
    v_mov_b32 v13, v12
    s_nop 1
    v_permlane32_swap_b32 v12, v13
    v_max_f32 v12, v12, v13
    v_cmp_gt_u32 vcc, 32, v1
    s_nop 1
    v_cndmask_b32 v11, v12, v11, vcc
    s_lshl_b32 s28, s4, 8
    s_add_u32 s28, s28, 19456
    v_lshlrev_b32 v13, 2, v1
    v_add_u32 v12, s28, v13
    ds_write_b32 v12, v11
    s_waitcnt lgkmcnt(0)
    s_barrier
    v_add_u32 v13, 19456, v13
    ds_read_b32 v200, v13 offset:0
    ds_read_b32 v201, v13 offset:256
    ds_read_b32 v202, v13 offset:512
    ds_read_b32 v203, v13 offset:768
    s_waitcnt lgkmcnt(1)
    v_max3_f32 v200, v200, v201, v202
    s_waitcnt lgkmcnt(0)
    v_max_f32 v200, v200, v203
    v_sub_f32 v200, 0, v200
    v_cvt_pk_bf16_f32 v201, v200, v200
    v_lshlrev_b32 v201, 16, v201
    v_sub_f32 v201, v200, v201
    v_cvt_pk_bf16_f32 v89, v200, v201
    s_waitcnt lgkmcnt(0)
    s_barrier
    v_subrev_u32 v8, 4096, v244
    v_and_b32 v9, 31, v1
    v_lshlrev_b32 v9, 3, v9
    s_lshl_b32 s28, s4, 12
    s_add_u32 s28, s28, 0x10000
    v_add_u32 v9, s28, v9
    v_subrev_u32 v10, 4096, v246
    v_accvgpr_write_b32 a208, 0
    v_accvgpr_write_b32 a209, 0
    v_accvgpr_write_b32 a210, 0
    v_accvgpr_write_b32 a211, 0
    v_accvgpr_write_b32 a212, 0
    v_accvgpr_write_b32 a213, 0
    v_accvgpr_write_b32 a214, 0
    v_accvgpr_write_b32 a215, 0
    v_accvgpr_write_b32 a216, 0
    v_accvgpr_write_b32 a217, 0
    v_accvgpr_write_b32 a218, 0
    v_accvgpr_write_b32 a219, 0
    v_accvgpr_write_b32 a220, 0
    v_accvgpr_write_b32 a221, 0
    v_accvgpr_write_b32 a222, 0
    v_accvgpr_write_b32 a223, 0
    v_accvgpr_write_b32 a224, 0
    v_accvgpr_write_b32 a225, 0
    v_accvgpr_write_b32 a226, 0
    v_accvgpr_write_b32 a227, 0
    v_accvgpr_write_b32 a228, 0
    v_accvgpr_write_b32 a229, 0
    v_accvgpr_write_b32 a230, 0
    v_accvgpr_write_b32 a231, 0
    v_accvgpr_write_b32 a232, 0
    v_accvgpr_write_b32 a233, 0
    v_accvgpr_write_b32 a234, 0
    v_accvgpr_write_b32 a235, 0
    v_accvgpr_write_b32 a236, 0
    v_accvgpr_write_b32 a237, 0
    v_accvgpr_write_b32 a238, 0
    v_accvgpr_write_b32 a239, 0
    s_mov_b32 s33, 16
    s_nop 4
interleave_layers__grouped_kv_mqa__ssm_conv_h3__prompt_kernel_sp_pv:
    global_load_dwordx4 v[148:151], v8, s[40:41] sc1
    global_load_dwordx2 v[152:153], v9, s[40:41] sc1
    global_load_dwordx4 v[156:159], v10, s[40:41] sc1
    global_load_dwordx4 v[160:163], v10, s[40:41] offset:1024 sc1
    v_add_u32 v8, 1024, v8
    v_add_u32 v9, 256, v9
    v_add_u32 v10, 2048, v10
    s_waitcnt vmcnt(3)
    v_mfma_f32_32x32x16_bf16 v[16:31], v[148:151], v[80:83], 0
    v_mfma_f32_32x32x16_bf16 v[32:47], v[148:151], v[84:87], 0
    s_waitcnt vmcnt(2)
    s_nop 8
    v_mfma_f32_32x32x4_2b_bf16 v[16:47], v[152:153], v[88:89], v[16:47] cbsz:1 abid:0
    s_nop 15
    s_nop 3
    v_exp_f32 v16, v16
    v_exp_f32 v17, v17
    v_exp_f32 v18, v18
    v_exp_f32 v19, v19
    v_exp_f32 v20, v20
    v_exp_f32 v21, v21
    v_exp_f32 v22, v22
    v_exp_f32 v23, v23
    v_cvt_pk_bf16_f32 v16, v16, v17
    v_cvt_pk_bf16_f32 v17, v18, v19
    v_cvt_pk_bf16_f32 v18, v20, v21
    v_cvt_pk_bf16_f32 v19, v22, v23
    v_exp_f32 v24, v24
    v_exp_f32 v25, v25
    v_exp_f32 v26, v26
    v_exp_f32 v27, v27
    v_exp_f32 v28, v28
    v_exp_f32 v29, v29
    v_exp_f32 v30, v30
    v_exp_f32 v31, v31
    v_cvt_pk_bf16_f32 v24, v24, v25
    v_cvt_pk_bf16_f32 v25, v26, v27
    v_cvt_pk_bf16_f32 v26, v28, v29
    v_cvt_pk_bf16_f32 v27, v30, v31
    v_exp_f32 v32, v32
    v_exp_f32 v33, v33
    v_exp_f32 v34, v34
    v_exp_f32 v35, v35
    v_exp_f32 v36, v36
    v_exp_f32 v37, v37
    v_exp_f32 v38, v38
    v_exp_f32 v39, v39
    v_cvt_pk_bf16_f32 v32, v32, v33
    v_cvt_pk_bf16_f32 v33, v34, v35
    v_cvt_pk_bf16_f32 v34, v36, v37
    v_cvt_pk_bf16_f32 v35, v38, v39
    v_exp_f32 v40, v40
    v_exp_f32 v41, v41
    v_exp_f32 v42, v42
    v_exp_f32 v43, v43
    v_exp_f32 v44, v44
    v_exp_f32 v45, v45
    v_exp_f32 v46, v46
    v_exp_f32 v47, v47
    v_cvt_pk_bf16_f32 v40, v40, v41
    v_cvt_pk_bf16_f32 v41, v42, v43
    v_cvt_pk_bf16_f32 v42, v44, v45
    v_cvt_pk_bf16_f32 v43, v46, v47
    s_waitcnt vmcnt(1)
    v_mfma_f32_32x32x16_bf16 a[208:223], v[156:159], v[16:19], a[208:223]
    s_waitcnt vmcnt(0)
    v_mfma_f32_32x32x16_bf16 a[208:223], v[160:163], v[24:27], a[208:223]
    v_mfma_f32_32x32x16_bf16 a[224:239], v[156:159], v[32:35], a[224:239]
    v_mfma_f32_32x32x16_bf16 a[224:239], v[160:163], v[40:43], a[224:239]
    s_sub_u32 s33, s33, 1
    s_cmp_lg_u32 s33, 0
    s_cbranch_scc1 interleave_layers__grouped_kv_mqa__ssm_conv_h3__prompt_kernel_sp_pv
    s_nop 6
    ds_write_b128 v234, a[208:211] offset:0
    ds_write_b128 v234, a[212:215] offset:1024
    ds_write_b128 v234, a[216:219] offset:2048
    ds_write_b128 v234, a[224:227] offset:3072
    ds_write_b128 v234, a[228:231] offset:4096
    ds_write_b128 v234, a[232:235] offset:5120
    s_waitcnt lgkmcnt(0)
    s_barrier
    ds_read_b128 v[216:219], v236 offset:0
    ds_read_b128 v[220:223], v236 offset:6144
    ds_read_b128 v[224:227], v236 offset:12288
    ds_read_b128 v[228:231], v236 offset:18432
    ds_read_b128 v[200:203], v235 offset:0
    ds_read_b128 v[204:207], v235 offset:6144
    ds_read_b128 v[208:211], v235 offset:12288
    ds_read_b128 v[212:215], v235 offset:18432
    s_waitcnt lgkmcnt(6)
    v_pk_add_f32 v[216:217], v[216:217], v[220:221]
    s_waitcnt lgkmcnt(4)
    v_pk_add_f32 v[224:225], v[224:225], v[228:229]
    v_add_f32 v218, v218, v222
    v_add_f32 v226, v226, v230
    v_pk_add_f32 v[216:217], v[216:217], v[224:225]
    v_add_f32 v218, v218, v226
    v_rcp_f32 v242, v218
    v_subrev_u32 v243, 0x1f800000, v218
    v_cmp_le_u32 vcc, 0x40000000, v243
    s_waitcnt lgkmcnt(2)
    v_pk_add_f32 v[200:201], v[200:201], v[204:205]
    s_waitcnt lgkmcnt(0)
    v_pk_add_f32 v[208:209], v[208:209], v[212:213]
    v_pk_add_f32 v[202:203], v[202:203], v[206:207]
    v_pk_add_f32 v[210:211], v[210:211], v[214:215]
    s_or_b64 s[84:85], s[84:85], vcc
    v_pk_add_f32 v[200:201], v[200:201], v[208:209]
    v_pk_add_f32 v[202:203], v[202:203], v[210:211]
    v_pk_mul_f32 v[216:217], v[216:217], v[242:243] op_sel_hi:[1,0]
    v_pk_mul_f32 v[200:201], v[200:201], v[242:243] op_sel_hi:[1,0]
    v_pk_mul_f32 v[202:203], v[202:203], v[242:243] op_sel_hi:[1,0]
    v_cvt_pk_bf16_f32 v220, v216, v217
    v_cvt_pk_bf16_f32 v204, v200, v201
    v_cvt_pk_bf16_f32 v205, v202, v203
    ds_write_b32 v238, v220
    ds_write_b64 v237, v[204:205]
    v_add_u32 v238, 256, v238
    s_waitcnt lgkmcnt(0)
    s_barrier
    ds_read_b128 v[188:191], v4 offset:44032
    ds_read_b128 v[192:195], v4 offset:45056
    v_add_u32 v5, 0, v233
    global_load_dwordx4 v[16:19], v5, s[8:9] offset:-4096 sc1
    v_add_u32 v5, 1024, v233
    global_load_dwordx4 v[20:23], v5, s[8:9] offset:-4096 sc1
    v_add_u32 v5, 2048, v233
    global_load_dwordx4 v[24:27], v5, s[8:9] offset:-4096 sc1
    v_add_u32 v5, 3072, v233
    global_load_dwordx4 v[28:31], v5, s[8:9] offset:-4096 sc1
    v_add_u32 v5, 4096, v233
    global_load_dwordx4 v[32:35], v5, s[8:9] offset:-4096 sc1
    v_add_u32 v5, 5120, v233
    global_load_dwordx4 v[36:39], v5, s[8:9] offset:-4096 sc1
    v_add_u32 v5, 6144, v233
    global_load_dwordx4 v[40:43], v5, s[8:9] offset:-4096 sc1
    v_add_u32 v5, 7168, v233
    global_load_dwordx4 v[44:47], v5, s[8:9] offset:-4096 sc1
    v_add_u32 v5, 8192, v233
    global_load_dwordx4 v[48:51], v5, s[8:9] offset:-4096 sc1
    v_add_u32 v5, 36864, v233
    global_load_dwordx4 v[52:55], v5, s[8:9] offset:-4096 sc1
    v_add_u32 v5, 37888, v233
    global_load_dwordx4 v[56:59], v5, s[8:9] offset:-4096 sc1
    v_add_u32 v5, 38912, v233
    global_load_dwordx4 v[60:63], v5, s[8:9] offset:-4096 sc1
    v_add_u32 v5, 39936, v233
    global_load_dwordx4 v[64:67], v5, s[8:9] offset:-4096 sc1
    v_add_u32 v5, 40960, v233
    global_load_dwordx4 v[68:71], v5, s[8:9] offset:-4096 sc1
    v_add_u32 v5, 41984, v233
    global_load_dwordx4 v[72:75], v5, s[8:9] offset:-4096 sc1
    v_add_u32 v5, 43008, v233
    global_load_dwordx4 v[76:79], v5, s[8:9] offset:-4096 sc1
    v_add_u32 v5, 44032, v233
    global_load_dwordx4 v[80:83], v5, s[8:9] offset:-4096 sc1
    v_add_u32 v5, 45056, v233
    global_load_dwordx4 v[84:87], v5, s[8:9] offset:-4096 sc1
    s_waitcnt vmcnt(17) lgkmcnt(1)
    v_mfma_f32_16x16x32_bf16 v[96:99], v[16:19], v[188:191], v[96:99]
    s_waitcnt vmcnt(16)
    v_mfma_f32_16x16x32_bf16 v[100:103], v[20:23], v[188:191], v[100:103]
    s_waitcnt vmcnt(15)
    v_mfma_f32_16x16x32_bf16 v[104:107], v[24:27], v[188:191], v[104:107]
    s_waitcnt vmcnt(14)
    v_mfma_f32_16x16x32_bf16 v[108:111], v[28:31], v[188:191], v[108:111]
    s_waitcnt vmcnt(13)
    v_mfma_f32_16x16x32_bf16 v[112:115], v[32:35], v[188:191], v[112:115]
    s_waitcnt vmcnt(12)
    v_mfma_f32_16x16x32_bf16 v[116:119], v[36:39], v[188:191], v[116:119]
    s_waitcnt vmcnt(11)
    v_mfma_f32_16x16x32_bf16 v[120:123], v[40:43], v[188:191], v[120:123]
    s_waitcnt vmcnt(10)
    v_mfma_f32_16x16x32_bf16 v[124:127], v[44:47], v[188:191], v[124:127]
    s_waitcnt vmcnt(9)
    v_mfma_f32_16x16x32_bf16 v[128:131], v[48:51], v[188:191], v[128:131]
    s_waitcnt vmcnt(8) lgkmcnt(0)
    v_mfma_f32_16x16x32_bf16 v[96:99], v[52:55], v[192:195], v[96:99]
    s_waitcnt vmcnt(7)
    v_mfma_f32_16x16x32_bf16 v[100:103], v[56:59], v[192:195], v[100:103]
    s_waitcnt vmcnt(6)
    v_mfma_f32_16x16x32_bf16 v[104:107], v[60:63], v[192:195], v[104:107]
    s_waitcnt vmcnt(5)
    v_mfma_f32_16x16x32_bf16 v[108:111], v[64:67], v[192:195], v[108:111]
    s_waitcnt vmcnt(4)
    v_mfma_f32_16x16x32_bf16 v[112:115], v[68:71], v[192:195], v[112:115]
    s_waitcnt vmcnt(3)
    v_mfma_f32_16x16x32_bf16 v[116:119], v[72:75], v[192:195], v[116:119]
    s_waitcnt vmcnt(2)
    v_mfma_f32_16x16x32_bf16 v[120:123], v[76:79], v[192:195], v[120:123]
    s_waitcnt vmcnt(1)
    v_mfma_f32_16x16x32_bf16 v[124:127], v[80:83], v[192:195], v[124:127]
    s_waitcnt vmcnt(0)
    v_mfma_f32_16x16x32_bf16 v[128:131], v[84:87], v[192:195], v[128:131]
    v_add_u32 v233, 73728, v233
    v_add_u32 v240, 256, v240
    s_add_u32 s82, s82, 1
    s_waitcnt vmcnt(0) lgkmcnt(0)
    s_nop 15
    s_barrier
    s_cmp_lt_u32 s82, 4
    s_cbranch_scc1 interleave_layers__grouped_kv_mqa__ssm_conv_h3__prompt_kernel_sp_ph
    ds_read_b128 v[196:199], v4 offset:46080
    v_add_u32 v5, 0, v233
    global_load_dwordx4 v[16:19], v5, s[8:9] offset:-4096 sc1
    v_add_u32 v5, 1024, v233
    global_load_dwordx4 v[20:23], v5, s[8:9] offset:-4096 sc1
    v_add_u32 v5, 2048, v233
    global_load_dwordx4 v[24:27], v5, s[8:9] offset:-4096 sc1
    v_add_u32 v5, 3072, v233
    global_load_dwordx4 v[28:31], v5, s[8:9] offset:-4096 sc1
    v_add_u32 v5, 4096, v233
    global_load_dwordx4 v[32:35], v5, s[8:9] offset:-4096 sc1
    v_add_u32 v5, 5120, v233
    global_load_dwordx4 v[36:39], v5, s[8:9] offset:-4096 sc1
    v_add_u32 v5, 6144, v233
    global_load_dwordx4 v[40:43], v5, s[8:9] offset:-4096 sc1
    v_add_u32 v5, 7168, v233
    global_load_dwordx4 v[44:47], v5, s[8:9] offset:-4096 sc1
    v_add_u32 v5, 8192, v233
    global_load_dwordx4 v[48:51], v5, s[8:9] offset:-4096 sc1
    s_waitcnt vmcnt(8) lgkmcnt(0)
    v_mfma_f32_16x16x32_bf16 v[96:99], v[16:19], v[196:199], v[96:99]
    s_waitcnt vmcnt(7)
    v_mfma_f32_16x16x32_bf16 v[100:103], v[20:23], v[196:199], v[100:103]
    s_waitcnt vmcnt(6)
    v_mfma_f32_16x16x32_bf16 v[104:107], v[24:27], v[196:199], v[104:107]
    s_waitcnt vmcnt(5)
    v_mfma_f32_16x16x32_bf16 v[108:111], v[28:31], v[196:199], v[108:111]
    s_waitcnt vmcnt(4)
    v_mfma_f32_16x16x32_bf16 v[112:115], v[32:35], v[196:199], v[112:115]
    s_waitcnt vmcnt(3)
    v_mfma_f32_16x16x32_bf16 v[116:119], v[36:39], v[196:199], v[116:119]
    s_waitcnt vmcnt(2)
    v_mfma_f32_16x16x32_bf16 v[120:123], v[40:43], v[196:199], v[120:123]
    s_waitcnt vmcnt(1)
    v_mfma_f32_16x16x32_bf16 v[124:127], v[44:47], v[196:199], v[124:127]
    s_waitcnt vmcnt(0)
    v_mfma_f32_16x16x32_bf16 v[128:131], v[48:51], v[196:199], v[128:131]
    s_waitcnt vmcnt(0) lgkmcnt(0)
    s_nop 15
    s_branch interleave_layers__grouped_kv_mqa__ssm_conv_h3__prompt_kernel_at_slow_back
interleave_layers__grouped_kv_mqa__ssm_conv_h3__prompt_kernel_exit:
interleave_layers__grouped_kv_mqa__ssm_conv_h3__prompt_kernel_done:
    s_endpgm
.section .rodata,"a"
.p2align 6
.amdhsa_kernel interleave_layers__grouped_kv_mqa__ssm_conv_h3__prompt_kernel
  .amdhsa_next_free_vgpr 512
  .amdhsa_next_free_sgpr 102
  .amdhsa_accum_offset 256
  .amdhsa_group_segment_fixed_size 0
  .amdhsa_kernarg_size 112
  .amdhsa_user_sgpr_count 2
  .amdhsa_user_sgpr_kernarg_segment_ptr 1
  .amdhsa_system_sgpr_workgroup_id_x 1
  .amdhsa_float_denorm_mode_32 3
.end_amdhsa_kernel
```
